```python
import torch

def _softmax(x, axis=-1):
    return torch.softmax(x, dim=axis)
def _gelu(x):
    return torch.nn.functional.gelu(x, approximate="tanh")
def _silu(x):
    return torch.nn.functional.silu(x)
def _sigmoid(x):
    return torch.sigmoid(x)
def _layernorm(x, axis=-1, eps=1e-5):
    m = x.mean(dim=axis, keepdim=True)
    v = x.var(dim=axis, keepdim=True, unbiased=False)
    return (x - m) / torch.sqrt(v + eps)
def _scatter_add(tgt, idx, src, axis=0):
    return tgt.clone().index_add_(axis, idx, src)
def _segment_sum(src, seg, n):
    out = torch.zeros((n,) + src.shape[1:], dtype=src.dtype)
    return out.index_add_(0, seg, src)
def _pad(x, pw):
    flat = tuple(v for pair in reversed(pw) for v in pair)
    return torch.nn.functional.pad(x, flat)

kernel_name = 'gated_mix__ssm_conv_s5__glu_gated_glu__prompt'

def setup_inputs():

    _w = (lambda a: (lambda t: t.to(torch.bfloat16) if t.is_floating_point() else t)(torch.as_tensor(a)))
    def _A_setup():
        B, S, D = 1, 2048, 512
        P = D
        Lambda_re = -0.5 * (lambda _x: torch.exp(torch.as_tensor(_x)))((lambda *s: torch.randn(*s, dtype=torch.bfloat16) * 0.4)(P))
        Lambda_im = (lambda *s: torch.randn(*s, dtype=torch.bfloat16) * 0.8)(P) * 1.0
        B_re = (lambda *s: torch.randn(*s, dtype=torch.bfloat16) * 0.8)(P, D) * (D ** -0.5)
        B_im = (lambda *s: torch.randn(*s, dtype=torch.bfloat16) * 0.8)(P, D) * (D ** -0.5)
        C_re = (lambda *s: torch.randn(*s, dtype=torch.bfloat16) * 0.8)(D, P) * (P ** -0.5)
        C_im = (lambda *s: torch.randn(*s, dtype=torch.bfloat16) * 0.8)(D, P) * (P ** -0.5)
        log_dt = (lambda *s: torch.randn(*s, dtype=torch.bfloat16) * 0.4)(P) * 0.3 - 2.0
        Dskip = (lambda *s: torch.randn(*s, dtype=torch.bfloat16) * 0.1)(D)
        return {
            "x": _w((lambda *s: torch.randn(*s, dtype=torch.bfloat16) * 0.05)(B, S, D)),
            "Lambda_re": _w(Lambda_re),
            "Lambda_im": _w(Lambda_im),
            "B_re": _w(B_re),
            "B_im": _w(B_im),
            "C_re": _w(C_re),
            "C_im": _w(C_im),
            "log_dt": _w(log_dt),
            "Dskip": _w(Dskip),
        }
    _A_in = _A_setup()

    def _B_setup():
        B, S, D, F = 1, 2048, 512, 1792
        return {
            "x": _w((lambda *s: torch.randn(*s, dtype=torch.bfloat16) * 0.05)(B, S, D)),
            "w_gate": _w((lambda *s: torch.randn(*s, dtype=torch.bfloat16) * 0.4)(D, F)),
            "w_up": _w((lambda *s: torch.randn(*s, dtype=torch.bfloat16) * 0.05)(D, F)),
            "w_down": _w((lambda *s: torch.randn(*s, dtype=torch.bfloat16) * 0.05)(F, D)),
        }
    _B_in = _B_setup()

    return {
        "A_x": _A_in["x"],
        "A_Lambda_re": _A_in["Lambda_re"],
        "A_Lambda_im": _A_in["Lambda_im"],
        "A_B_re": _A_in["B_re"],
        "A_B_im": _A_in["B_im"],
        "A_C_re": _A_in["C_re"],
        "A_C_im": _A_in["C_im"],
        "A_log_dt": _A_in["log_dt"],
        "A_Dskip": _A_in["Dskip"],
        "B_x": _B_in["x"],
        "B_w_gate": _B_in["w_gate"],
        "B_w_up": _B_in["w_up"],
        "B_w_down": _B_in["w_down"],
        "gate_w": _w((lambda *s: torch.randn(*s, dtype=torch.bfloat16) * 0.05)(512) * 16.0),
    }

def reference(A_x, A_Lambda_re, A_Lambda_im, A_B_re, A_B_im, A_C_re, A_C_im, A_log_dt, A_Dskip, B_x, B_w_gate, B_w_up, B_w_down, gate_w):
    def _A_ref(x, Lambda_re, Lambda_im, B_re, B_im, C_re, C_im, log_dt, Dskip):
        Bsz, L, H = x.shape
        Lam = Lambda_re + 1j * Lambda_im
        Bmat = B_re + 1j * B_im
        Cmat = C_re + 1j * C_im
        dt = torch.exp(log_dt)
        Lam_bar = torch.exp(dt * Lam)
        B_bar = ((Lam_bar - 1.0) / Lam)[:, None] * Bmat
        Bu = torch.einsum("bld,pd->blp", x + 0j, B_bar)
        h = torch.zeros_like(Bu[:, 0, :])
        hs = []
        for t in range(L):
            h = Lam_bar[None, :] * h + Bu[:, t, :]
            hs.append(h)
        hseq = torch.stack(hs, 1)
        y = 2.0 * torch.einsum("blp,dp->bld", hseq, Cmat).real + x * Dskip[None, None, :]
        return y

    def _B_ref(x, w_gate, w_up, w_down):
        g = torch.einsum("bsd,df->bsf", x, w_gate)
        u = torch.einsum("bsd,df->bsf", x, w_up)
        h = _sigmoid(g) * u
        return torch.einsum("bsf,fd->bsd", h, w_down)

    x = A_x
    g = _sigmoid((x * gate_w).sum(-1, keepdims=True))
    a = _A_ref(x, A_Lambda_re, A_Lambda_im, A_B_re, A_B_im, A_C_re, A_C_im, A_log_dt, A_Dskip)
    b = _B_ref(x, B_w_gate, B_w_up, B_w_down)
    return g * a + (1 - g) * b
```

```asm
; @launch grid=(256,1,1) block=(512,1,1) lds=163840
.amdgcn_target "amdgcn-amd-amdhsa--gfx950"
.text
    .p2align 8
    .globl gated_mix__ssm_conv_s5__glu_gated_glu__prompt_kernel
    .type gated_mix__ssm_conv_s5__glu_gated_glu__prompt_kernel,@function
gated_mix__ssm_conv_s5__glu_gated_glu__prompt_kernel:
    s_getpc_b64 s[90:91]
    s_cmp_ge_u32 s2, 256
    s_cbranch_scc1 L_1
    s_load_dwordx16 s[16:31], s[0:1], 0
    s_load_dwordx16 s[32:47], s[0:1], 64
    s_load_dwordx2 s[48:49], s[0:1], 128
    v_lshrrev_b32 v1, 6, v0
    v_and_b32 v0, 63, v0
    v_readfirstlane_b32 s3, v1
    s_and_b32 s4, s2, 7
    s_lshr_b32 s5, s2, 3
    s_and_b32 s6, s4, 1
    s_lshr_b32 s7, s5, 2
    s_lshl_b32 s7, s7, 1
    s_add_u32 s6, s6, s7
    s_and_b32 s7, s5, 3
    s_lshr_b32 s8, s4, 1
    s_mul_i32 s9, s8, 448
    s_lshl_b32 s4, s7, 7
    s_add_u32 s9, s9, s4
    s_lshl_b32 s11, s8, 7
    s_lshl_b32 s4, s7, 4
    s_add_u32 s10, s11, s4
    s_add_u32 s11, s11, 64
    s_cmp_eq_u32 s7, 3
    s_cselect_b32 s12, 1, 0
    s_lshl_b32 s13, s8, 2
    s_add_u32 s13, s13, s7
    s_cmp_lt_u32 s3, 4
    s_cbranch_scc1 L_2
    s_sub_u32 s3, s3, 4
    s_setprio 3
    v_lshrrev_b32 v1, 3, v0
    v_and_b32 v2, 7, v0
    v_lshrrev_b32 v3, 5, v0
    v_and_b32 v4, 2, v1
    v_or_b32 v3, v3, v4
    v_xor_b32 v3, v3, v2
    v_lshlrev_b32 v3, 4, v3
    v_lshl_add_u32 v10, v1, 10, v3
    v_xor_b32 v11, 64, v10
    v_bfe_u32 v3, v0, 4, 1
    v_lshlrev_b32 v3, 2, v3
    v_xor_b32 v3, v3, v2
    v_lshlrev_b32 v3, 4, v3
    s_movk_i32 s4, 3584
    v_mad_u32_u24 v16, v1, s4, v3
    v_lshl_add_u32 v15, v1, 10, v3
    v_lshrrev_b32 v4, 4, v0
    v_xor_b32 v3, v4, v2
    v_lshlrev_b32 v3, 4, v3
    v_lshl_add_u32 v28, v1, 10, v3
    v_xor_b32 v29, 64, v28
    s_cmp_eq_u32 s12, 1
    s_cselect_b64 vcc, -1, 0
    v_cndmask_b32 v12, v16, v28, vcc
    v_cndmask_b32 v13, v16, v29, vcc
    s_and_b32 s14, s3, 1
    s_mul_i32 s4, s14, 114688
    s_lshl_b32 s5, s9, 1
    s_add_u32 s70, s4, s5
    s_lshl_b32 s4, s14, 5
    s_add_u32 s4, s4, s11
    s_lshl_b32 s5, s4, 10
    s_cmp_eq_u32 s12, 1
    s_cselect_b32 s80, s5, s70
    s_mov_b32 s81, 143360
    s_movk_i32 s82, 28672
    s_cselect_b32 s81, -24448, s81
    s_cselect_b32 s82, 8192, s82
    s_mov_b32 s4, 1835008
    s_cselect_b32 s58, 524288, s4
    s_mov_b32 s59, 0x20000
    s_cselect_b32 s4, 0, 128
    s_add_u32 s70, s70, s4
    s_lshl_b32 s4, s14, 2
    v_or_b32 v4, s4, v4
    v_xor_b32 v4, v4, v2
    v_lshlrev_b32 v4, 4, v4
    v_lshl_add_u32 v14, v1, 10, v4
    s_lshl_b32 s4, s14, 3
    s_add_u32 s4, s4, s10
    s_lshl_b32 s85, s4, 10
    s_lshl_b32 s4, s6, 7
    s_lshl_b32 s5, s3, 5
    s_add_u32 s4, s4, s5
    s_lshl_b32 s86, s4, 10
    s_lshl_b32 s87, s3, 12
    s_lshr_b32 s4, s3, 1
    s_mul_i32 s88, s4, 24576
    s_lshl_b32 s4, s14, 12
    s_add_u32 s88, s88, s4
    s_add_u32 s88, s88, 102400
    s_lshl_b32 s89, s3, 10
    s_add_u32 s89, s89, 151552
    s_mov_b32 s54, 2097152
    s_mov_b32 s55, 0x20000
    s_mov_b32 s62, 524288
    s_mov_b32 s63, 0x20000
    s_waitcnt lgkmcnt(0)
    s_mov_b64 s[52:53], s[16:17]
    s_cmp_ge_u32 s3, 2
    s_cselect_b64 s[72:73], s[38:39], s[36:37]
    s_cselect_b64 s[60:61], s[24:25], s[22:23]
    s_cmp_eq_u32 s12, 1
    s_cselect_b64 s[56:57], s[60:61], s[72:73]
    s_mov_b64 s[90:91], s[72:73]
    s_add_u32 m0, s87, 4096
    s_add_u32 s4, s86, 0
    buffer_load_dwordx4 v10, s[52:55], s4 offen lds
    s_add_u32 m0, s87, 5120
    s_add_u32 s4, s86, 8192
    buffer_load_dwordx4 v10, s[52:55], s4 offen lds
    s_add_u32 m0, s87, 6144
    s_add_u32 s4, s86, 16384
    buffer_load_dwordx4 v11, s[52:55], s4 offen lds
    s_add_u32 m0, s87, 7168
    s_add_u32 s4, s86, 24576
    buffer_load_dwordx4 v11, s[52:55], s4 offen lds
    s_add_u32 m0, s88, 0
    s_nop 0
    buffer_load_dwordx4 v12, s[56:59], s80 offen lds
    s_add_u32 s80, s80, s82
    s_add_u32 m0, s88, 1024
    s_nop 0
    buffer_load_dwordx4 v13, s[56:59], s80 offen lds
    s_add_u32 s80, s80, s82
    s_add_u32 m0, s88, 2048
    s_nop 0
    buffer_load_dwordx4 v12, s[56:59], s80 offen lds
    s_add_u32 s80, s80, s82
    s_add_u32 m0, s88, 3072
    s_nop 0
    buffer_load_dwordx4 v13, s[56:59], s80 offen lds
    s_add_u32 s80, s80, s81
    s_add_u32 m0, s89, 0
    s_add_u32 s4, s85, 0
    buffer_load_dwordx4 v14, s[60:63], s4 offen lds
    s_add_u32 m0, s87, 20480
    s_add_u32 s4, s86, 128
    buffer_load_dwordx4 v10, s[52:55], s4 offen lds
    s_add_u32 m0, s87, 21504
    s_add_u32 s4, s86, 8320
    buffer_load_dwordx4 v10, s[52:55], s4 offen lds
    s_add_u32 m0, s87, 22528
    s_add_u32 s4, s86, 16512
    buffer_load_dwordx4 v11, s[52:55], s4 offen lds
    s_add_u32 m0, s87, 23552
    s_add_u32 s4, s86, 24704
    buffer_load_dwordx4 v11, s[52:55], s4 offen lds
    s_add_u32 m0, s88, 8192
    s_nop 0
    buffer_load_dwordx4 v12, s[56:59], s80 offen lds
    s_add_u32 s80, s80, s82
    s_add_u32 m0, s88, 9216
    s_nop 0
    buffer_load_dwordx4 v13, s[56:59], s80 offen lds
    s_add_u32 s80, s80, s82
    s_add_u32 m0, s88, 10240
    s_nop 0
    buffer_load_dwordx4 v12, s[56:59], s80 offen lds
    s_add_u32 s80, s80, s82
    s_add_u32 m0, s88, 11264
    s_nop 0
    buffer_load_dwordx4 v13, s[56:59], s80 offen lds
    s_add_u32 s80, s80, s81
    s_add_u32 m0, s89, 4096
    s_add_u32 s4, s85, 128
    buffer_load_dwordx4 v14, s[60:63], s4 offen lds
    s_waitcnt vmcnt(9)
    s_barrier
    s_add_u32 m0, s87, 36864
    s_add_u32 s4, s86, 256
    buffer_load_dwordx4 v10, s[52:55], s4 offen lds
    s_add_u32 m0, s87, 37888
    s_add_u32 s4, s86, 8448
    buffer_load_dwordx4 v10, s[52:55], s4 offen lds
    s_add_u32 m0, s87, 38912
    s_add_u32 s4, s86, 16640
    buffer_load_dwordx4 v11, s[52:55], s4 offen lds
    s_add_u32 m0, s87, 39936
    s_add_u32 s4, s86, 24832
    buffer_load_dwordx4 v11, s[52:55], s4 offen lds
    s_add_u32 m0, s88, 16384
    s_nop 0
    buffer_load_dwordx4 v12, s[56:59], s80 offen lds
    s_add_u32 s80, s80, s82
    s_add_u32 m0, s88, 17408
    s_nop 0
    buffer_load_dwordx4 v13, s[56:59], s80 offen lds
    s_add_u32 s80, s80, s82
    s_add_u32 m0, s88, 18432
    s_nop 0
    buffer_load_dwordx4 v12, s[56:59], s80 offen lds
    s_add_u32 s80, s80, s82
    s_add_u32 m0, s88, 19456
    s_nop 0
    buffer_load_dwordx4 v13, s[56:59], s80 offen lds
    s_add_u32 s80, s80, s81
    s_add_u32 m0, s89, 8192
    s_add_u32 s4, s85, 256
    buffer_load_dwordx4 v14, s[60:63], s4 offen lds
    s_mov_b32 s64, s48
    s_mov_b32 s65, s49
    s_mov_b32 s66, 11796480
    s_mov_b32 s67, 0x20000
    s_mov_b32 s72, s18
    s_mov_b32 s73, s19
    s_mov_b32 s74, 1024
    s_mov_b32 s75, 0x20000
    s_mov_b32 s76, s20
    s_mov_b32 s77, s21
    s_mov_b32 s78, 1024
    s_mov_b32 s79, 0x20000
    s_mov_b32 s96, s30
    s_mov_b32 s97, s31
    s_mov_b32 s98, 1024
    s_mov_b32 s99, 0x20000
    s_mov_b64 s[68:69], s[42:43]
    s_mov_b32 s71, 0x20000
    s_mov_b32 s92, s70
    s_movk_i32 s70, 1024
    s_lshl_b32 s4, s6, 7
    s_lshl_b32 s5, s13, 3
    s_add_u32 s4, s4, s5
    s_lshl_b32 s5, s3, 1
    s_add_u32 s15, s4, s5
    s_lshl_b32 s14, s15, 10
    v_lshlrev_b32 v1, 4, v0
    s_and_b32 s4, s3, 1
    s_lshl_b32 s4, s4, 6
    v_add_u32 v2, s4, v0
    v_add_u32 v3, s10, v2
    s_sub_u32 s5, s11, 16
    v_add_u32 v4, s5, v2
    v_cmp_gt_u32 vcc, 16, v2
    s_nop 1
    v_cndmask_b32 v3, v4, v3, vcc
    v_lshlrev_b32 v3, 1, v3
    s_waitcnt vmcnt(9)
    s_barrier
    s_add_u32 m0, s87, 53248
    s_add_u32 s4, s86, 384
    buffer_load_dwordx4 v10, s[52:55], s4 offen lds
    s_add_u32 m0, s87, 54272
    s_add_u32 s4, s86, 8576
    buffer_load_dwordx4 v10, s[52:55], s4 offen lds
    s_add_u32 m0, s87, 55296
    s_add_u32 s4, s86, 16768
    buffer_load_dwordx4 v11, s[52:55], s4 offen lds
    s_add_u32 m0, s87, 56320
    s_add_u32 s4, s86, 24960
    buffer_load_dwordx4 v11, s[52:55], s4 offen lds
    s_add_u32 m0, s88, 0
    s_nop 0
    buffer_load_dwordx4 v12, s[56:59], s80 offen lds
    s_add_u32 s80, s80, s82
    s_add_u32 m0, s88, 1024
    s_nop 0
    buffer_load_dwordx4 v13, s[56:59], s80 offen lds
    s_add_u32 s80, s80, s82
    s_add_u32 m0, s88, 2048
    s_nop 0
    buffer_load_dwordx4 v12, s[56:59], s80 offen lds
    s_add_u32 s80, s80, s82
    s_add_u32 m0, s88, 3072
    s_nop 0
    buffer_load_dwordx4 v13, s[56:59], s80 offen lds
    s_add_u32 s80, s80, s81
    s_add_u32 m0, s89, 0
    s_add_u32 s4, s85, 384
    buffer_load_dwordx4 v14, s[60:63], s4 offen lds
    buffer_load_dwordx4 v[32:35], v1, s[52:55], s14 offen
    buffer_load_dwordx4 v[36:39], v1, s[52:55], s14 offen offset:1024
    buffer_load_dwordx4 v[40:43], v1, s[68:71], 0 offen
    buffer_load_ushort v44, v3, s[72:75], 0 offen
    buffer_load_ushort v45, v3, s[76:79], 0 offen
    buffer_load_ushort v46, v3, s[96:99], 0 offen
    s_mov_b32 s70, s92
    s_waitcnt vmcnt(15)
    s_barrier
    s_add_u32 m0, s87, 69632
    s_add_u32 s4, s86, 512
    buffer_load_dwordx4 v10, s[52:55], s4 offen lds
    s_add_u32 m0, s87, 70656
    s_add_u32 s4, s86, 8704
    buffer_load_dwordx4 v10, s[52:55], s4 offen lds
    s_add_u32 m0, s87, 71680
    s_add_u32 s4, s86, 16896
    buffer_load_dwordx4 v11, s[52:55], s4 offen lds
    s_add_u32 m0, s87, 72704
    s_add_u32 s4, s86, 25088
    buffer_load_dwordx4 v11, s[52:55], s4 offen lds
    s_add_u32 m0, s88, 8192
    s_nop 0
    buffer_load_dwordx4 v12, s[56:59], s80 offen lds
    s_add_u32 s80, s80, s82
    s_add_u32 m0, s88, 9216
    s_nop 0
    buffer_load_dwordx4 v13, s[56:59], s80 offen lds
    s_add_u32 s80, s80, s82
    s_add_u32 m0, s88, 10240
    s_nop 0
    buffer_load_dwordx4 v12, s[56:59], s80 offen lds
    s_add_u32 s80, s80, s82
    s_add_u32 m0, s88, 11264
    s_nop 0
    buffer_load_dwordx4 v13, s[56:59], s80 offen lds
    s_add_u32 s80, s80, s81
    s_add_u32 m0, s89, 4096
    s_add_u32 s4, s85, 512
    buffer_load_dwordx4 v14, s[60:63], s4 offen lds
    s_waitcnt vmcnt(15)
    s_barrier
    s_add_u32 m0, s87, 86016
    s_add_u32 s4, s86, 640
    buffer_load_dwordx4 v10, s[52:55], s4 offen lds
    s_add_u32 m0, s87, 87040
    s_add_u32 s4, s86, 8832
    buffer_load_dwordx4 v10, s[52:55], s4 offen lds
    s_add_u32 m0, s87, 88064
    s_add_u32 s4, s86, 17024
    buffer_load_dwordx4 v11, s[52:55], s4 offen lds
    s_add_u32 m0, s87, 89088
    s_add_u32 s4, s86, 25216
    buffer_load_dwordx4 v11, s[52:55], s4 offen lds
    s_add_u32 m0, s88, 16384
    s_nop 0
    buffer_load_dwordx4 v12, s[56:59], s80 offen lds
    s_add_u32 s80, s80, s82
    s_add_u32 m0, s88, 17408
    s_nop 0
    buffer_load_dwordx4 v13, s[56:59], s80 offen lds
    s_add_u32 s80, s80, s82
    s_add_u32 m0, s88, 18432
    s_nop 0
    buffer_load_dwordx4 v12, s[56:59], s80 offen lds
    s_add_u32 s80, s80, s82
    s_add_u32 m0, s88, 19456
    s_nop 0
    buffer_load_dwordx4 v13, s[56:59], s80 offen lds
    s_add_u32 s80, s80, s81
    s_add_u32 m0, s89, 8192
    s_add_u32 s4, s85, 640
    buffer_load_dwordx4 v14, s[60:63], s4 offen lds
    s_waitcnt vmcnt(18)
    v_lshlrev_b32 v44, 16, v44
    v_lshlrev_b32 v45, 16, v45
    v_lshlrev_b32 v46, 16, v46
    v_mul_f32 v46, 1069066811, v46
    v_exp_f32 v46, v46
    s_nop 0
    v_cvt_pk_bf16_f32 v47, v46, v46
    v_lshlrev_b32 v46, 16, v47
    v_mul_f32 v47, v46, v44
    v_mul_f32 v48, v46, v45
    v_mul_f32 v47, 1069066811, v47
    v_exp_f32 v47, v47
    v_mul_f32 v48, 1042479491, v48
    v_rndne_f32 v49, v48
    v_sub_f32 v48, v48, v49
    v_cos_f32 v49, v48
    v_sin_f32 v50, v48
    s_nop 0
    v_mul_f32 v52, v47, v49
    v_mul_f32 v53, v47, v50
    v_mul_f32 v49, v44, v44
    v_fma_f32 v49, v45, v45, v49
    v_rcp_f32 v49, v49
    v_add_f32 v50, -1.0, v52
    v_mul_f32 v54, v50, v44
    v_fma_f32 v54, v53, v45, v54
    v_mul_f32 v55, v53, v44
    v_fma_f32 v55, -v50, v45, v55
    v_add_f32 v49, v49, v49
    v_mul_f32 v54, v54, v49
    v_mul_f32 v55, v55, v49
    v_lshlrev_b32 v2, 4, v2
    v_cmp_gt_u32 vcc, 1280, v2
    s_and_saveexec_b64 s[78:79], vcc
    ds_write_b128 v2, v[52:55] offset:0
    s_mov_b64 exec, s[78:79]
    s_waitcnt vmcnt(9) lgkmcnt(0)
    s_barrier
    s_add_u32 m0, s87, 53248
    s_add_u32 s4, s86, 768
    buffer_load_dwordx4 v10, s[52:55], s4 offen lds
    s_add_u32 m0, s87, 54272
    s_add_u32 s4, s86, 8960
    buffer_load_dwordx4 v10, s[52:55], s4 offen lds
    s_add_u32 m0, s87, 55296
    s_add_u32 s4, s86, 17152
    buffer_load_dwordx4 v11, s[52:55], s4 offen lds
    s_add_u32 m0, s87, 56320
    s_add_u32 s4, s86, 25344
    buffer_load_dwordx4 v11, s[52:55], s4 offen lds
    s_add_u32 m0, s88, 0
    s_nop 0
    buffer_load_dwordx4 v12, s[56:59], s80 offen lds
    s_add_u32 s80, s80, s82
    s_add_u32 m0, s88, 1024
    s_nop 0
    buffer_load_dwordx4 v13, s[56:59], s80 offen lds
    s_add_u32 s80, s80, s82
    s_add_u32 m0, s88, 2048
    s_nop 0
    buffer_load_dwordx4 v12, s[56:59], s80 offen lds
    s_add_u32 s80, s80, s82
    s_add_u32 m0, s88, 3072
    s_nop 0
    buffer_load_dwordx4 v13, s[56:59], s80 offen lds
    s_add_u32 s80, s80, s81
    s_add_u32 m0, s89, 0
    s_add_u32 s4, s85, 768
    buffer_load_dwordx4 v14, s[60:63], s4 offen lds
    v_mov_b32 v4, 0
    v_mov_b32 v5, 0
    s_mov_b32 s4, 0xffff0000
    v_lshlrev_b32 v6, 16, v40
    v_and_b32 v7, s4, v40
    v_lshlrev_b32 v8, 16, v32
    v_and_b32 v9, s4, v32
    v_mul_f32 v8, v8, v6
    v_mul_f32 v9, v9, v7
    v_cvt_pk_bf16_f32 v8, v8, v9
    v_lshlrev_b32 v9, 16, v8
    v_and_b32 v8, s4, v8
    v_add_f32 v4, v4, v9
    v_add_f32 v4, v4, v8
    v_lshlrev_b32 v8, 16, v36
    v_and_b32 v9, s4, v36
    v_mul_f32 v8, v8, v6
    v_mul_f32 v9, v9, v7
    v_cvt_pk_bf16_f32 v8, v8, v9
    v_lshlrev_b32 v9, 16, v8
    v_and_b32 v8, s4, v8
    v_add_f32 v5, v5, v9
    v_add_f32 v5, v5, v8
    v_lshlrev_b32 v6, 16, v41
    v_and_b32 v7, s4, v41
    v_lshlrev_b32 v8, 16, v33
    v_and_b32 v9, s4, v33
    v_mul_f32 v8, v8, v6
    v_mul_f32 v9, v9, v7
    v_cvt_pk_bf16_f32 v8, v8, v9
    v_lshlrev_b32 v9, 16, v8
    v_and_b32 v8, s4, v8
    v_add_f32 v4, v4, v9
    v_add_f32 v4, v4, v8
    v_lshlrev_b32 v8, 16, v37
    v_and_b32 v9, s4, v37
    v_mul_f32 v8, v8, v6
    v_mul_f32 v9, v9, v7
    v_cvt_pk_bf16_f32 v8, v8, v9
    v_lshlrev_b32 v9, 16, v8
    v_and_b32 v8, s4, v8
    v_add_f32 v5, v5, v9
    v_add_f32 v5, v5, v8
    s_waitcnt vmcnt(9)
    s_barrier
    s_add_u32 m0, s87, 69632
    s_add_u32 s4, s86, 896
    buffer_load_dwordx4 v10, s[52:55], s4 offen lds
    s_add_u32 m0, s87, 70656
    s_add_u32 s4, s86, 9088
    buffer_load_dwordx4 v10, s[52:55], s4 offen lds
    s_add_u32 m0, s87, 71680
    s_add_u32 s4, s86, 17280
    buffer_load_dwordx4 v11, s[52:55], s4 offen lds
    s_add_u32 m0, s87, 72704
    s_add_u32 s4, s86, 25472
    buffer_load_dwordx4 v11, s[52:55], s4 offen lds
    s_add_u32 m0, s88, 8192
    s_nop 0
    buffer_load_dwordx4 v12, s[56:59], s80 offen lds
    s_add_u32 s80, s80, s82
    s_add_u32 m0, s88, 9216
    s_nop 0
    buffer_load_dwordx4 v13, s[56:59], s80 offen lds
    s_add_u32 s80, s80, s82
    s_add_u32 m0, s88, 10240
    s_nop 0
    buffer_load_dwordx4 v12, s[56:59], s80 offen lds
    s_add_u32 s80, s80, s82
    s_add_u32 m0, s88, 11264
    s_nop 0
    buffer_load_dwordx4 v13, s[56:59], s80 offen lds
    s_add_u32 s80, s80, s81
    s_add_u32 m0, s89, 4096
    s_add_u32 s4, s85, 896
    buffer_load_dwordx4 v14, s[60:63], s4 offen lds
    s_mov_b32 s4, 0xffff0000
    v_lshlrev_b32 v6, 16, v42
    v_and_b32 v7, s4, v42
    v_lshlrev_b32 v8, 16, v34
    v_and_b32 v9, s4, v34
    v_mul_f32 v8, v8, v6
    v_mul_f32 v9, v9, v7
    v_cvt_pk_bf16_f32 v8, v8, v9
    v_lshlrev_b32 v9, 16, v8
    v_and_b32 v8, s4, v8
    v_add_f32 v4, v4, v9
    v_add_f32 v4, v4, v8
    v_lshlrev_b32 v8, 16, v38
    v_and_b32 v9, s4, v38
    v_mul_f32 v8, v8, v6
    v_mul_f32 v9, v9, v7
    v_cvt_pk_bf16_f32 v8, v8, v9
    v_lshlrev_b32 v9, 16, v8
    v_and_b32 v8, s4, v8
    v_add_f32 v5, v5, v9
    v_add_f32 v5, v5, v8
    v_lshlrev_b32 v6, 16, v43
    v_and_b32 v7, s4, v43
    v_lshlrev_b32 v8, 16, v35
    v_and_b32 v9, s4, v35
    v_mul_f32 v8, v8, v6
    v_mul_f32 v9, v9, v7
    v_cvt_pk_bf16_f32 v8, v8, v9
    v_lshlrev_b32 v9, 16, v8
    v_and_b32 v8, s4, v8
    v_add_f32 v4, v4, v9
    v_add_f32 v4, v4, v8
    v_lshlrev_b32 v8, 16, v39
    v_and_b32 v9, s4, v39
    v_mul_f32 v8, v8, v6
    v_mul_f32 v9, v9, v7
    v_cvt_pk_bf16_f32 v8, v8, v9
    v_lshlrev_b32 v9, 16, v8
    v_and_b32 v8, s4, v8
    v_add_f32 v5, v5, v9
    v_add_f32 v5, v5, v8
    s_waitcnt vmcnt(9)
    s_barrier
    s_mov_b64 s[56:57], s[90:91]
    s_mov_b32 s58, 1835008
    s_add_u32 s80, s70, 1146880
    s_mov_b32 s81, 143360
    s_movk_i32 s82, 28672
    v_mov_b32 v12, v16
    v_mov_b32 v13, v16
    s_add_u32 m0, s88, 16384
    s_nop 0
    buffer_load_dwordx4 v12, s[56:59], s80 offen lds
    s_add_u32 s80, s80, s82
    s_add_u32 m0, s88, 17408
    s_nop 0
    buffer_load_dwordx4 v13, s[56:59], s80 offen lds
    s_add_u32 s80, s80, s82
    s_add_u32 m0, s88, 18432
    s_nop 0
    buffer_load_dwordx4 v12, s[56:59], s80 offen lds
    s_add_u32 s80, s80, s82
    s_add_u32 m0, s88, 19456
    s_nop 0
    buffer_load_dwordx4 v13, s[56:59], s80 offen lds
    s_add_u32 s80, s80, s81
    s_nop 1
    v_add_f32_dpp v4, v4, v4 row_shr:1 row_mask:0xf bank_mask:0xf bound_ctrl:0
    v_add_f32_dpp v5, v5, v5 row_shr:1 row_mask:0xf bank_mask:0xf bound_ctrl:0
    s_nop 1
    v_add_f32_dpp v4, v4, v4 row_shr:2 row_mask:0xf bank_mask:0xf bound_ctrl:0
    v_add_f32_dpp v5, v5, v5 row_shr:2 row_mask:0xf bank_mask:0xf bound_ctrl:0
    s_nop 1
    v_add_f32_dpp v4, v4, v4 row_shr:4 row_mask:0xf bank_mask:0xf bound_ctrl:0
    v_add_f32_dpp v5, v5, v5 row_shr:4 row_mask:0xf bank_mask:0xf bound_ctrl:0
    s_nop 1
    v_add_f32_dpp v4, v4, v4 row_shr:8 row_mask:0xf bank_mask:0xf bound_ctrl:0
    v_add_f32_dpp v5, v5, v5 row_shr:8 row_mask:0xf bank_mask:0xf bound_ctrl:0
    s_nop 1
    v_readlane_b32 s76, v4, 15
    v_readlane_b32 s77, v4, 31
    v_readlane_b32 s78, v4, 47
    v_readlane_b32 s96, v5, 15
    v_readlane_b32 s97, v5, 31
    v_readlane_b32 s98, v5, 47
    s_nop 1
    v_add_f32 v4, s76, v4
    v_add_f32 v5, s96, v5
    v_add_f32 v4, s77, v4
    v_add_f32 v5, s97, v5
    v_add_f32 v4, s78, v4
    v_add_f32 v5, s98, v5
    s_nop 0
    v_readlane_b32 s4, v4, 63
    v_readlane_b32 s5, v5, 63
    v_cmp_eq_u32 vcc, 1, v0
    s_nop 0
    v_mov_b32 v4, s4
    v_mov_b32 v5, s5
    v_cndmask_b32 v4, v4, v5, vcc
    v_cvt_pk_bf16_f32 v5, v4, v4
    v_lshlrev_b32 v4, 16, v5
    v_mul_f32 v4, 3216550459, v4
    v_exp_f32 v4, v4
    s_nop 0
    v_add_f32 v4, 1.0, v4
    v_rcp_f32 v4, v4
    s_nop 0
    v_cvt_pk_bf16_f32 v5, v4, v4
    v_lshlrev_b32 v4, 16, v5
    s_lshl_b32 s4, s15, 2
    s_add_u32 s4, s4, 11534336
    v_lshlrev_b32 v5, 2, v0
    s_mov_b64 exec, 3
    buffer_store_dword v4, v5, s[64:67], s4 offen sc1
    s_mov_b64 exec, -1
    s_waitcnt vmcnt(5)
    s_barrier
    s_add_u32 m0, s88, 0
    s_nop 0
    buffer_load_dwordx4 v12, s[56:59], s80 offen lds
    s_add_u32 s80, s80, s82
    s_add_u32 m0, s88, 1024
    s_nop 0
    buffer_load_dwordx4 v13, s[56:59], s80 offen lds
    s_add_u32 s80, s80, s82
    s_add_u32 m0, s88, 2048
    s_nop 0
    buffer_load_dwordx4 v12, s[56:59], s80 offen lds
    s_add_u32 s80, s80, s82
    s_add_u32 m0, s88, 3072
    s_nop 0
    buffer_load_dwordx4 v13, s[56:59], s80 offen lds
    s_add_u32 s80, s80, s81
    s_waitcnt vmcnt(5)
    s_barrier
    s_add_u32 m0, s88, 8192
    s_nop 0
    buffer_load_dwordx4 v12, s[56:59], s80 offen lds
    s_add_u32 s80, s80, s82
    s_add_u32 m0, s88, 9216
    s_nop 0
    buffer_load_dwordx4 v13, s[56:59], s80 offen lds
    s_add_u32 s80, s80, s82
    s_add_u32 m0, s88, 10240
    s_nop 0
    buffer_load_dwordx4 v12, s[56:59], s80 offen lds
    s_add_u32 s80, s80, s82
    s_add_u32 m0, s88, 11264
    s_nop 0
    buffer_load_dwordx4 v13, s[56:59], s80 offen lds
    s_add_u32 s80, s80, s81
    s_waitcnt vmcnt(8)
    s_cmp_eq_u32 s3, 2
    s_cbranch_scc1 L_5
    s_and_b32 s4, s3, s12
    s_cmp_eq_u32 s3, 3
    s_cselect_b32 s4, s4, 0
    s_cmp_eq_u32 s4, 1
    s_cbranch_scc1 L_6
    s_waitcnt vmcnt(4)
    s_barrier
    s_sub_u32 s80, s80, 1835008
    s_add_u32 m0, s88, 16384
    s_nop 0
    buffer_load_dwordx4 v12, s[56:59], s80 offen lds
    s_add_u32 s80, s80, s82
    s_add_u32 m0, s88, 17408
    s_nop 0
    buffer_load_dwordx4 v13, s[56:59], s80 offen lds
    s_add_u32 s80, s80, s82
    s_add_u32 m0, s88, 18432
    s_nop 0
    buffer_load_dwordx4 v12, s[56:59], s80 offen lds
    s_add_u32 s80, s80, s82
    s_add_u32 m0, s88, 19456
    s_nop 0
    buffer_load_dwordx4 v13, s[56:59], s80 offen lds
    s_add_u32 s80, s80, s81
    s_waitcnt vmcnt(4)
    s_barrier
    s_add_u32 m0, s88, 0
    s_nop 0
    buffer_load_dwordx4 v12, s[56:59], s80 offen lds
    s_add_u32 s80, s80, s82
    s_add_u32 m0, s88, 1024
    s_nop 0
    buffer_load_dwordx4 v13, s[56:59], s80 offen lds
    s_add_u32 s80, s80, s82
    s_add_u32 m0, s88, 2048
    s_nop 0
    buffer_load_dwordx4 v12, s[56:59], s80 offen lds
    s_add_u32 s80, s80, s82
    s_add_u32 m0, s88, 3072
    s_nop 0
    buffer_load_dwordx4 v13, s[56:59], s80 offen lds
    s_add_u32 s80, s80, s81
    s_waitcnt vmcnt(4)
    s_barrier
    s_add_u32 m0, s88, 8192
    s_nop 0
    buffer_load_dwordx4 v12, s[56:59], s80 offen lds
    s_add_u32 s80, s80, s82
    s_add_u32 m0, s88, 9216
    s_nop 0
    buffer_load_dwordx4 v13, s[56:59], s80 offen lds
    s_add_u32 s80, s80, s82
    s_add_u32 m0, s88, 10240
    s_nop 0
    buffer_load_dwordx4 v12, s[56:59], s80 offen lds
    s_add_u32 s80, s80, s82
    s_add_u32 m0, s88, 11264
    s_nop 0
    buffer_load_dwordx4 v13, s[56:59], s80 offen lds
    s_add_u32 s80, s80, s81
    s_waitcnt vmcnt(4)
    s_barrier
    s_add_u32 m0, s87, 86016
    s_add_u32 s4, s86, 384
    buffer_load_dwordx4 v10, s[52:55], s4 offen lds
    s_add_u32 m0, s87, 87040
    s_add_u32 s4, s86, 8576
    buffer_load_dwordx4 v10, s[52:55], s4 offen lds
    s_add_u32 m0, s87, 88064
    s_add_u32 s4, s86, 16768
    buffer_load_dwordx4 v11, s[52:55], s4 offen lds
    s_add_u32 m0, s87, 89088
    s_add_u32 s4, s86, 24960
    buffer_load_dwordx4 v11, s[52:55], s4 offen lds
    s_add_u32 m0, s88, 16384
    s_nop 0
    buffer_load_dwordx4 v12, s[56:59], s80 offen lds
    s_add_u32 s80, s80, s82
    s_add_u32 m0, s88, 17408
    s_nop 0
    buffer_load_dwordx4 v13, s[56:59], s80 offen lds
    s_add_u32 s80, s80, s82
    s_add_u32 m0, s88, 18432
    s_nop 0
    buffer_load_dwordx4 v12, s[56:59], s80 offen lds
    s_add_u32 s80, s80, s82
    s_add_u32 m0, s88, 19456
    s_nop 0
    buffer_load_dwordx4 v13, s[56:59], s80 offen lds
    s_add_u32 s80, s80, s81
    s_waitcnt vmcnt(8)
    s_barrier
    s_add_u32 m0, s87, 53248
    s_add_u32 s4, s86, 512
    buffer_load_dwordx4 v10, s[52:55], s4 offen lds
    s_add_u32 m0, s87, 54272
    s_add_u32 s4, s86, 8704
    buffer_load_dwordx4 v10, s[52:55], s4 offen lds
    s_add_u32 m0, s87, 55296
    s_add_u32 s4, s86, 16896
    buffer_load_dwordx4 v11, s[52:55], s4 offen lds
    s_add_u32 m0, s87, 56320
    s_add_u32 s4, s86, 25088
    buffer_load_dwordx4 v11, s[52:55], s4 offen lds
    s_add_u32 m0, s88, 0
    s_nop 0
    buffer_load_dwordx4 v12, s[56:59], s80 offen lds
    s_add_u32 s80, s80, s82
    s_add_u32 m0, s88, 1024
    s_nop 0
    buffer_load_dwordx4 v13, s[56:59], s80 offen lds
    s_add_u32 s80, s80, s82
    s_add_u32 m0, s88, 2048
    s_nop 0
    buffer_load_dwordx4 v12, s[56:59], s80 offen lds
    s_add_u32 s80, s80, s82
    s_add_u32 m0, s88, 3072
    s_nop 0
    buffer_load_dwordx4 v13, s[56:59], s80 offen lds
    s_add_u32 s80, s80, s81
    s_and_b32 s4, s2, 7
    s_lshr_b32 s5, s2, 3
    s_lshl_b32 s84, s4, 2
    s_lshr_b32 s4, s5, 3
    s_add_u32 s84, s84, s4
    s_and_b32 s85, s5, 7
    s_mov_b32 s52, s40
    s_mov_b32 s53, s41
    s_mov_b32 s54, 1835008
    s_mov_b32 s55, 0x20000
    s_mov_b32 s56, s26
    s_mov_b32 s57, s27
    s_mov_b32 s58, 524288
    s_mov_b32 s59, 0x20000
    s_mov_b32 s60, s28
    s_mov_b32 s61, s29
    s_mov_b32 s62, 524288
    s_mov_b32 s63, 0x20000
    s_lshl_b32 s4, s3, 14
    s_lshl_b32 s5, s85, 7
    s_add_u32 s89, s4, s5
    s_lshl_b32 s5, s85, 16
    s_add_u32 s90, s4, s5
    s_lshl_b32 s91, s3, 11
    s_add_u32 m0, s91, 4096
    s_add_u32 s4, s89, 0
    buffer_load_dwordx4 v15, s[52:55], s4 offen lds
    s_add_u32 m0, s91, 5120
    s_add_u32 s4, s89, 8192
    buffer_load_dwordx4 v15, s[52:55], s4 offen lds
    s_add_u32 m0, s91, 12288
    s_add_u32 s4, s89, 131072
    buffer_load_dwordx4 v15, s[52:55], s4 offen lds
    s_add_u32 m0, s91, 13312
    s_add_u32 s4, s89, 139264
    buffer_load_dwordx4 v15, s[52:55], s4 offen lds
    s_add_u32 m0, s91, 20480
    s_add_u32 s4, s89, 262144
    buffer_load_dwordx4 v15, s[52:55], s4 offen lds
    s_add_u32 m0, s91, 21504
    s_add_u32 s4, s89, 270336
    buffer_load_dwordx4 v15, s[52:55], s4 offen lds
    s_add_u32 m0, s91, 28672
    s_add_u32 s4, s89, 458752
    buffer_load_dwordx4 v15, s[52:55], s4 offen lds
    s_add_u32 m0, s91, 29696
    s_add_u32 s4, s89, 466944
    buffer_load_dwordx4 v15, s[52:55], s4 offen lds
    s_waitcnt vmcnt(16) lgkmcnt(0)
    s_barrier
    s_add_u32 m0, s91, 36864
    s_add_u32 s4, s89, 589824
    buffer_load_dwordx4 v15, s[52:55], s4 offen lds
    s_add_u32 m0, s91, 37888
    s_add_u32 s4, s89, 598016
    buffer_load_dwordx4 v15, s[52:55], s4 offen lds
    s_add_u32 m0, s91, 45056
    s_add_u32 s4, s89, 720896
    buffer_load_dwordx4 v15, s[52:55], s4 offen lds
    s_add_u32 m0, s91, 46080
    s_add_u32 s4, s89, 729088
    buffer_load_dwordx4 v15, s[52:55], s4 offen lds
    s_add_u32 m0, s91, 110592
    s_add_u32 s4, s89, 917504
    buffer_load_dwordx4 v15, s[52:55], s4 offen lds
    s_add_u32 m0, s91, 111616
    s_add_u32 s4, s89, 925696
    buffer_load_dwordx4 v15, s[52:55], s4 offen lds
    s_add_u32 m0, s91, 135168
    s_add_u32 s4, s89, 1048576
    buffer_load_dwordx4 v15, s[52:55], s4 offen lds
    s_add_u32 m0, s91, 136192
    s_add_u32 s4, s89, 1056768
    buffer_load_dwordx4 v15, s[52:55], s4 offen lds
    s_waitcnt vmcnt(16)
    s_barrier
    s_add_u32 m0, s91, 86016
    s_add_u32 s4, s89, 1179648
    buffer_load_dwordx4 v15, s[52:55], s4 offen lds
    s_add_u32 m0, s91, 87040
    s_add_u32 s4, s89, 1187840
    buffer_load_dwordx4 v15, s[52:55], s4 offen lds
    s_add_u32 m0, s91, 94208
    s_add_u32 s4, s89, 1376256
    buffer_load_dwordx4 v15, s[52:55], s4 offen lds
    s_add_u32 m0, s91, 95232
    s_add_u32 s4, s89, 1384448
    buffer_load_dwordx4 v15, s[52:55], s4 offen lds
    s_add_u32 m0, s91, 118784
    s_add_u32 s4, s89, 1507328
    buffer_load_dwordx4 v15, s[52:55], s4 offen lds
    s_add_u32 m0, s91, 119808
    s_add_u32 s4, s89, 1515520
    buffer_load_dwordx4 v15, s[52:55], s4 offen lds
    s_add_u32 m0, s91, 143360
    s_add_u32 s4, s89, 1638400
    buffer_load_dwordx4 v15, s[52:55], s4 offen lds
    s_add_u32 m0, s91, 144384
    s_add_u32 s4, s89, 1646592
    buffer_load_dwordx4 v15, s[52:55], s4 offen lds
    s_waitcnt vmcnt(20)
    s_barrier
    s_add_u32 m0, s91, 53248
    s_add_u32 s4, s90, 0
    buffer_load_dwordx4 v28, s[56:59], s4 offen lds
    s_add_u32 m0, s91, 54272
    s_add_u32 s4, s90, 8192
    buffer_load_dwordx4 v29, s[56:59], s4 offen lds
    s_add_u32 m0, s91, 61440
    s_add_u32 s4, s90, 0
    buffer_load_dwordx4 v28, s[60:63], s4 offen lds
    s_add_u32 m0, s91, 62464
    s_add_u32 s4, s90, 8192
    buffer_load_dwordx4 v29, s[60:63], s4 offen lds
    s_add_u32 m0, s91, 102400
    s_add_u32 s4, s90, 128
    buffer_load_dwordx4 v28, s[56:59], s4 offen lds
    s_add_u32 m0, s91, 103424
    s_add_u32 s4, s90, 8320
    buffer_load_dwordx4 v29, s[56:59], s4 offen lds
    s_add_u32 m0, s91, 126976
    s_add_u32 s4, s90, 128
    buffer_load_dwordx4 v28, s[60:63], s4 offen lds
    s_add_u32 m0, s91, 128000
    s_add_u32 s4, s90, 8320
    buffer_load_dwordx4 v29, s[60:63], s4 offen lds
    s_waitcnt vmcnt(24)
    s_barrier
    s_add_u32 m0, s91, 69632
    s_add_u32 s4, s90, 256
    buffer_load_dwordx4 v28, s[56:59], s4 offen lds
    s_add_u32 m0, s91, 70656
    s_add_u32 s4, s90, 8448
    buffer_load_dwordx4 v29, s[56:59], s4 offen lds
    s_add_u32 m0, s91, 77824
    s_add_u32 s4, s90, 256
    buffer_load_dwordx4 v28, s[60:63], s4 offen lds
    s_add_u32 m0, s91, 78848
    s_add_u32 s4, s90, 8448
    buffer_load_dwordx4 v29, s[60:63], s4 offen lds
    s_waitcnt vmcnt(24)
    s_barrier
    s_add_u32 m0, s91, 4096
    s_add_u32 s4, s90, 384
    buffer_load_dwordx4 v28, s[56:59], s4 offen lds
    s_add_u32 m0, s91, 5120
    s_add_u32 s4, s90, 8576
    buffer_load_dwordx4 v29, s[56:59], s4 offen lds
    s_add_u32 m0, s91, 12288
    s_add_u32 s4, s90, 384
    buffer_load_dwordx4 v28, s[60:63], s4 offen lds
    s_add_u32 m0, s91, 13312
    s_add_u32 s4, s90, 8576
    buffer_load_dwordx4 v29, s[60:63], s4 offen lds
    s_waitcnt vmcnt(24)
    s_barrier
    s_add_u32 m0, s91, 20480
    s_add_u32 s4, s90, 512
    buffer_load_dwordx4 v28, s[56:59], s4 offen lds
    s_add_u32 m0, s91, 21504
    s_add_u32 s4, s90, 8704
    buffer_load_dwordx4 v29, s[56:59], s4 offen lds
    s_add_u32 m0, s91, 28672
    s_add_u32 s4, s90, 512
    buffer_load_dwordx4 v28, s[60:63], s4 offen lds
    s_add_u32 m0, s91, 29696
    s_add_u32 s4, s90, 8704
    buffer_load_dwordx4 v29, s[60:63], s4 offen lds
    s_waitcnt vmcnt(24)
    s_barrier
    s_add_u32 m0, s91, 36864
    s_add_u32 s4, s90, 640
    buffer_load_dwordx4 v28, s[56:59], s4 offen lds
    s_add_u32 m0, s91, 37888
    s_add_u32 s4, s90, 8832
    buffer_load_dwordx4 v29, s[56:59], s4 offen lds
    s_add_u32 m0, s91, 45056
    s_add_u32 s4, s90, 640
    buffer_load_dwordx4 v28, s[60:63], s4 offen lds
    s_add_u32 m0, s91, 46080
    s_add_u32 s4, s90, 8832
    buffer_load_dwordx4 v29, s[60:63], s4 offen lds
    s_waitcnt vmcnt(24)
    s_barrier
    s_add_u32 m0, s91, 110592
    s_add_u32 s4, s90, 768
    buffer_load_dwordx4 v28, s[56:59], s4 offen lds
    s_add_u32 m0, s91, 111616
    s_add_u32 s4, s90, 8960
    buffer_load_dwordx4 v29, s[56:59], s4 offen lds
    s_add_u32 m0, s91, 135168
    s_add_u32 s4, s90, 768
    buffer_load_dwordx4 v28, s[60:63], s4 offen lds
    s_add_u32 m0, s91, 136192
    s_add_u32 s4, s90, 8960
    buffer_load_dwordx4 v29, s[60:63], s4 offen lds
    s_waitcnt vmcnt(24)
    s_barrier
    s_add_u32 m0, s91, 86016
    s_add_u32 s4, s90, 896
    buffer_load_dwordx4 v28, s[56:59], s4 offen lds
    s_add_u32 m0, s91, 87040
    s_add_u32 s4, s90, 9088
    buffer_load_dwordx4 v29, s[56:59], s4 offen lds
    s_add_u32 m0, s91, 94208
    s_add_u32 s4, s90, 896
    buffer_load_dwordx4 v28, s[60:63], s4 offen lds
    s_add_u32 m0, s91, 95232
    s_add_u32 s4, s90, 9088
    buffer_load_dwordx4 v29, s[60:63], s4 offen lds
    s_waitcnt vmcnt(24)
    s_barrier
    s_add_u32 m0, s91, 118784
    s_add_u32 s4, s89, 65536
    buffer_load_dwordx4 v15, s[52:55], s4 offen lds
    s_add_u32 m0, s91, 119808
    s_add_u32 s4, s89, 73728
    buffer_load_dwordx4 v15, s[52:55], s4 offen lds
    s_add_u32 m0, s91, 143360
    s_add_u32 s4, s89, 196608
    buffer_load_dwordx4 v15, s[52:55], s4 offen lds
    s_add_u32 m0, s91, 144384
    s_add_u32 s4, s89, 204800
    buffer_load_dwordx4 v15, s[52:55], s4 offen lds
    s_waitcnt vmcnt(24)
    s_barrier
    s_add_u32 m0, s91, 53248
    s_add_u32 s4, s89, 327680
    buffer_load_dwordx4 v15, s[52:55], s4 offen lds
    s_add_u32 m0, s91, 54272
    s_add_u32 s4, s89, 335872
    buffer_load_dwordx4 v15, s[52:55], s4 offen lds
    s_add_u32 m0, s91, 61440
    s_add_u32 s4, s89, 393216
    buffer_load_dwordx4 v15, s[52:55], s4 offen lds
    s_add_u32 m0, s91, 62464
    s_add_u32 s4, s89, 401408
    buffer_load_dwordx4 v15, s[52:55], s4 offen lds
    s_waitcnt vmcnt(24)
    s_barrier
    s_add_u32 m0, s91, 102400
    s_add_u32 s4, s89, 524288
    buffer_load_dwordx4 v15, s[52:55], s4 offen lds
    s_add_u32 m0, s91, 103424
    s_add_u32 s4, s89, 532480
    buffer_load_dwordx4 v15, s[52:55], s4 offen lds
    s_add_u32 m0, s91, 126976
    s_add_u32 s4, s89, 655360
    buffer_load_dwordx4 v15, s[52:55], s4 offen lds
    s_add_u32 m0, s91, 128000
    s_add_u32 s4, s89, 663552
    buffer_load_dwordx4 v15, s[52:55], s4 offen lds
    s_waitcnt vmcnt(24)
    s_barrier
    s_add_u32 m0, s91, 69632
    s_add_u32 s4, s89, 786432
    buffer_load_dwordx4 v15, s[52:55], s4 offen lds
    s_add_u32 m0, s91, 70656
    s_add_u32 s4, s89, 794624
    buffer_load_dwordx4 v15, s[52:55], s4 offen lds
    s_add_u32 m0, s91, 77824
    s_add_u32 s4, s89, 851968
    buffer_load_dwordx4 v15, s[52:55], s4 offen lds
    s_add_u32 m0, s91, 78848
    s_add_u32 s4, s89, 860160
    buffer_load_dwordx4 v15, s[52:55], s4 offen lds
    s_waitcnt vmcnt(24)
    s_barrier
    s_add_u32 m0, s91, 4096
    s_add_u32 s4, s89, 983040
    buffer_load_dwordx4 v15, s[52:55], s4 offen lds
    s_add_u32 m0, s91, 5120
    s_add_u32 s4, s89, 991232
    buffer_load_dwordx4 v15, s[52:55], s4 offen lds
    s_add_u32 m0, s91, 12288
    s_add_u32 s4, s89, 1114112
    buffer_load_dwordx4 v15, s[52:55], s4 offen lds
    s_add_u32 m0, s91, 13312
    s_add_u32 s4, s89, 1122304
    buffer_load_dwordx4 v15, s[52:55], s4 offen lds
    s_waitcnt vmcnt(24)
    s_barrier
    s_add_u32 m0, s91, 20480
    s_add_u32 s4, s89, 1245184
    buffer_load_dwordx4 v15, s[52:55], s4 offen lds
    s_add_u32 m0, s91, 21504
    s_add_u32 s4, s89, 1253376
    buffer_load_dwordx4 v15, s[52:55], s4 offen lds
    s_add_u32 m0, s91, 28672
    s_add_u32 s4, s89, 1310720
    buffer_load_dwordx4 v15, s[52:55], s4 offen lds
    s_add_u32 m0, s91, 29696
    s_add_u32 s4, s89, 1318912
    buffer_load_dwordx4 v15, s[52:55], s4 offen lds
    s_waitcnt vmcnt(24)
    s_barrier
    s_add_u32 m0, s91, 36864
    s_add_u32 s4, s89, 1441792
    buffer_load_dwordx4 v15, s[52:55], s4 offen lds
    s_add_u32 m0, s91, 37888
    s_add_u32 s4, s89, 1449984
    buffer_load_dwordx4 v15, s[52:55], s4 offen lds
    s_add_u32 m0, s91, 45056
    s_add_u32 s4, s89, 1572864
    buffer_load_dwordx4 v15, s[52:55], s4 offen lds
    s_add_u32 m0, s91, 46080
    s_add_u32 s4, s89, 1581056
    buffer_load_dwordx4 v15, s[52:55], s4 offen lds
    s_waitcnt vmcnt(24)
    s_barrier
    s_add_u32 m0, s91, 110592
    s_add_u32 s4, s89, 1703936
    buffer_load_dwordx4 v15, s[52:55], s4 offen lds
    s_add_u32 m0, s91, 111616
    s_add_u32 s4, s89, 1712128
    buffer_load_dwordx4 v15, s[52:55], s4 offen lds
    s_add_u32 m0, s91, 135168
    s_add_u32 s4, s89, 1769472
    buffer_load_dwordx4 v15, s[52:55], s4 offen lds
    s_add_u32 m0, s91, 136192
    s_add_u32 s4, s89, 1777664
    buffer_load_dwordx4 v15, s[52:55], s4 offen lds
    s_waitcnt vmcnt(24)
    s_barrier
    s_waitcnt vmcnt(20)
    s_barrier
    s_waitcnt vmcnt(16)
    s_barrier
    s_waitcnt vmcnt(12)
    s_barrier
    s_waitcnt vmcnt(8)
    s_barrier
    s_waitcnt vmcnt(4)
    s_barrier
    s_waitcnt vmcnt(0)
    s_barrier
    s_barrier
    s_endpgm
L_5:
    s_add_u32 s96, s48, 11599872
    s_addc_u32 s97, s49, 0
    s_mov_b32 s98, 131072
    s_mov_b32 s99, 0x20000
    v_lshlrev_b32 v1, 4, v0
    v_mov_b32 v4, 0
    ds_read_b64 v[2:3], v1 offset:0
    ds_read_b32 v5, v4 offset:2048
    s_waitcnt lgkmcnt(0)
    v_readfirstlane_b32 s72, v5
    v_mul_f32 v8, v3, v3
    v_mul_f32 v9, v2, v3
    v_fma_f32 v2, v2, v2, -v8
    v_add_f32 v3, v9, v9
    v_mul_f32 v8, v3, v3
    v_mul_f32 v9, v2, v3
    v_fma_f32 v2, v2, v2, -v8
    v_add_f32 v3, v9, v9
    v_mul_f32 v8, v3, v3
    v_mul_f32 v9, v2, v3
    v_fma_f32 v2, v2, v2, -v8
    v_add_f32 v3, v9, v9
    v_mov_b32 v162, v2
    v_mov_b32 v163, v3
    v_mul_f32 v8, v3, v3
    v_mul_f32 v9, v2, v3
    v_fma_f32 v2, v2, v2, -v8
    v_add_f32 v3, v9, v9
    v_mul_f32 v8, v3, v3
    v_mul_f32 v9, v2, v3
    v_fma_f32 v2, v2, v2, -v8
    v_add_f32 v3, v9, v9
    v_mul_f32 v8, v3, v3
    v_mul_f32 v9, v2, v3
    v_fma_f32 v2, v2, v2, -v8
    v_add_f32 v3, v9, v9
    v_mul_f32 v8, v3, v3
    v_mul_f32 v9, v2, v3
    v_fma_f32 v2, v2, v2, -v8
    v_add_f32 v3, v9, v9
    s_lshl_b32 s4, s10, 4
    s_lshl_b32 s5, s6, 13
    s_add_u32 s4, s4, s5
    v_add_u32 v17, s4, v1
    v_lshlrev_b32 v1, 2, v0
    v_add_u32 v1, 151552, v1
    v_mov_b32 v125, v5
    v_mov_b32 v127, v5
    s_cmp_ge_u32 s6, 1
    s_cselect_b32 s4, s72, 0
    v_mov_b32 v193, s4
    s_cmp_ge_u32 s6, 2
    s_cselect_b32 s4, s72, 0
    v_mov_b32 v194, s4
    s_cmp_ge_u32 s6, 3
    s_cselect_b32 s4, s72, 0
    v_mov_b32 v195, s4
    s_cmp_ge_u32 s6, 4
    s_cselect_b32 s4, s72, 0
    v_mov_b32 v196, s4
    s_cmp_ge_u32 s6, 5
    s_cselect_b32 s4, s72, 0
    v_mov_b32 v197, s4
    s_cmp_ge_u32 s6, 6
    s_cselect_b32 s4, s72, 0
    v_mov_b32 v198, s4
    s_cmp_ge_u32 s6, 7
    s_cselect_b32 s4, s72, 0
    v_mov_b32 v199, s4
    s_cmp_ge_u32 s6, 8
    s_cselect_b32 s4, s72, 0
    v_mov_b32 v200, s4
    s_cmp_ge_u32 s6, 9
    s_cselect_b32 s4, s72, 0
    v_mov_b32 v201, s4
    s_cmp_ge_u32 s6, 10
    s_cselect_b32 s4, s72, 0
    v_mov_b32 v202, s4
    s_cmp_ge_u32 s6, 11
    s_cselect_b32 s4, s72, 0
    v_mov_b32 v203, s4
    s_cmp_ge_u32 s6, 12
    s_cselect_b32 s4, s72, 0
    v_mov_b32 v204, s4
    s_cmp_ge_u32 s6, 13
    s_cselect_b32 s4, s72, 0
    v_mov_b32 v205, s4
    s_cmp_ge_u32 s6, 14
    s_cselect_b32 s4, s72, 0
    v_mov_b32 v206, s4
    s_cmp_ge_u32 s6, 15
    s_cselect_b32 s4, s72, 0
    v_mov_b32 v207, s4
    s_waitcnt vmcnt(4)
    s_barrier
    s_sub_u32 s80, s80, 1835008
    s_add_u32 m0, s88, 16384
    s_nop 0
    buffer_load_dwordx4 v12, s[56:59], s80 offen lds
    s_add_u32 s80, s80, s82
    s_add_u32 m0, s88, 17408
    s_nop 0
    buffer_load_dwordx4 v13, s[56:59], s80 offen lds
    s_add_u32 s80, s80, s82
    s_add_u32 m0, s88, 18432
    s_nop 0
    buffer_load_dwordx4 v12, s[56:59], s80 offen lds
    s_add_u32 s80, s80, s82
    s_add_u32 m0, s88, 19456
    s_nop 0
    buffer_load_dwordx4 v13, s[56:59], s80 offen lds
    s_add_u32 s80, s80, s81
    s_mov_b64 exec, 65535
    ds_read_b32 v32, v1 offset:0
    ds_read_b32 v48, v1 offset:1024
    ds_read_b32 v33, v1 offset:64
    ds_read_b32 v49, v1 offset:1088
    ds_read_b32 v34, v1 offset:128
    ds_read_b32 v50, v1 offset:1152
    ds_read_b32 v35, v1 offset:192
    ds_read_b32 v51, v1 offset:1216
    ds_read_b32 v36, v1 offset:256
    ds_read_b32 v52, v1 offset:1280
    ds_read_b32 v37, v1 offset:320
    ds_read_b32 v53, v1 offset:1344
    ds_read_b32 v38, v1 offset:384
    ds_read_b32 v54, v1 offset:1408
    ds_read_b32 v39, v1 offset:448
    ds_read_b32 v55, v1 offset:1472
    ds_read_b32 v40, v1 offset:512
    ds_read_b32 v56, v1 offset:1536
    ds_read_b32 v41, v1 offset:576
    ds_read_b32 v57, v1 offset:1600
    ds_read_b32 v42, v1 offset:640
    ds_read_b32 v58, v1 offset:1664
    ds_read_b32 v43, v1 offset:704
    ds_read_b32 v59, v1 offset:1728
    ds_read_b32 v44, v1 offset:768
    ds_read_b32 v60, v1 offset:1792
    ds_read_b32 v45, v1 offset:832
    ds_read_b32 v61, v1 offset:1856
    ds_read_b32 v46, v1 offset:896
    ds_read_b32 v62, v1 offset:1920
    ds_read_b32 v47, v1 offset:960
    ds_read_b32 v63, v1 offset:1984
    s_waitcnt lgkmcnt(0)
    v_fma_f32 v33, v32, v162, v33
    v_fma_f32 v49, v48, v162, v49
    v_fma_f32 v33, -v48, v163, v33
    v_fma_f32 v49, v32, v163, v49
    v_fma_f32 v34, v33, v162, v34
    v_fma_f32 v50, v49, v162, v50
    v_fma_f32 v34, -v49, v163, v34
    v_fma_f32 v50, v33, v163, v50
    v_fma_f32 v35, v34, v162, v35
    v_fma_f32 v51, v50, v162, v51
    v_fma_f32 v35, -v50, v163, v35
    v_fma_f32 v51, v34, v163, v51
    v_fma_f32 v36, v35, v162, v36
    v_fma_f32 v52, v51, v162, v52
    v_fma_f32 v36, -v51, v163, v36
    v_fma_f32 v52, v35, v163, v52
    v_fma_f32 v37, v36, v162, v37
    v_fma_f32 v53, v52, v162, v53
    v_fma_f32 v37, -v52, v163, v37
    v_fma_f32 v53, v36, v163, v53
    v_fma_f32 v38, v37, v162, v38
    v_fma_f32 v54, v53, v162, v54
    v_fma_f32 v38, -v53, v163, v38
    v_fma_f32 v54, v37, v163, v54
    v_fma_f32 v39, v38, v162, v39
    v_fma_f32 v55, v54, v162, v55
    v_fma_f32 v39, -v54, v163, v39
    v_fma_f32 v55, v38, v163, v55
    v_fma_f32 v40, v39, v162, v40
    v_fma_f32 v56, v55, v162, v56
    v_fma_f32 v40, -v55, v163, v40
    v_fma_f32 v56, v39, v163, v56
    v_fma_f32 v41, v40, v162, v41
    v_fma_f32 v57, v56, v162, v57
    v_fma_f32 v41, -v56, v163, v41
    v_fma_f32 v57, v40, v163, v57
    v_fma_f32 v42, v41, v162, v42
    v_fma_f32 v58, v57, v162, v58
    v_fma_f32 v42, -v57, v163, v42
    v_fma_f32 v58, v41, v163, v58
    v_fma_f32 v43, v42, v162, v43
    v_fma_f32 v59, v58, v162, v59
    v_fma_f32 v43, -v58, v163, v43
    v_fma_f32 v59, v42, v163, v59
    v_fma_f32 v44, v43, v162, v44
    v_fma_f32 v60, v59, v162, v60
    v_fma_f32 v44, -v59, v163, v44
    v_fma_f32 v60, v43, v163, v60
    v_fma_f32 v45, v44, v162, v45
    v_fma_f32 v61, v60, v162, v61
    v_fma_f32 v45, -v60, v163, v45
    v_fma_f32 v61, v44, v163, v61
    v_fma_f32 v46, v45, v162, v46
    v_fma_f32 v62, v61, v162, v62
    v_fma_f32 v46, -v61, v163, v46
    v_fma_f32 v62, v45, v163, v62
    v_fma_f32 v124, v46, v162, v47
    v_fma_f32 v126, v62, v162, v63
    v_fma_f32 v124, -v62, v163, v124
    v_fma_f32 v126, v46, v163, v126
    buffer_store_dwordx4 v[124:127], v17, s[96:99], 0 offen sc1
    s_mov_b64 exec, -1
    s_waitcnt vmcnt(5)
    s_barrier
    s_add_u32 m0, s88, 0
    s_nop 0
    buffer_load_dwordx4 v12, s[56:59], s80 offen lds
    s_add_u32 s80, s80, s82
    s_add_u32 m0, s88, 1024
    s_nop 0
    buffer_load_dwordx4 v13, s[56:59], s80 offen lds
    s_add_u32 s80, s80, s82
    s_add_u32 m0, s88, 2048
    s_nop 0
    buffer_load_dwordx4 v12, s[56:59], s80 offen lds
    s_add_u32 s80, s80, s82
    s_add_u32 m0, s88, 3072
    s_nop 0
    buffer_load_dwordx4 v13, s[56:59], s80 offen lds
    s_add_u32 s80, s80, s81
    v_mov_b32 v132, v2
    v_mov_b32 v133, v3
    s_cmp_ge_u32 s6, 2
    s_cselect_b64 vcc, -1, 0
    v_cndmask_b32 v132, 0, v132, vcc
    v_cndmask_b32 v133, 0, v133, vcc
    v_mul_f32 v134, v132, v2
    v_mul_f32 v135, v132, v3
    v_fma_f32 v134, -v133, v3, v134
    v_fma_f32 v135, v133, v2, v135
    s_cmp_ge_u32 s6, 3
    s_cselect_b64 vcc, -1, 0
    v_cndmask_b32 v134, 0, v134, vcc
    v_cndmask_b32 v135, 0, v135, vcc
    v_mul_f32 v136, v134, v2
    v_mul_f32 v137, v134, v3
    v_fma_f32 v136, -v135, v3, v136
    v_fma_f32 v137, v135, v2, v137
    s_cmp_ge_u32 s6, 4
    s_cselect_b64 vcc, -1, 0
    v_cndmask_b32 v136, 0, v136, vcc
    v_cndmask_b32 v137, 0, v137, vcc
    v_mul_f32 v138, v136, v2
    v_mul_f32 v139, v136, v3
    v_fma_f32 v138, -v137, v3, v138
    v_fma_f32 v139, v137, v2, v139
    s_cmp_ge_u32 s6, 5
    s_cselect_b64 vcc, -1, 0
    v_cndmask_b32 v138, 0, v138, vcc
    v_cndmask_b32 v139, 0, v139, vcc
    v_mul_f32 v140, v138, v2
    v_mul_f32 v141, v138, v3
    v_fma_f32 v140, -v139, v3, v140
    v_fma_f32 v141, v139, v2, v141
    s_cmp_ge_u32 s6, 6
    s_cselect_b64 vcc, -1, 0
    v_cndmask_b32 v140, 0, v140, vcc
    v_cndmask_b32 v141, 0, v141, vcc
    v_mul_f32 v142, v140, v2
    v_mul_f32 v143, v140, v3
    v_fma_f32 v142, -v141, v3, v142
    v_fma_f32 v143, v141, v2, v143
    s_cmp_ge_u32 s6, 7
    s_cselect_b64 vcc, -1, 0
    v_cndmask_b32 v142, 0, v142, vcc
    v_cndmask_b32 v143, 0, v143, vcc
    v_mul_f32 v144, v142, v2
    v_mul_f32 v145, v142, v3
    v_fma_f32 v144, -v143, v3, v144
    v_fma_f32 v145, v143, v2, v145
    s_cmp_ge_u32 s6, 8
    s_cselect_b64 vcc, -1, 0
    v_cndmask_b32 v144, 0, v144, vcc
    v_cndmask_b32 v145, 0, v145, vcc
    v_mul_f32 v146, v144, v2
    v_mul_f32 v147, v144, v3
    v_fma_f32 v146, -v145, v3, v146
    v_fma_f32 v147, v145, v2, v147
    s_cmp_ge_u32 s6, 9
    s_cselect_b64 vcc, -1, 0
    v_cndmask_b32 v146, 0, v146, vcc
    v_cndmask_b32 v147, 0, v147, vcc
    v_mul_f32 v148, v146, v2
    v_mul_f32 v149, v146, v3
    v_fma_f32 v148, -v147, v3, v148
    v_fma_f32 v149, v147, v2, v149
    s_cmp_ge_u32 s6, 10
    s_cselect_b64 vcc, -1, 0
    v_cndmask_b32 v148, 0, v148, vcc
    v_cndmask_b32 v149, 0, v149, vcc
    v_mul_f32 v150, v148, v2
    v_mul_f32 v151, v148, v3
    v_fma_f32 v150, -v149, v3, v150
    v_fma_f32 v151, v149, v2, v151
    s_cmp_ge_u32 s6, 11
    s_cselect_b64 vcc, -1, 0
    v_cndmask_b32 v150, 0, v150, vcc
    v_cndmask_b32 v151, 0, v151, vcc
    v_mul_f32 v152, v150, v2
    v_mul_f32 v153, v150, v3
    v_fma_f32 v152, -v151, v3, v152
    v_fma_f32 v153, v151, v2, v153
    s_cmp_ge_u32 s6, 12
    s_cselect_b64 vcc, -1, 0
    v_cndmask_b32 v152, 0, v152, vcc
    v_cndmask_b32 v153, 0, v153, vcc
    v_mul_f32 v154, v152, v2
    v_mul_f32 v155, v152, v3
    v_fma_f32 v154, -v153, v3, v154
    v_fma_f32 v155, v153, v2, v155
    s_cmp_ge_u32 s6, 13
    s_cselect_b64 vcc, -1, 0
    v_cndmask_b32 v154, 0, v154, vcc
    v_cndmask_b32 v155, 0, v155, vcc
    v_mul_f32 v156, v154, v2
    v_mul_f32 v157, v154, v3
    v_fma_f32 v156, -v155, v3, v156
    v_fma_f32 v157, v155, v2, v157
    s_cmp_ge_u32 s6, 14
    s_cselect_b64 vcc, -1, 0
    v_cndmask_b32 v156, 0, v156, vcc
    v_cndmask_b32 v157, 0, v157, vcc
    v_mul_f32 v158, v156, v2
    v_mul_f32 v159, v156, v3
    v_fma_f32 v158, -v157, v3, v158
    v_fma_f32 v159, v157, v2, v159
    s_cmp_ge_u32 s6, 15
    s_cselect_b64 vcc, -1, 0
    v_cndmask_b32 v158, 0, v158, vcc
    v_cndmask_b32 v159, 0, v159, vcc
    s_waitcnt vmcnt(5)
    s_barrier
    s_add_u32 m0, s88, 8192
    s_nop 0
    buffer_load_dwordx4 v12, s[56:59], s80 offen lds
    s_add_u32 s80, s80, s82
    s_add_u32 m0, s88, 9216
    s_nop 0
    buffer_load_dwordx4 v13, s[56:59], s80 offen lds
    s_add_u32 s80, s80, s82
    s_add_u32 m0, s88, 10240
    s_nop 0
    buffer_load_dwordx4 v12, s[56:59], s80 offen lds
    s_add_u32 s80, s80, s82
    s_add_u32 m0, s88, 11264
    s_nop 0
    buffer_load_dwordx4 v13, s[56:59], s80 offen lds
    s_add_u32 s80, s80, s81
    v_mul_f32 v164, v162, v162
    v_mul_f32 v165, v162, v163
    v_fma_f32 v164, -v163, v163, v164
    v_fma_f32 v165, v163, v162, v165
    v_mul_f32 v166, v164, v162
    v_mul_f32 v167, v164, v163
    v_fma_f32 v166, -v165, v163, v166
    v_fma_f32 v167, v165, v162, v167
    v_mul_f32 v168, v166, v162
    v_mul_f32 v169, v166, v163
    v_fma_f32 v168, -v167, v163, v168
    v_fma_f32 v169, v167, v162, v169
    v_mul_f32 v170, v168, v162
    v_mul_f32 v171, v168, v163
    v_fma_f32 v170, -v169, v163, v170
    v_fma_f32 v171, v169, v162, v171
    v_mul_f32 v172, v170, v162
    v_mul_f32 v173, v170, v163
    v_fma_f32 v172, -v171, v163, v172
    v_fma_f32 v173, v171, v162, v173
    v_mul_f32 v174, v172, v162
    v_mul_f32 v175, v172, v163
    v_fma_f32 v174, -v173, v163, v174
    v_fma_f32 v175, v173, v162, v175
    v_mul_f32 v176, v174, v162
    v_mul_f32 v177, v174, v163
    v_fma_f32 v176, -v175, v163, v176
    v_fma_f32 v177, v175, v162, v177
    v_mul_f32 v178, v176, v162
    v_mul_f32 v179, v176, v163
    v_fma_f32 v178, -v177, v163, v178
    v_fma_f32 v179, v177, v162, v179
    v_mul_f32 v180, v178, v162
    v_mul_f32 v181, v178, v163
    v_fma_f32 v180, -v179, v163, v180
    v_fma_f32 v181, v179, v162, v181
    v_mul_f32 v182, v180, v162
    v_mul_f32 v183, v180, v163
    v_fma_f32 v182, -v181, v163, v182
    v_fma_f32 v183, v181, v162, v183
    v_mul_f32 v184, v182, v162
    v_mul_f32 v185, v182, v163
    v_fma_f32 v184, -v183, v163, v184
    v_fma_f32 v185, v183, v162, v185
    v_mul_f32 v186, v184, v162
    v_mul_f32 v187, v184, v163
    v_fma_f32 v186, -v185, v163, v186
    v_fma_f32 v187, v185, v162, v187
    v_mul_f32 v188, v186, v162
    v_mul_f32 v189, v186, v163
    v_fma_f32 v188, -v187, v163, v188
    v_fma_f32 v189, v187, v162, v189
    v_mul_f32 v190, v188, v162
    v_mul_f32 v191, v188, v163
    v_fma_f32 v190, -v189, v163, v190
    v_fma_f32 v191, v189, v162, v191
    s_waitcnt vmcnt(4)
    s_barrier
    s_mov_b64 exec, 65535
    v_subrev_u32 v25, 8192, v17
    buffer_load_dwordx4 v[64:67], v25, s[96:99], 0 offen sc1
    v_subrev_u32 v26, 16384, v17
    buffer_load_dwordx4 v[68:71], v26, s[96:99], 0 offen sc1
    v_subrev_u32 v27, 24576, v17
    buffer_load_dwordx4 v[72:75], v27, s[96:99], 0 offen sc1
    v_subrev_u32 v24, 32768, v17
    buffer_load_dwordx4 v[76:79], v24, s[96:99], 0 offen sc1
    v_subrev_u32 v25, 40960, v17
    buffer_load_dwordx4 v[80:83], v25, s[96:99], 0 offen sc1
    v_subrev_u32 v26, 49152, v17
    buffer_load_dwordx4 v[84:87], v26, s[96:99], 0 offen sc1
    v_subrev_u32 v27, 57344, v17
    buffer_load_dwordx4 v[88:91], v27, s[96:99], 0 offen sc1
    v_subrev_u32 v24, 65536, v17
    buffer_load_dwordx4 v[92:95], v24, s[96:99], 0 offen sc1
    v_subrev_u32 v25, 73728, v17
    buffer_load_dwordx4 v[96:99], v25, s[96:99], 0 offen sc1
    v_subrev_u32 v26, 81920, v17
    buffer_load_dwordx4 v[100:103], v26, s[96:99], 0 offen sc1
    v_subrev_u32 v27, 90112, v17
    buffer_load_dwordx4 v[104:107], v27, s[96:99], 0 offen sc1
    v_subrev_u32 v24, 98304, v17
    buffer_load_dwordx4 v[108:111], v24, s[96:99], 0 offen sc1
    v_subrev_u32 v25, 106496, v17
    buffer_load_dwordx4 v[112:115], v25, s[96:99], 0 offen sc1
    v_subrev_u32 v26, 114688, v17
    buffer_load_dwordx4 v[116:119], v26, s[96:99], 0 offen sc1
    v_subrev_u32 v27, 122880, v17
    buffer_load_dwordx4 v[120:123], v27, s[96:99], 0 offen sc1
    s_mov_b64 exec, -1
    s_add_u32 m0, s87, 86016
    s_add_u32 s4, s86, 384
    buffer_load_dwordx4 v10, s[52:55], s4 offen lds
    s_add_u32 m0, s87, 87040
    s_add_u32 s4, s86, 8576
    buffer_load_dwordx4 v10, s[52:55], s4 offen lds
    s_add_u32 m0, s87, 88064
    s_add_u32 s4, s86, 16768
    buffer_load_dwordx4 v11, s[52:55], s4 offen lds
    s_add_u32 m0, s87, 89088
    s_add_u32 s4, s86, 24960
    buffer_load_dwordx4 v11, s[52:55], s4 offen lds
    s_add_u32 m0, s88, 16384
    s_nop 0
    buffer_load_dwordx4 v12, s[56:59], s80 offen lds
    s_add_u32 s80, s80, s82
    s_add_u32 m0, s88, 17408
    s_nop 0
    buffer_load_dwordx4 v13, s[56:59], s80 offen lds
    s_add_u32 s80, s80, s82
    s_add_u32 m0, s88, 18432
    s_nop 0
    buffer_load_dwordx4 v12, s[56:59], s80 offen lds
    s_add_u32 s80, s80, s82
    s_add_u32 m0, s88, 19456
    s_nop 0
    buffer_load_dwordx4 v13, s[56:59], s80 offen lds
    s_add_u32 s80, s80, s81
    s_waitcnt vmcnt(23)
    s_barrier
    s_mov_b64 exec, 65535
    s_mov_b32 s83, 0x8000
    s_waitcnt vmcnt(8)
    s_branch L_10
L_8:
    v_subrev_u32 v25, 8192, v17
    buffer_load_dwordx4 v[64:67], v25, s[96:99], 0 offen sc1
    v_subrev_u32 v26, 16384, v17
    buffer_load_dwordx4 v[68:71], v26, s[96:99], 0 offen sc1
    v_subrev_u32 v27, 24576, v17
    buffer_load_dwordx4 v[72:75], v27, s[96:99], 0 offen sc1
    v_subrev_u32 v24, 32768, v17
    buffer_load_dwordx4 v[76:79], v24, s[96:99], 0 offen sc1
    v_subrev_u32 v25, 40960, v17
    buffer_load_dwordx4 v[80:83], v25, s[96:99], 0 offen sc1
    v_subrev_u32 v26, 49152, v17
    buffer_load_dwordx4 v[84:87], v26, s[96:99], 0 offen sc1
    v_subrev_u32 v27, 57344, v17
    buffer_load_dwordx4 v[88:91], v27, s[96:99], 0 offen sc1
    v_subrev_u32 v24, 65536, v17
    buffer_load_dwordx4 v[92:95], v24, s[96:99], 0 offen sc1
    v_subrev_u32 v25, 73728, v17
    buffer_load_dwordx4 v[96:99], v25, s[96:99], 0 offen sc1
    v_subrev_u32 v26, 81920, v17
    buffer_load_dwordx4 v[100:103], v26, s[96:99], 0 offen sc1
    v_subrev_u32 v27, 90112, v17
    buffer_load_dwordx4 v[104:107], v27, s[96:99], 0 offen sc1
    v_subrev_u32 v24, 98304, v17
    buffer_load_dwordx4 v[108:111], v24, s[96:99], 0 offen sc1
    v_subrev_u32 v25, 106496, v17
    buffer_load_dwordx4 v[112:115], v25, s[96:99], 0 offen sc1
    v_subrev_u32 v26, 114688, v17
    buffer_load_dwordx4 v[116:119], v26, s[96:99], 0 offen sc1
    v_subrev_u32 v27, 122880, v17
    buffer_load_dwordx4 v[120:123], v27, s[96:99], 0 offen sc1
    s_waitcnt vmcnt(0)
L_10:
    v_mov_b32 v20, 0
    v_xor_b32 v23, v65, v193
    v_xor_b32 v24, v67, v193
    v_or3_b32 v20, v20, v23, v24
    v_xor_b32 v21, v69, v194
    v_xor_b32 v22, v71, v194
    v_or3_b32 v20, v20, v21, v22
    v_xor_b32 v23, v73, v195
    v_xor_b32 v24, v75, v195
    v_or3_b32 v20, v20, v23, v24
    v_xor_b32 v21, v77, v196
    v_xor_b32 v22, v79, v196
    v_or3_b32 v20, v20, v21, v22
    v_xor_b32 v23, v81, v197
    v_xor_b32 v24, v83, v197
    v_or3_b32 v20, v20, v23, v24
    v_xor_b32 v21, v85, v198
    v_xor_b32 v22, v87, v198
    v_or3_b32 v20, v20, v21, v22
    v_xor_b32 v23, v89, v199
    v_xor_b32 v24, v91, v199
    v_or3_b32 v20, v20, v23, v24
    v_xor_b32 v21, v93, v200
    v_xor_b32 v22, v95, v200
    v_or3_b32 v20, v20, v21, v22
    v_xor_b32 v23, v97, v201
    v_xor_b32 v24, v99, v201
    v_or3_b32 v20, v20, v23, v24
    v_xor_b32 v21, v101, v202
    v_xor_b32 v22, v103, v202
    v_or3_b32 v20, v20, v21, v22
    v_xor_b32 v23, v105, v203
    v_xor_b32 v24, v107, v203
    v_or3_b32 v20, v20, v23, v24
    v_xor_b32 v21, v109, v204
    v_xor_b32 v22, v111, v204
    v_or3_b32 v20, v20, v21, v22
    v_xor_b32 v23, v113, v205
    v_xor_b32 v24, v115, v205
    v_or3_b32 v20, v20, v23, v24
    v_xor_b32 v21, v117, v206
    v_xor_b32 v22, v119, v206
    v_or3_b32 v20, v20, v21, v22
    v_xor_b32 v23, v121, v207
    v_xor_b32 v24, v123, v207
    v_or3_b32 v20, v20, v23, v24
    v_cmp_ne_u32 vcc, 0, v20
    s_cmp_eq_u64 vcc, 0
    s_cbranch_scc1 L_9
    s_sub_u32 s83, s83, 1
    s_cmp_lg_u32 s83, 0
    s_cbranch_scc1 L_8
L_9:
    v_mov_b32 v20, v64
    v_mov_b32 v21, v66
    v_mov_b32 v22, 0
    v_mov_b32 v23, 0
    v_fma_f32 v22, v68, v132, v22
    v_fma_f32 v23, v70, v132, v23
    v_fma_f32 v22, -v70, v133, v22
    v_fma_f32 v23, v68, v133, v23
    v_fma_f32 v20, v72, v134, v20
    v_fma_f32 v21, v74, v134, v21
    v_fma_f32 v20, -v74, v135, v20
    v_fma_f32 v21, v72, v135, v21
    v_fma_f32 v22, v76, v136, v22
    v_fma_f32 v23, v78, v136, v23
    v_fma_f32 v22, -v78, v137, v22
    v_fma_f32 v23, v76, v137, v23
    v_fma_f32 v20, v80, v138, v20
    v_fma_f32 v21, v82, v138, v21
    v_fma_f32 v20, -v82, v139, v20
    v_fma_f32 v21, v80, v139, v21
    v_fma_f32 v22, v84, v140, v22
    v_fma_f32 v23, v86, v140, v23
    v_fma_f32 v22, -v86, v141, v22
    v_fma_f32 v23, v84, v141, v23
    v_fma_f32 v20, v88, v142, v20
    v_fma_f32 v21, v90, v142, v21
    v_fma_f32 v20, -v90, v143, v20
    v_fma_f32 v21, v88, v143, v21
    v_fma_f32 v22, v92, v144, v22
    v_fma_f32 v23, v94, v144, v23
    v_fma_f32 v22, -v94, v145, v22
    v_fma_f32 v23, v92, v145, v23
    v_fma_f32 v20, v96, v146, v20
    v_fma_f32 v21, v98, v146, v21
    v_fma_f32 v20, -v98, v147, v20
    v_fma_f32 v21, v96, v147, v21
    v_fma_f32 v22, v100, v148, v22
    v_fma_f32 v23, v102, v148, v23
    v_fma_f32 v22, -v102, v149, v22
    v_fma_f32 v23, v100, v149, v23
    v_fma_f32 v20, v104, v150, v20
    v_fma_f32 v21, v106, v150, v21
    v_fma_f32 v20, -v106, v151, v20
    v_fma_f32 v21, v104, v151, v21
    v_fma_f32 v22, v108, v152, v22
    v_fma_f32 v23, v110, v152, v23
    v_fma_f32 v22, -v110, v153, v22
    v_fma_f32 v23, v108, v153, v23
    v_fma_f32 v20, v112, v154, v20
    v_fma_f32 v21, v114, v154, v21
    v_fma_f32 v20, -v114, v155, v20
    v_fma_f32 v21, v112, v155, v21
    v_fma_f32 v22, v116, v156, v22
    v_fma_f32 v23, v118, v156, v23
    v_fma_f32 v22, -v118, v157, v22
    v_fma_f32 v23, v116, v157, v23
    v_fma_f32 v20, v120, v158, v20
    v_fma_f32 v21, v122, v158, v21
    v_fma_f32 v20, -v122, v159, v20
    v_fma_f32 v21, v120, v159, v21
    v_add_f32 v20, v20, v22
    v_add_f32 v21, v21, v23
    ds_write_b32 v1, v20 offset:0
    ds_write_b32 v1, v21 offset:1024
    v_fma_f32 v32, v20, v162, v32
    v_fma_f32 v48, v21, v162, v48
    v_fma_f32 v32, -v21, v163, v32
    v_fma_f32 v48, v20, v163, v48
    ds_write_b32 v1, v32 offset:64
    ds_write_b32 v1, v48 offset:1088
    v_fma_f32 v33, v20, v164, v33
    v_fma_f32 v49, v21, v164, v49
    v_fma_f32 v33, -v21, v165, v33
    v_fma_f32 v49, v20, v165, v49
    ds_write_b32 v1, v33 offset:128
    ds_write_b32 v1, v49 offset:1152
    v_fma_f32 v34, v20, v166, v34
    v_fma_f32 v50, v21, v166, v50
    v_fma_f32 v34, -v21, v167, v34
    v_fma_f32 v50, v20, v167, v50
    ds_write_b32 v1, v34 offset:192
    ds_write_b32 v1, v50 offset:1216
    v_fma_f32 v35, v20, v168, v35
    v_fma_f32 v51, v21, v168, v51
    v_fma_f32 v35, -v21, v169, v35
    v_fma_f32 v51, v20, v169, v51
    ds_write_b32 v1, v35 offset:256
    ds_write_b32 v1, v51 offset:1280
    v_fma_f32 v36, v20, v170, v36
    v_fma_f32 v52, v21, v170, v52
    v_fma_f32 v36, -v21, v171, v36
    v_fma_f32 v52, v20, v171, v52
    ds_write_b32 v1, v36 offset:320
    ds_write_b32 v1, v52 offset:1344
    v_fma_f32 v37, v20, v172, v37
    v_fma_f32 v53, v21, v172, v53
    v_fma_f32 v37, -v21, v173, v37
    v_fma_f32 v53, v20, v173, v53
    ds_write_b32 v1, v37 offset:384
    ds_write_b32 v1, v53 offset:1408
    v_fma_f32 v38, v20, v174, v38
    v_fma_f32 v54, v21, v174, v54
    v_fma_f32 v38, -v21, v175, v38
    v_fma_f32 v54, v20, v175, v54
    ds_write_b32 v1, v38 offset:448
    ds_write_b32 v1, v54 offset:1472
    v_fma_f32 v39, v20, v176, v39
    v_fma_f32 v55, v21, v176, v55
    v_fma_f32 v39, -v21, v177, v39
    v_fma_f32 v55, v20, v177, v55
    ds_write_b32 v1, v39 offset:512
    ds_write_b32 v1, v55 offset:1536
    v_fma_f32 v40, v20, v178, v40
    v_fma_f32 v56, v21, v178, v56
    v_fma_f32 v40, -v21, v179, v40
    v_fma_f32 v56, v20, v179, v56
    ds_write_b32 v1, v40 offset:576
    ds_write_b32 v1, v56 offset:1600
    v_fma_f32 v41, v20, v180, v41
    v_fma_f32 v57, v21, v180, v57
    v_fma_f32 v41, -v21, v181, v41
    v_fma_f32 v57, v20, v181, v57
    ds_write_b32 v1, v41 offset:640
    ds_write_b32 v1, v57 offset:1664
    v_fma_f32 v42, v20, v182, v42
    v_fma_f32 v58, v21, v182, v58
    v_fma_f32 v42, -v21, v183, v42
    v_fma_f32 v58, v20, v183, v58
    ds_write_b32 v1, v42 offset:704
    ds_write_b32 v1, v58 offset:1728
    v_fma_f32 v43, v20, v184, v43
    v_fma_f32 v59, v21, v184, v59
    v_fma_f32 v43, -v21, v185, v43
    v_fma_f32 v59, v20, v185, v59
    ds_write_b32 v1, v43 offset:768
    ds_write_b32 v1, v59 offset:1792
    v_fma_f32 v44, v20, v186, v44
    v_fma_f32 v60, v21, v186, v60
    v_fma_f32 v44, -v21, v187, v44
    v_fma_f32 v60, v20, v187, v60
    ds_write_b32 v1, v44 offset:832
    ds_write_b32 v1, v60 offset:1856
    v_fma_f32 v45, v20, v188, v45
    v_fma_f32 v61, v21, v188, v61
    v_fma_f32 v45, -v21, v189, v45
    v_fma_f32 v61, v20, v189, v61
    ds_write_b32 v1, v45 offset:896
    ds_write_b32 v1, v61 offset:1920
    v_fma_f32 v46, v20, v190, v46
    v_fma_f32 v62, v21, v190, v62
    v_fma_f32 v46, -v21, v191, v46
    v_fma_f32 v62, v20, v191, v62
    ds_write_b32 v1, v46 offset:960
    ds_write_b32 v1, v62 offset:1984
    s_mov_b64 exec, -1
    s_add_u32 m0, s87, 53248
    s_add_u32 s4, s86, 512
    buffer_load_dwordx4 v10, s[52:55], s4 offen lds
    s_add_u32 m0, s87, 54272
    s_add_u32 s4, s86, 8704
    buffer_load_dwordx4 v10, s[52:55], s4 offen lds
    s_add_u32 m0, s87, 55296
    s_add_u32 s4, s86, 16896
    buffer_load_dwordx4 v11, s[52:55], s4 offen lds
    s_add_u32 m0, s87, 56320
    s_add_u32 s4, s86, 25088
    buffer_load_dwordx4 v11, s[52:55], s4 offen lds
    s_add_u32 m0, s88, 0
    s_nop 0
    buffer_load_dwordx4 v12, s[56:59], s80 offen lds
    s_add_u32 s80, s80, s82
    s_add_u32 m0, s88, 1024
    s_nop 0
    buffer_load_dwordx4 v13, s[56:59], s80 offen lds
    s_add_u32 s80, s80, s82
    s_add_u32 m0, s88, 2048
    s_nop 0
    buffer_load_dwordx4 v12, s[56:59], s80 offen lds
    s_add_u32 s80, s80, s82
    s_add_u32 m0, s88, 3072
    s_nop 0
    buffer_load_dwordx4 v13, s[56:59], s80 offen lds
    s_add_u32 s80, s80, s81
    s_and_b32 s4, s2, 7
    s_lshr_b32 s5, s2, 3
    s_lshl_b32 s84, s4, 2
    s_lshr_b32 s4, s5, 3
    s_add_u32 s84, s84, s4
    s_and_b32 s85, s5, 7
    s_mov_b32 s52, s40
    s_mov_b32 s53, s41
    s_mov_b32 s54, 1835008
    s_mov_b32 s55, 0x20000
    s_mov_b32 s56, s26
    s_mov_b32 s57, s27
    s_mov_b32 s58, 524288
    s_mov_b32 s59, 0x20000
    s_mov_b32 s60, s28
    s_mov_b32 s61, s29
    s_mov_b32 s62, 524288
    s_mov_b32 s63, 0x20000
    s_lshl_b32 s4, s3, 14
    s_lshl_b32 s5, s85, 7
    s_add_u32 s89, s4, s5
    s_lshl_b32 s5, s85, 16
    s_add_u32 s90, s4, s5
    s_lshl_b32 s91, s3, 11
    s_lshr_b32 s4, s84, 1
    s_lshl_b32 s4, s4, 10
    s_add_u32 s86, s4, 11730944
    v_lshlrev_b32 v9, 2, v0
    s_add_u32 m0, s91, 4096
    s_add_u32 s4, s89, 0
    buffer_load_dwordx4 v15, s[52:55], s4 offen lds
    s_add_u32 m0, s91, 5120
    s_add_u32 s4, s89, 8192
    buffer_load_dwordx4 v15, s[52:55], s4 offen lds
    s_add_u32 m0, s91, 12288
    s_add_u32 s4, s89, 131072
    buffer_load_dwordx4 v15, s[52:55], s4 offen lds
    s_add_u32 m0, s91, 13312
    s_add_u32 s4, s89, 139264
    buffer_load_dwordx4 v15, s[52:55], s4 offen lds
    s_add_u32 m0, s91, 20480
    s_add_u32 s4, s89, 262144
    buffer_load_dwordx4 v15, s[52:55], s4 offen lds
    s_add_u32 m0, s91, 21504
    s_add_u32 s4, s89, 270336
    buffer_load_dwordx4 v15, s[52:55], s4 offen lds
    s_add_u32 m0, s91, 28672
    s_add_u32 s4, s89, 458752
    buffer_load_dwordx4 v15, s[52:55], s4 offen lds
    s_add_u32 m0, s91, 29696
    s_add_u32 s4, s89, 466944
    buffer_load_dwordx4 v15, s[52:55], s4 offen lds
    s_waitcnt vmcnt(16) lgkmcnt(0)
    s_barrier
    s_add_u32 m0, s91, 36864
    s_add_u32 s4, s89, 589824
    buffer_load_dwordx4 v15, s[52:55], s4 offen lds
    s_add_u32 m0, s91, 37888
    s_add_u32 s4, s89, 598016
    buffer_load_dwordx4 v15, s[52:55], s4 offen lds
    s_add_u32 m0, s91, 45056
    s_add_u32 s4, s89, 720896
    buffer_load_dwordx4 v15, s[52:55], s4 offen lds
    s_add_u32 m0, s91, 46080
    s_add_u32 s4, s89, 729088
    buffer_load_dwordx4 v15, s[52:55], s4 offen lds
    s_add_u32 m0, s91, 110592
    s_add_u32 s4, s89, 917504
    buffer_load_dwordx4 v15, s[52:55], s4 offen lds
    s_add_u32 m0, s91, 111616
    s_add_u32 s4, s89, 925696
    buffer_load_dwordx4 v15, s[52:55], s4 offen lds
    s_add_u32 m0, s91, 135168
    s_add_u32 s4, s89, 1048576
    buffer_load_dwordx4 v15, s[52:55], s4 offen lds
    s_add_u32 m0, s91, 136192
    s_add_u32 s4, s89, 1056768
    buffer_load_dwordx4 v15, s[52:55], s4 offen lds
    s_waitcnt vmcnt(16)
    s_barrier
    buffer_load_dword v8, v9, s[64:67], s86 offen offset:0 sc1
    s_add_u32 m0, s91, 86016
    s_add_u32 s4, s89, 1179648
    buffer_load_dwordx4 v15, s[52:55], s4 offen lds
    s_add_u32 m0, s91, 87040
    s_add_u32 s4, s89, 1187840
    buffer_load_dwordx4 v15, s[52:55], s4 offen lds
    s_add_u32 m0, s91, 94208
    s_add_u32 s4, s89, 1376256
    buffer_load_dwordx4 v15, s[52:55], s4 offen lds
    s_add_u32 m0, s91, 95232
    s_add_u32 s4, s89, 1384448
    buffer_load_dwordx4 v15, s[52:55], s4 offen lds
    s_add_u32 m0, s91, 118784
    s_add_u32 s4, s89, 1507328
    buffer_load_dwordx4 v15, s[52:55], s4 offen lds
    s_add_u32 m0, s91, 119808
    s_add_u32 s4, s89, 1515520
    buffer_load_dwordx4 v15, s[52:55], s4 offen lds
    s_add_u32 m0, s91, 143360
    s_add_u32 s4, s89, 1638400
    buffer_load_dwordx4 v15, s[52:55], s4 offen lds
    s_add_u32 m0, s91, 144384
    s_add_u32 s4, s89, 1646592
    buffer_load_dwordx4 v15, s[52:55], s4 offen lds
    s_waitcnt vmcnt(21)
    s_waitcnt vmcnt(8)
    s_mov_b32 s88, 0x8000
    s_branch L_13
L_11:
    buffer_load_dword v8, v9, s[64:67], s86 offen offset:0 sc1
    s_waitcnt vmcnt(0)
L_13:
    v_cmp_ne_u32 vcc, s72, v8
    s_cmp_eq_u64 vcc, 0
    s_cbranch_scc1 L_12
    s_sub_u32 s88, s88, 1
    s_cmp_lg_u32 s88, 0
    s_cbranch_scc1 L_11
L_12:
    s_barrier
    s_add_u32 m0, s91, 53248
    s_add_u32 s4, s90, 0
    buffer_load_dwordx4 v28, s[56:59], s4 offen lds
    s_add_u32 m0, s91, 54272
    s_add_u32 s4, s90, 8192
    buffer_load_dwordx4 v29, s[56:59], s4 offen lds
    s_add_u32 m0, s91, 61440
    s_add_u32 s4, s90, 0
    buffer_load_dwordx4 v28, s[60:63], s4 offen lds
    s_add_u32 m0, s91, 62464
    s_add_u32 s4, s90, 8192
    buffer_load_dwordx4 v29, s[60:63], s4 offen lds
    s_add_u32 m0, s91, 102400
    s_add_u32 s4, s90, 128
    buffer_load_dwordx4 v28, s[56:59], s4 offen lds
    s_add_u32 m0, s91, 103424
    s_add_u32 s4, s90, 8320
    buffer_load_dwordx4 v29, s[56:59], s4 offen lds
    s_add_u32 m0, s91, 126976
    s_add_u32 s4, s90, 128
    buffer_load_dwordx4 v28, s[60:63], s4 offen lds
    s_add_u32 m0, s91, 128000
    s_add_u32 s4, s90, 8320
    buffer_load_dwordx4 v29, s[60:63], s4 offen lds
    s_barrier
    s_add_u32 m0, s91, 69632
    s_add_u32 s4, s90, 256
    buffer_load_dwordx4 v28, s[56:59], s4 offen lds
    s_add_u32 m0, s91, 70656
    s_add_u32 s4, s90, 8448
    buffer_load_dwordx4 v29, s[56:59], s4 offen lds
    s_add_u32 m0, s91, 77824
    s_add_u32 s4, s90, 256
    buffer_load_dwordx4 v28, s[60:63], s4 offen lds
    s_add_u32 m0, s91, 78848
    s_add_u32 s4, s90, 8448
    buffer_load_dwordx4 v29, s[60:63], s4 offen lds
    s_barrier
    s_add_u32 m0, s91, 4096
    s_add_u32 s4, s90, 384
    buffer_load_dwordx4 v28, s[56:59], s4 offen lds
    s_add_u32 m0, s91, 5120
    s_add_u32 s4, s90, 8576
    buffer_load_dwordx4 v29, s[56:59], s4 offen lds
    s_add_u32 m0, s91, 12288
    s_add_u32 s4, s90, 384
    buffer_load_dwordx4 v28, s[60:63], s4 offen lds
    s_add_u32 m0, s91, 13312
    s_add_u32 s4, s90, 8576
    buffer_load_dwordx4 v29, s[60:63], s4 offen lds
    s_barrier
    buffer_load_dword v8, v9, s[64:67], s86 offen offset:256 sc1
    s_add_u32 m0, s91, 20480
    s_add_u32 s4, s90, 512
    buffer_load_dwordx4 v28, s[56:59], s4 offen lds
    s_add_u32 m0, s91, 21504
    s_add_u32 s4, s90, 8704
    buffer_load_dwordx4 v29, s[56:59], s4 offen lds
    s_add_u32 m0, s91, 28672
    s_add_u32 s4, s90, 512
    buffer_load_dwordx4 v28, s[60:63], s4 offen lds
    s_add_u32 m0, s91, 29696
    s_add_u32 s4, s90, 8704
    buffer_load_dwordx4 v29, s[60:63], s4 offen lds
    s_waitcnt vmcnt(25)
    s_waitcnt vmcnt(4)
    s_mov_b32 s88, 0x8000
    s_branch L_16
L_14:
    buffer_load_dword v8, v9, s[64:67], s86 offen offset:256 sc1
    s_waitcnt vmcnt(0)
L_16:
    v_cmp_ne_u32 vcc, s72, v8
    s_cmp_eq_u64 vcc, 0
    s_cbranch_scc1 L_15
    s_sub_u32 s88, s88, 1
    s_cmp_lg_u32 s88, 0
    s_cbranch_scc1 L_14
L_15:
    s_barrier
    s_add_u32 m0, s91, 36864
    s_add_u32 s4, s90, 640
    buffer_load_dwordx4 v28, s[56:59], s4 offen lds
    s_add_u32 m0, s91, 37888
    s_add_u32 s4, s90, 8832
    buffer_load_dwordx4 v29, s[56:59], s4 offen lds
    s_add_u32 m0, s91, 45056
    s_add_u32 s4, s90, 640
    buffer_load_dwordx4 v28, s[60:63], s4 offen lds
    s_add_u32 m0, s91, 46080
    s_add_u32 s4, s90, 8832
    buffer_load_dwordx4 v29, s[60:63], s4 offen lds
    s_barrier
    s_add_u32 m0, s91, 110592
    s_add_u32 s4, s90, 768
    buffer_load_dwordx4 v28, s[56:59], s4 offen lds
    s_add_u32 m0, s91, 111616
    s_add_u32 s4, s90, 8960
    buffer_load_dwordx4 v29, s[56:59], s4 offen lds
    s_add_u32 m0, s91, 135168
    s_add_u32 s4, s90, 768
    buffer_load_dwordx4 v28, s[60:63], s4 offen lds
    s_add_u32 m0, s91, 136192
    s_add_u32 s4, s90, 8960
    buffer_load_dwordx4 v29, s[60:63], s4 offen lds
    s_barrier
    s_add_u32 m0, s91, 86016
    s_add_u32 s4, s90, 896
    buffer_load_dwordx4 v28, s[56:59], s4 offen lds
    s_add_u32 m0, s91, 87040
    s_add_u32 s4, s90, 9088
    buffer_load_dwordx4 v29, s[56:59], s4 offen lds
    s_add_u32 m0, s91, 94208
    s_add_u32 s4, s90, 896
    buffer_load_dwordx4 v28, s[60:63], s4 offen lds
    s_add_u32 m0, s91, 95232
    s_add_u32 s4, s90, 9088
    buffer_load_dwordx4 v29, s[60:63], s4 offen lds
    s_barrier
    s_add_u32 m0, s91, 118784
    s_add_u32 s4, s89, 65536
    buffer_load_dwordx4 v15, s[52:55], s4 offen lds
    s_add_u32 m0, s91, 119808
    s_add_u32 s4, s89, 73728
    buffer_load_dwordx4 v15, s[52:55], s4 offen lds
    s_add_u32 m0, s91, 143360
    s_add_u32 s4, s89, 196608
    buffer_load_dwordx4 v15, s[52:55], s4 offen lds
    s_add_u32 m0, s91, 144384
    s_add_u32 s4, s89, 204800
    buffer_load_dwordx4 v15, s[52:55], s4 offen lds
    s_barrier
    buffer_load_dword v8, v9, s[64:67], s86 offen offset:512 sc1
    s_add_u32 m0, s91, 53248
    s_add_u32 s4, s89, 327680
    buffer_load_dwordx4 v15, s[52:55], s4 offen lds
    s_add_u32 m0, s91, 54272
    s_add_u32 s4, s89, 335872
    buffer_load_dwordx4 v15, s[52:55], s4 offen lds
    s_add_u32 m0, s91, 61440
    s_add_u32 s4, s89, 393216
    buffer_load_dwordx4 v15, s[52:55], s4 offen lds
    s_add_u32 m0, s91, 62464
    s_add_u32 s4, s89, 401408
    buffer_load_dwordx4 v15, s[52:55], s4 offen lds
    s_waitcnt vmcnt(4)
    s_mov_b32 s88, 0x8000
    s_branch L_19
L_17:
    buffer_load_dword v8, v9, s[64:67], s86 offen offset:512 sc1
    s_waitcnt vmcnt(0)
L_19:
    v_cmp_ne_u32 vcc, s72, v8
    s_cmp_eq_u64 vcc, 0
    s_cbranch_scc1 L_18
    s_sub_u32 s88, s88, 1
    s_cmp_lg_u32 s88, 0
    s_cbranch_scc1 L_17
L_18:
    s_barrier
    s_add_u32 m0, s91, 102400
    s_add_u32 s4, s89, 524288
    buffer_load_dwordx4 v15, s[52:55], s4 offen lds
    s_add_u32 m0, s91, 103424
    s_add_u32 s4, s89, 532480
    buffer_load_dwordx4 v15, s[52:55], s4 offen lds
    s_add_u32 m0, s91, 126976
    s_add_u32 s4, s89, 655360
    buffer_load_dwordx4 v15, s[52:55], s4 offen lds
    s_add_u32 m0, s91, 128000
    s_add_u32 s4, s89, 663552
    buffer_load_dwordx4 v15, s[52:55], s4 offen lds
    s_barrier
    s_add_u32 m0, s91, 69632
    s_add_u32 s4, s89, 786432
    buffer_load_dwordx4 v15, s[52:55], s4 offen lds
    s_add_u32 m0, s91, 70656
    s_add_u32 s4, s89, 794624
    buffer_load_dwordx4 v15, s[52:55], s4 offen lds
    s_add_u32 m0, s91, 77824
    s_add_u32 s4, s89, 851968
    buffer_load_dwordx4 v15, s[52:55], s4 offen lds
    s_add_u32 m0, s91, 78848
    s_add_u32 s4, s89, 860160
    buffer_load_dwordx4 v15, s[52:55], s4 offen lds
    s_barrier
    s_add_u32 m0, s91, 4096
    s_add_u32 s4, s89, 983040
    buffer_load_dwordx4 v15, s[52:55], s4 offen lds
    s_add_u32 m0, s91, 5120
    s_add_u32 s4, s89, 991232
    buffer_load_dwordx4 v15, s[52:55], s4 offen lds
    s_add_u32 m0, s91, 12288
    s_add_u32 s4, s89, 1114112
    buffer_load_dwordx4 v15, s[52:55], s4 offen lds
    s_add_u32 m0, s91, 13312
    s_add_u32 s4, s89, 1122304
    buffer_load_dwordx4 v15, s[52:55], s4 offen lds
    s_barrier
    s_add_u32 m0, s91, 20480
    s_add_u32 s4, s89, 1245184
    buffer_load_dwordx4 v15, s[52:55], s4 offen lds
    s_add_u32 m0, s91, 21504
    s_add_u32 s4, s89, 1253376
    buffer_load_dwordx4 v15, s[52:55], s4 offen lds
    s_add_u32 m0, s91, 28672
    s_add_u32 s4, s89, 1310720
    buffer_load_dwordx4 v15, s[52:55], s4 offen lds
    s_add_u32 m0, s91, 29696
    s_add_u32 s4, s89, 1318912
    buffer_load_dwordx4 v15, s[52:55], s4 offen lds
    s_barrier
    s_add_u32 m0, s91, 36864
    s_add_u32 s4, s89, 1441792
    buffer_load_dwordx4 v15, s[52:55], s4 offen lds
    s_add_u32 m0, s91, 37888
    s_add_u32 s4, s89, 1449984
    buffer_load_dwordx4 v15, s[52:55], s4 offen lds
    s_add_u32 m0, s91, 45056
    s_add_u32 s4, s89, 1572864
    buffer_load_dwordx4 v15, s[52:55], s4 offen lds
    s_add_u32 m0, s91, 46080
    s_add_u32 s4, s89, 1581056
    buffer_load_dwordx4 v15, s[52:55], s4 offen lds
    s_barrier
    s_add_u32 m0, s91, 110592
    s_add_u32 s4, s89, 1703936
    buffer_load_dwordx4 v15, s[52:55], s4 offen lds
    s_add_u32 m0, s91, 111616
    s_add_u32 s4, s89, 1712128
    buffer_load_dwordx4 v15, s[52:55], s4 offen lds
    s_add_u32 m0, s91, 135168
    s_add_u32 s4, s89, 1769472
    buffer_load_dwordx4 v15, s[52:55], s4 offen lds
    s_add_u32 m0, s91, 136192
    s_add_u32 s4, s89, 1777664
    buffer_load_dwordx4 v15, s[52:55], s4 offen lds
    s_waitcnt vmcnt(24)
    s_barrier
    s_waitcnt vmcnt(20)
    s_barrier
    s_waitcnt vmcnt(16)
    s_barrier
    s_waitcnt vmcnt(12)
    s_barrier
    s_waitcnt vmcnt(8)
    s_barrier
    s_waitcnt vmcnt(4)
    s_barrier
    s_waitcnt vmcnt(0)
    s_barrier
    s_barrier
    s_endpgm
L_6:
    s_add_u32 s96, s48, 11599872
    s_addc_u32 s97, s49, 0
    s_mov_b32 s98, 131072
    s_mov_b32 s99, 0x20000
    v_lshlrev_b32 v1, 4, v0
    v_mov_b32 v4, 0
    ds_read_b64 v[2:3], v1 offset:256
    ds_read_b32 v5, v4 offset:2048
    s_waitcnt lgkmcnt(0)
    v_readfirstlane_b32 s72, v5
    v_mul_f32 v8, v3, v3
    v_mul_f32 v9, v2, v3
    v_fma_f32 v2, v2, v2, -v8
    v_add_f32 v3, v9, v9
    v_mul_f32 v8, v3, v3
    v_mul_f32 v9, v2, v3
    v_fma_f32 v2, v2, v2, -v8
    v_add_f32 v3, v9, v9
    v_mul_f32 v8, v3, v3
    v_mul_f32 v9, v2, v3
    v_fma_f32 v2, v2, v2, -v8
    v_add_f32 v3, v9, v9
    v_mul_f32 v8, v3, v3
    v_mul_f32 v9, v2, v3
    v_fma_f32 v2, v2, v2, -v8
    v_add_f32 v3, v9, v9
    v_mov_b32 v162, v2
    v_mov_b32 v163, v3
    v_mul_f32 v8, v3, v3
    v_mul_f32 v9, v2, v3
    v_fma_f32 v2, v2, v2, -v8
    v_add_f32 v3, v9, v9
    v_mul_f32 v8, v3, v3
    v_mul_f32 v9, v2, v3
    v_fma_f32 v2, v2, v2, -v8
    v_add_f32 v3, v9, v9
    v_mul_f32 v8, v3, v3
    v_mul_f32 v9, v2, v3
    v_fma_f32 v2, v2, v2, -v8
    v_add_f32 v3, v9, v9
    s_lshl_b32 s4, s11, 4
    s_lshl_b32 s5, s6, 13
    s_add_u32 s4, s4, s5
    v_add_u32 v17, s4, v1
    v_lshlrev_b32 v1, 2, v0
    v_add_u32 v1, 151552, v1
    v_mov_b32 v125, v5
    v_mov_b32 v127, v5
    s_cmp_ge_u32 s6, 1
    s_cselect_b32 s4, s72, 0
    v_mov_b32 v193, s4
    s_cmp_ge_u32 s6, 2
    s_cselect_b32 s4, s72, 0
    v_mov_b32 v194, s4
    s_cmp_ge_u32 s6, 3
    s_cselect_b32 s4, s72, 0
    v_mov_b32 v195, s4
    s_cmp_ge_u32 s6, 4
    s_cselect_b32 s4, s72, 0
    v_mov_b32 v196, s4
    s_cmp_ge_u32 s6, 5
    s_cselect_b32 s4, s72, 0
    v_mov_b32 v197, s4
    s_cmp_ge_u32 s6, 6
    s_cselect_b32 s4, s72, 0
    v_mov_b32 v198, s4
    s_cmp_ge_u32 s6, 7
    s_cselect_b32 s4, s72, 0
    v_mov_b32 v199, s4
    s_cmp_ge_u32 s6, 8
    s_cselect_b32 s4, s72, 0
    v_mov_b32 v200, s4
    s_cmp_ge_u32 s6, 9
    s_cselect_b32 s4, s72, 0
    v_mov_b32 v201, s4
    s_cmp_ge_u32 s6, 10
    s_cselect_b32 s4, s72, 0
    v_mov_b32 v202, s4
    s_cmp_ge_u32 s6, 11
    s_cselect_b32 s4, s72, 0
    v_mov_b32 v203, s4
    s_cmp_ge_u32 s6, 12
    s_cselect_b32 s4, s72, 0
    v_mov_b32 v204, s4
    s_cmp_ge_u32 s6, 13
    s_cselect_b32 s4, s72, 0
    v_mov_b32 v205, s4
    s_cmp_ge_u32 s6, 14
    s_cselect_b32 s4, s72, 0
    v_mov_b32 v206, s4
    s_cmp_ge_u32 s6, 15
    s_cselect_b32 s4, s72, 0
    v_mov_b32 v207, s4
    s_waitcnt vmcnt(4)
    s_barrier
    s_sub_u32 s80, s80, 1835008
    s_add_u32 m0, s88, 16384
    s_nop 0
    buffer_load_dwordx4 v12, s[56:59], s80 offen lds
    s_add_u32 s80, s80, s82
    s_add_u32 m0, s88, 17408
    s_nop 0
    buffer_load_dwordx4 v13, s[56:59], s80 offen lds
    s_add_u32 s80, s80, s82
    s_add_u32 m0, s88, 18432
    s_nop 0
    buffer_load_dwordx4 v12, s[56:59], s80 offen lds
    s_add_u32 s80, s80, s82
    s_add_u32 m0, s88, 19456
    s_nop 0
    buffer_load_dwordx4 v13, s[56:59], s80 offen lds
    s_add_u32 s80, s80, s81
    s_nop 0
    ds_read_b32 v32, v1 offset:2048
    ds_read_b32 v48, v1 offset:8192
    ds_read_b32 v33, v1 offset:2304
    ds_read_b32 v49, v1 offset:8448
    ds_read_b32 v34, v1 offset:2560
    ds_read_b32 v50, v1 offset:8704
    ds_read_b32 v35, v1 offset:2816
    ds_read_b32 v51, v1 offset:8960
    ds_read_b32 v36, v1 offset:3072
    ds_read_b32 v52, v1 offset:9216
    ds_read_b32 v37, v1 offset:3328
    ds_read_b32 v53, v1 offset:9472
    ds_read_b32 v38, v1 offset:3584
    ds_read_b32 v54, v1 offset:9728
    ds_read_b32 v39, v1 offset:3840
    ds_read_b32 v55, v1 offset:9984
    s_waitcnt lgkmcnt(0)
    v_fma_f32 v33, v32, v162, v33
    v_fma_f32 v49, v48, v162, v49
    v_fma_f32 v33, -v48, v163, v33
    v_fma_f32 v49, v32, v163, v49
    v_fma_f32 v34, v33, v162, v34
    v_fma_f32 v50, v49, v162, v50
    v_fma_f32 v34, -v49, v163, v34
    v_fma_f32 v50, v33, v163, v50
    v_fma_f32 v35, v34, v162, v35
    v_fma_f32 v51, v50, v162, v51
    v_fma_f32 v35, -v50, v163, v35
    v_fma_f32 v51, v34, v163, v51
    v_fma_f32 v36, v35, v162, v36
    v_fma_f32 v52, v51, v162, v52
    v_fma_f32 v36, -v51, v163, v36
    v_fma_f32 v52, v35, v163, v52
    v_fma_f32 v37, v36, v162, v37
    v_fma_f32 v53, v52, v162, v53
    v_fma_f32 v37, -v52, v163, v37
    v_fma_f32 v53, v36, v163, v53
    v_fma_f32 v38, v37, v162, v38
    v_fma_f32 v54, v53, v162, v54
    v_fma_f32 v38, -v53, v163, v38
    v_fma_f32 v54, v37, v163, v54
    v_fma_f32 v124, v38, v162, v39
    v_fma_f32 v126, v54, v162, v55
    v_fma_f32 v124, -v54, v163, v124
    v_fma_f32 v126, v38, v163, v126
    buffer_store_dwordx4 v[124:127], v17, s[96:99], 0 offen sc1
    s_mov_b64 exec, -1
    s_waitcnt vmcnt(5)
    s_barrier
    s_add_u32 m0, s88, 0
    s_nop 0
    buffer_load_dwordx4 v12, s[56:59], s80 offen lds
    s_add_u32 s80, s80, s82
    s_add_u32 m0, s88, 1024
    s_nop 0
    buffer_load_dwordx4 v13, s[56:59], s80 offen lds
    s_add_u32 s80, s80, s82
    s_add_u32 m0, s88, 2048
    s_nop 0
    buffer_load_dwordx4 v12, s[56:59], s80 offen lds
    s_add_u32 s80, s80, s82
    s_add_u32 m0, s88, 3072
    s_nop 0
    buffer_load_dwordx4 v13, s[56:59], s80 offen lds
    s_add_u32 s80, s80, s81
    v_mov_b32 v132, v2
    v_mov_b32 v133, v3
    s_cmp_ge_u32 s6, 2
    s_cselect_b64 vcc, -1, 0
    v_cndmask_b32 v132, 0, v132, vcc
    v_cndmask_b32 v133, 0, v133, vcc
    v_mul_f32 v134, v132, v2
    v_mul_f32 v135, v132, v3
    v_fma_f32 v134, -v133, v3, v134
    v_fma_f32 v135, v133, v2, v135
    s_cmp_ge_u32 s6, 3
    s_cselect_b64 vcc, -1, 0
    v_cndmask_b32 v134, 0, v134, vcc
    v_cndmask_b32 v135, 0, v135, vcc
    v_mul_f32 v136, v134, v2
    v_mul_f32 v137, v134, v3
    v_fma_f32 v136, -v135, v3, v136
    v_fma_f32 v137, v135, v2, v137
    s_cmp_ge_u32 s6, 4
    s_cselect_b64 vcc, -1, 0
    v_cndmask_b32 v136, 0, v136, vcc
    v_cndmask_b32 v137, 0, v137, vcc
    v_mul_f32 v138, v136, v2
    v_mul_f32 v139, v136, v3
    v_fma_f32 v138, -v137, v3, v138
    v_fma_f32 v139, v137, v2, v139
    s_cmp_ge_u32 s6, 5
    s_cselect_b64 vcc, -1, 0
    v_cndmask_b32 v138, 0, v138, vcc
    v_cndmask_b32 v139, 0, v139, vcc
    v_mul_f32 v140, v138, v2
    v_mul_f32 v141, v138, v3
    v_fma_f32 v140, -v139, v3, v140
    v_fma_f32 v141, v139, v2, v141
    s_cmp_ge_u32 s6, 6
    s_cselect_b64 vcc, -1, 0
    v_cndmask_b32 v140, 0, v140, vcc
    v_cndmask_b32 v141, 0, v141, vcc
    v_mul_f32 v142, v140, v2
    v_mul_f32 v143, v140, v3
    v_fma_f32 v142, -v141, v3, v142
    v_fma_f32 v143, v141, v2, v143
    s_cmp_ge_u32 s6, 7
    s_cselect_b64 vcc, -1, 0
    v_cndmask_b32 v142, 0, v142, vcc
    v_cndmask_b32 v143, 0, v143, vcc
    v_mul_f32 v144, v142, v2
    v_mul_f32 v145, v142, v3
    v_fma_f32 v144, -v143, v3, v144
    v_fma_f32 v145, v143, v2, v145
    s_cmp_ge_u32 s6, 8
    s_cselect_b64 vcc, -1, 0
    v_cndmask_b32 v144, 0, v144, vcc
    v_cndmask_b32 v145, 0, v145, vcc
    v_mul_f32 v146, v144, v2
    v_mul_f32 v147, v144, v3
    v_fma_f32 v146, -v145, v3, v146
    v_fma_f32 v147, v145, v2, v147
    s_cmp_ge_u32 s6, 9
    s_cselect_b64 vcc, -1, 0
    v_cndmask_b32 v146, 0, v146, vcc
    v_cndmask_b32 v147, 0, v147, vcc
    v_mul_f32 v148, v146, v2
    v_mul_f32 v149, v146, v3
    v_fma_f32 v148, -v147, v3, v148
    v_fma_f32 v149, v147, v2, v149
    s_cmp_ge_u32 s6, 10
    s_cselect_b64 vcc, -1, 0
    v_cndmask_b32 v148, 0, v148, vcc
    v_cndmask_b32 v149, 0, v149, vcc
    v_mul_f32 v150, v148, v2
    v_mul_f32 v151, v148, v3
    v_fma_f32 v150, -v149, v3, v150
    v_fma_f32 v151, v149, v2, v151
    s_cmp_ge_u32 s6, 11
    s_cselect_b64 vcc, -1, 0
    v_cndmask_b32 v150, 0, v150, vcc
    v_cndmask_b32 v151, 0, v151, vcc
    v_mul_f32 v152, v150, v2
    v_mul_f32 v153, v150, v3
    v_fma_f32 v152, -v151, v3, v152
    v_fma_f32 v153, v151, v2, v153
    s_cmp_ge_u32 s6, 12
    s_cselect_b64 vcc, -1, 0
    v_cndmask_b32 v152, 0, v152, vcc
    v_cndmask_b32 v153, 0, v153, vcc
    v_mul_f32 v154, v152, v2
    v_mul_f32 v155, v152, v3
    v_fma_f32 v154, -v153, v3, v154
    v_fma_f32 v155, v153, v2, v155
    s_cmp_ge_u32 s6, 13
    s_cselect_b64 vcc, -1, 0
    v_cndmask_b32 v154, 0, v154, vcc
    v_cndmask_b32 v155, 0, v155, vcc
    v_mul_f32 v156, v154, v2
    v_mul_f32 v157, v154, v3
    v_fma_f32 v156, -v155, v3, v156
    v_fma_f32 v157, v155, v2, v157
    s_cmp_ge_u32 s6, 14
    s_cselect_b64 vcc, -1, 0
    v_cndmask_b32 v156, 0, v156, vcc
    v_cndmask_b32 v157, 0, v157, vcc
    v_mul_f32 v158, v156, v2
    v_mul_f32 v159, v156, v3
    v_fma_f32 v158, -v157, v3, v158
    v_fma_f32 v159, v157, v2, v159
    s_cmp_ge_u32 s6, 15
    s_cselect_b64 vcc, -1, 0
    v_cndmask_b32 v158, 0, v158, vcc
    v_cndmask_b32 v159, 0, v159, vcc
    s_waitcnt vmcnt(5)
    s_barrier
    s_add_u32 m0, s88, 8192
    s_nop 0
    buffer_load_dwordx4 v12, s[56:59], s80 offen lds
    s_add_u32 s80, s80, s82
    s_add_u32 m0, s88, 9216
    s_nop 0
    buffer_load_dwordx4 v13, s[56:59], s80 offen lds
    s_add_u32 s80, s80, s82
    s_add_u32 m0, s88, 10240
    s_nop 0
    buffer_load_dwordx4 v12, s[56:59], s80 offen lds
    s_add_u32 s80, s80, s82
    s_add_u32 m0, s88, 11264
    s_nop 0
    buffer_load_dwordx4 v13, s[56:59], s80 offen lds
    s_add_u32 s80, s80, s81
    v_mul_f32 v164, v162, v162
    v_mul_f32 v165, v162, v163
    v_fma_f32 v164, -v163, v163, v164
    v_fma_f32 v165, v163, v162, v165
    v_mul_f32 v166, v164, v162
    v_mul_f32 v167, v164, v163
    v_fma_f32 v166, -v165, v163, v166
    v_fma_f32 v167, v165, v162, v167
    v_mul_f32 v168, v166, v162
    v_mul_f32 v169, v166, v163
    v_fma_f32 v168, -v167, v163, v168
    v_fma_f32 v169, v167, v162, v169
    v_mul_f32 v170, v168, v162
    v_mul_f32 v171, v168, v163
    v_fma_f32 v170, -v169, v163, v170
    v_fma_f32 v171, v169, v162, v171
    v_mul_f32 v172, v170, v162
    v_mul_f32 v173, v170, v163
    v_fma_f32 v172, -v171, v163, v172
    v_fma_f32 v173, v171, v162, v173
    v_mul_f32 v174, v172, v162
    v_mul_f32 v175, v172, v163
    v_fma_f32 v174, -v173, v163, v174
    v_fma_f32 v175, v173, v162, v175
    s_waitcnt vmcnt(4)
    s_barrier
    s_nop 0
    v_subrev_u32 v25, 8192, v17
    buffer_load_dwordx4 v[64:67], v25, s[96:99], 0 offen sc1
    v_subrev_u32 v26, 16384, v17
    buffer_load_dwordx4 v[68:71], v26, s[96:99], 0 offen sc1
    v_subrev_u32 v27, 24576, v17
    buffer_load_dwordx4 v[72:75], v27, s[96:99], 0 offen sc1
    v_subrev_u32 v24, 32768, v17
    buffer_load_dwordx4 v[76:79], v24, s[96:99], 0 offen sc1
    v_subrev_u32 v25, 40960, v17
    buffer_load_dwordx4 v[80:83], v25, s[96:99], 0 offen sc1
    v_subrev_u32 v26, 49152, v17
    buffer_load_dwordx4 v[84:87], v26, s[96:99], 0 offen sc1
    v_subrev_u32 v27, 57344, v17
    buffer_load_dwordx4 v[88:91], v27, s[96:99], 0 offen sc1
    v_subrev_u32 v24, 65536, v17
    buffer_load_dwordx4 v[92:95], v24, s[96:99], 0 offen sc1
    v_subrev_u32 v25, 73728, v17
    buffer_load_dwordx4 v[96:99], v25, s[96:99], 0 offen sc1
    v_subrev_u32 v26, 81920, v17
    buffer_load_dwordx4 v[100:103], v26, s[96:99], 0 offen sc1
    v_subrev_u32 v27, 90112, v17
    buffer_load_dwordx4 v[104:107], v27, s[96:99], 0 offen sc1
    v_subrev_u32 v24, 98304, v17
    buffer_load_dwordx4 v[108:111], v24, s[96:99], 0 offen sc1
    v_subrev_u32 v25, 106496, v17
    buffer_load_dwordx4 v[112:115], v25, s[96:99], 0 offen sc1
    v_subrev_u32 v26, 114688, v17
    buffer_load_dwordx4 v[116:119], v26, s[96:99], 0 offen sc1
    v_subrev_u32 v27, 122880, v17
    buffer_load_dwordx4 v[120:123], v27, s[96:99], 0 offen sc1
    s_mov_b64 exec, -1
    s_add_u32 m0, s87, 86016
    s_add_u32 s4, s86, 384
    buffer_load_dwordx4 v10, s[52:55], s4 offen lds
    s_add_u32 m0, s87, 87040
    s_add_u32 s4, s86, 8576
    buffer_load_dwordx4 v10, s[52:55], s4 offen lds
    s_add_u32 m0, s87, 88064
    s_add_u32 s4, s86, 16768
    buffer_load_dwordx4 v11, s[52:55], s4 offen lds
    s_add_u32 m0, s87, 89088
    s_add_u32 s4, s86, 24960
    buffer_load_dwordx4 v11, s[52:55], s4 offen lds
    s_add_u32 m0, s88, 16384
    s_nop 0
    buffer_load_dwordx4 v12, s[56:59], s80 offen lds
    s_add_u32 s80, s80, s82
    s_add_u32 m0, s88, 17408
    s_nop 0
    buffer_load_dwordx4 v13, s[56:59], s80 offen lds
    s_add_u32 s80, s80, s82
    s_add_u32 m0, s88, 18432
    s_nop 0
    buffer_load_dwordx4 v12, s[56:59], s80 offen lds
    s_add_u32 s80, s80, s82
    s_add_u32 m0, s88, 19456
    s_nop 0
    buffer_load_dwordx4 v13, s[56:59], s80 offen lds
    s_add_u32 s80, s80, s81
    s_waitcnt vmcnt(23)
    s_barrier
    s_nop 0
    s_mov_b32 s83, 0x8000
    s_waitcnt vmcnt(8)
    s_branch L_22
L_20:
    v_subrev_u32 v25, 8192, v17
    buffer_load_dwordx4 v[64:67], v25, s[96:99], 0 offen sc1
    v_subrev_u32 v26, 16384, v17
    buffer_load_dwordx4 v[68:71], v26, s[96:99], 0 offen sc1
    v_subrev_u32 v27, 24576, v17
    buffer_load_dwordx4 v[72:75], v27, s[96:99], 0 offen sc1
    v_subrev_u32 v24, 32768, v17
    buffer_load_dwordx4 v[76:79], v24, s[96:99], 0 offen sc1
    v_subrev_u32 v25, 40960, v17
    buffer_load_dwordx4 v[80:83], v25, s[96:99], 0 offen sc1
    v_subrev_u32 v26, 49152, v17
    buffer_load_dwordx4 v[84:87], v26, s[96:99], 0 offen sc1
    v_subrev_u32 v27, 57344, v17
    buffer_load_dwordx4 v[88:91], v27, s[96:99], 0 offen sc1
    v_subrev_u32 v24, 65536, v17
    buffer_load_dwordx4 v[92:95], v24, s[96:99], 0 offen sc1
    v_subrev_u32 v25, 73728, v17
    buffer_load_dwordx4 v[96:99], v25, s[96:99], 0 offen sc1
    v_subrev_u32 v26, 81920, v17
    buffer_load_dwordx4 v[100:103], v26, s[96:99], 0 offen sc1
    v_subrev_u32 v27, 90112, v17
    buffer_load_dwordx4 v[104:107], v27, s[96:99], 0 offen sc1
    v_subrev_u32 v24, 98304, v17
    buffer_load_dwordx4 v[108:111], v24, s[96:99], 0 offen sc1
    v_subrev_u32 v25, 106496, v17
    buffer_load_dwordx4 v[112:115], v25, s[96:99], 0 offen sc1
    v_subrev_u32 v26, 114688, v17
    buffer_load_dwordx4 v[116:119], v26, s[96:99], 0 offen sc1
    v_subrev_u32 v27, 122880, v17
    buffer_load_dwordx4 v[120:123], v27, s[96:99], 0 offen sc1
    s_waitcnt vmcnt(0)
L_22:
    v_mov_b32 v20, 0
    v_xor_b32 v23, v65, v193
    v_xor_b32 v24, v67, v193
    v_or3_b32 v20, v20, v23, v24
    v_xor_b32 v21, v69, v194
    v_xor_b32 v22, v71, v194
    v_or3_b32 v20, v20, v21, v22
    v_xor_b32 v23, v73, v195
    v_xor_b32 v24, v75, v195
    v_or3_b32 v20, v20, v23, v24
    v_xor_b32 v21, v77, v196
    v_xor_b32 v22, v79, v196
    v_or3_b32 v20, v20, v21, v22
    v_xor_b32 v23, v81, v197
    v_xor_b32 v24, v83, v197
    v_or3_b32 v20, v20, v23, v24
    v_xor_b32 v21, v85, v198
    v_xor_b32 v22, v87, v198
    v_or3_b32 v20, v20, v21, v22
    v_xor_b32 v23, v89, v199
    v_xor_b32 v24, v91, v199
    v_or3_b32 v20, v20, v23, v24
    v_xor_b32 v21, v93, v200
    v_xor_b32 v22, v95, v200
    v_or3_b32 v20, v20, v21, v22
    v_xor_b32 v23, v97, v201
    v_xor_b32 v24, v99, v201
    v_or3_b32 v20, v20, v23, v24
    v_xor_b32 v21, v101, v202
    v_xor_b32 v22, v103, v202
    v_or3_b32 v20, v20, v21, v22
    v_xor_b32 v23, v105, v203
    v_xor_b32 v24, v107, v203
    v_or3_b32 v20, v20, v23, v24
    v_xor_b32 v21, v109, v204
    v_xor_b32 v22, v111, v204
    v_or3_b32 v20, v20, v21, v22
    v_xor_b32 v23, v113, v205
    v_xor_b32 v24, v115, v205
    v_or3_b32 v20, v20, v23, v24
    v_xor_b32 v21, v117, v206
    v_xor_b32 v22, v119, v206
    v_or3_b32 v20, v20, v21, v22
    v_xor_b32 v23, v121, v207
    v_xor_b32 v24, v123, v207
    v_or3_b32 v20, v20, v23, v24
    v_cmp_ne_u32 vcc, 0, v20
    s_cmp_eq_u64 vcc, 0
    s_cbranch_scc1 L_21
    s_sub_u32 s83, s83, 1
    s_cmp_lg_u32 s83, 0
    s_cbranch_scc1 L_20
L_21:
    v_mov_b32 v20, v64
    v_mov_b32 v21, v66
    v_mov_b32 v22, 0
    v_mov_b32 v23, 0
    v_fma_f32 v22, v68, v132, v22
    v_fma_f32 v23, v70, v132, v23
    v_fma_f32 v22, -v70, v133, v22
    v_fma_f32 v23, v68, v133, v23
    v_fma_f32 v20, v72, v134, v20
    v_fma_f32 v21, v74, v134, v21
    v_fma_f32 v20, -v74, v135, v20
    v_fma_f32 v21, v72, v135, v21
    v_fma_f32 v22, v76, v136, v22
    v_fma_f32 v23, v78, v136, v23
    v_fma_f32 v22, -v78, v137, v22
    v_fma_f32 v23, v76, v137, v23
    v_fma_f32 v20, v80, v138, v20
    v_fma_f32 v21, v82, v138, v21
    v_fma_f32 v20, -v82, v139, v20
    v_fma_f32 v21, v80, v139, v21
    v_fma_f32 v22, v84, v140, v22
    v_fma_f32 v23, v86, v140, v23
    v_fma_f32 v22, -v86, v141, v22
    v_fma_f32 v23, v84, v141, v23
    v_fma_f32 v20, v88, v142, v20
    v_fma_f32 v21, v90, v142, v21
    v_fma_f32 v20, -v90, v143, v20
    v_fma_f32 v21, v88, v143, v21
    v_fma_f32 v22, v92, v144, v22
    v_fma_f32 v23, v94, v144, v23
    v_fma_f32 v22, -v94, v145, v22
    v_fma_f32 v23, v92, v145, v23
    v_fma_f32 v20, v96, v146, v20
    v_fma_f32 v21, v98, v146, v21
    v_fma_f32 v20, -v98, v147, v20
    v_fma_f32 v21, v96, v147, v21
    v_fma_f32 v22, v100, v148, v22
    v_fma_f32 v23, v102, v148, v23
    v_fma_f32 v22, -v102, v149, v22
    v_fma_f32 v23, v100, v149, v23
    v_fma_f32 v20, v104, v150, v20
    v_fma_f32 v21, v106, v150, v21
    v_fma_f32 v20, -v106, v151, v20
    v_fma_f32 v21, v104, v151, v21
    v_fma_f32 v22, v108, v152, v22
    v_fma_f32 v23, v110, v152, v23
    v_fma_f32 v22, -v110, v153, v22
    v_fma_f32 v23, v108, v153, v23
    v_fma_f32 v20, v112, v154, v20
    v_fma_f32 v21, v114, v154, v21
    v_fma_f32 v20, -v114, v155, v20
    v_fma_f32 v21, v112, v155, v21
    v_fma_f32 v22, v116, v156, v22
    v_fma_f32 v23, v118, v156, v23
    v_fma_f32 v22, -v118, v157, v22
    v_fma_f32 v23, v116, v157, v23
    v_fma_f32 v20, v120, v158, v20
    v_fma_f32 v21, v122, v158, v21
    v_fma_f32 v20, -v122, v159, v20
    v_fma_f32 v21, v120, v159, v21
    v_add_f32 v20, v20, v22
    v_add_f32 v21, v21, v23
    ds_write_b32 v1, v20 offset:2048
    ds_write_b32 v1, v21 offset:8192
    v_fma_f32 v32, v20, v162, v32
    v_fma_f32 v48, v21, v162, v48
    v_fma_f32 v32, -v21, v163, v32
    v_fma_f32 v48, v20, v163, v48
    ds_write_b32 v1, v32 offset:2304
    ds_write_b32 v1, v48 offset:8448
    v_fma_f32 v33, v20, v164, v33
    v_fma_f32 v49, v21, v164, v49
    v_fma_f32 v33, -v21, v165, v33
    v_fma_f32 v49, v20, v165, v49
    ds_write_b32 v1, v33 offset:2560
    ds_write_b32 v1, v49 offset:8704
    v_fma_f32 v34, v20, v166, v34
    v_fma_f32 v50, v21, v166, v50
    v_fma_f32 v34, -v21, v167, v34
    v_fma_f32 v50, v20, v167, v50
    ds_write_b32 v1, v34 offset:2816
    ds_write_b32 v1, v50 offset:8960
    v_fma_f32 v35, v20, v168, v35
    v_fma_f32 v51, v21, v168, v51
    v_fma_f32 v35, -v21, v169, v35
    v_fma_f32 v51, v20, v169, v51
    ds_write_b32 v1, v35 offset:3072
    ds_write_b32 v1, v51 offset:9216
    v_fma_f32 v36, v20, v170, v36
    v_fma_f32 v52, v21, v170, v52
    v_fma_f32 v36, -v21, v171, v36
    v_fma_f32 v52, v20, v171, v52
    ds_write_b32 v1, v36 offset:3328
    ds_write_b32 v1, v52 offset:9472
    v_fma_f32 v37, v20, v172, v37
    v_fma_f32 v53, v21, v172, v53
    v_fma_f32 v37, -v21, v173, v37
    v_fma_f32 v53, v20, v173, v53
    ds_write_b32 v1, v37 offset:3584
    ds_write_b32 v1, v53 offset:9728
    v_fma_f32 v38, v20, v174, v38
    v_fma_f32 v54, v21, v174, v54
    v_fma_f32 v38, -v21, v175, v38
    v_fma_f32 v54, v20, v175, v54
    ds_write_b32 v1, v38 offset:3840
    ds_write_b32 v1, v54 offset:9984
    s_mov_b64 exec, -1
    s_add_u32 m0, s87, 53248
    s_add_u32 s4, s86, 512
    buffer_load_dwordx4 v10, s[52:55], s4 offen lds
    s_add_u32 m0, s87, 54272
    s_add_u32 s4, s86, 8704
    buffer_load_dwordx4 v10, s[52:55], s4 offen lds
    s_add_u32 m0, s87, 55296
    s_add_u32 s4, s86, 16896
    buffer_load_dwordx4 v11, s[52:55], s4 offen lds
    s_add_u32 m0, s87, 56320
    s_add_u32 s4, s86, 25088
    buffer_load_dwordx4 v11, s[52:55], s4 offen lds
    s_add_u32 m0, s88, 0
    s_nop 0
    buffer_load_dwordx4 v12, s[56:59], s80 offen lds
    s_add_u32 s80, s80, s82
    s_add_u32 m0, s88, 1024
    s_nop 0
    buffer_load_dwordx4 v13, s[56:59], s80 offen lds
    s_add_u32 s80, s80, s82
    s_add_u32 m0, s88, 2048
    s_nop 0
    buffer_load_dwordx4 v12, s[56:59], s80 offen lds
    s_add_u32 s80, s80, s82
    s_add_u32 m0, s88, 3072
    s_nop 0
    buffer_load_dwordx4 v13, s[56:59], s80 offen lds
    s_add_u32 s80, s80, s81
    s_and_b32 s4, s2, 7
    s_lshr_b32 s5, s2, 3
    s_lshl_b32 s84, s4, 2
    s_lshr_b32 s4, s5, 3
    s_add_u32 s84, s84, s4
    s_and_b32 s85, s5, 7
    s_mov_b32 s52, s40
    s_mov_b32 s53, s41
    s_mov_b32 s54, 1835008
    s_mov_b32 s55, 0x20000
    s_mov_b32 s56, s26
    s_mov_b32 s57, s27
    s_mov_b32 s58, 524288
    s_mov_b32 s59, 0x20000
    s_mov_b32 s60, s28
    s_mov_b32 s61, s29
    s_mov_b32 s62, 524288
    s_mov_b32 s63, 0x20000
    s_lshl_b32 s4, s3, 14
    s_lshl_b32 s5, s85, 7
    s_add_u32 s89, s4, s5
    s_lshl_b32 s5, s85, 16
    s_add_u32 s90, s4, s5
    s_lshl_b32 s91, s3, 11
    s_add_u32 m0, s91, 4096
    s_add_u32 s4, s89, 0
    buffer_load_dwordx4 v15, s[52:55], s4 offen lds
    s_add_u32 m0, s91, 5120
    s_add_u32 s4, s89, 8192
    buffer_load_dwordx4 v15, s[52:55], s4 offen lds
    s_add_u32 m0, s91, 12288
    s_add_u32 s4, s89, 131072
    buffer_load_dwordx4 v15, s[52:55], s4 offen lds
    s_add_u32 m0, s91, 13312
    s_add_u32 s4, s89, 139264
    buffer_load_dwordx4 v15, s[52:55], s4 offen lds
    s_add_u32 m0, s91, 20480
    s_add_u32 s4, s89, 262144
    buffer_load_dwordx4 v15, s[52:55], s4 offen lds
    s_add_u32 m0, s91, 21504
    s_add_u32 s4, s89, 270336
    buffer_load_dwordx4 v15, s[52:55], s4 offen lds
    s_add_u32 m0, s91, 28672
    s_add_u32 s4, s89, 458752
    buffer_load_dwordx4 v15, s[52:55], s4 offen lds
    s_add_u32 m0, s91, 29696
    s_add_u32 s4, s89, 466944
    buffer_load_dwordx4 v15, s[52:55], s4 offen lds
    s_waitcnt vmcnt(16) lgkmcnt(0)
    s_barrier
    s_add_u32 m0, s91, 36864
    s_add_u32 s4, s89, 589824
    buffer_load_dwordx4 v15, s[52:55], s4 offen lds
    s_add_u32 m0, s91, 37888
    s_add_u32 s4, s89, 598016
    buffer_load_dwordx4 v15, s[52:55], s4 offen lds
    s_add_u32 m0, s91, 45056
    s_add_u32 s4, s89, 720896
    buffer_load_dwordx4 v15, s[52:55], s4 offen lds
    s_add_u32 m0, s91, 46080
    s_add_u32 s4, s89, 729088
    buffer_load_dwordx4 v15, s[52:55], s4 offen lds
    s_add_u32 m0, s91, 110592
    s_add_u32 s4, s89, 917504
    buffer_load_dwordx4 v15, s[52:55], s4 offen lds
    s_add_u32 m0, s91, 111616
    s_add_u32 s4, s89, 925696
    buffer_load_dwordx4 v15, s[52:55], s4 offen lds
    s_add_u32 m0, s91, 135168
    s_add_u32 s4, s89, 1048576
    buffer_load_dwordx4 v15, s[52:55], s4 offen lds
    s_add_u32 m0, s91, 136192
    s_add_u32 s4, s89, 1056768
    buffer_load_dwordx4 v15, s[52:55], s4 offen lds
    s_waitcnt vmcnt(16)
    s_barrier
    s_add_u32 m0, s91, 86016
    s_add_u32 s4, s89, 1179648
    buffer_load_dwordx4 v15, s[52:55], s4 offen lds
    s_add_u32 m0, s91, 87040
    s_add_u32 s4, s89, 1187840
    buffer_load_dwordx4 v15, s[52:55], s4 offen lds
    s_add_u32 m0, s91, 94208
    s_add_u32 s4, s89, 1376256
    buffer_load_dwordx4 v15, s[52:55], s4 offen lds
    s_add_u32 m0, s91, 95232
    s_add_u32 s4, s89, 1384448
    buffer_load_dwordx4 v15, s[52:55], s4 offen lds
    s_add_u32 m0, s91, 118784
    s_add_u32 s4, s89, 1507328
    buffer_load_dwordx4 v15, s[52:55], s4 offen lds
    s_add_u32 m0, s91, 119808
    s_add_u32 s4, s89, 1515520
    buffer_load_dwordx4 v15, s[52:55], s4 offen lds
    s_add_u32 m0, s91, 143360
    s_add_u32 s4, s89, 1638400
    buffer_load_dwordx4 v15, s[52:55], s4 offen lds
    s_add_u32 m0, s91, 144384
    s_add_u32 s4, s89, 1646592
    buffer_load_dwordx4 v15, s[52:55], s4 offen lds
    s_waitcnt vmcnt(20)
    s_barrier
    s_add_u32 m0, s91, 53248
    s_add_u32 s4, s90, 0
    buffer_load_dwordx4 v28, s[56:59], s4 offen lds
    s_add_u32 m0, s91, 54272
    s_add_u32 s4, s90, 8192
    buffer_load_dwordx4 v29, s[56:59], s4 offen lds
    s_add_u32 m0, s91, 61440
    s_add_u32 s4, s90, 0
    buffer_load_dwordx4 v28, s[60:63], s4 offen lds
    s_add_u32 m0, s91, 62464
    s_add_u32 s4, s90, 8192
    buffer_load_dwordx4 v29, s[60:63], s4 offen lds
    s_add_u32 m0, s91, 102400
    s_add_u32 s4, s90, 128
    buffer_load_dwordx4 v28, s[56:59], s4 offen lds
    s_add_u32 m0, s91, 103424
    s_add_u32 s4, s90, 8320
    buffer_load_dwordx4 v29, s[56:59], s4 offen lds
    s_add_u32 m0, s91, 126976
    s_add_u32 s4, s90, 128
    buffer_load_dwordx4 v28, s[60:63], s4 offen lds
    s_add_u32 m0, s91, 128000
    s_add_u32 s4, s90, 8320
    buffer_load_dwordx4 v29, s[60:63], s4 offen lds
    s_waitcnt vmcnt(24)
    s_barrier
    s_add_u32 m0, s91, 69632
    s_add_u32 s4, s90, 256
    buffer_load_dwordx4 v28, s[56:59], s4 offen lds
    s_add_u32 m0, s91, 70656
    s_add_u32 s4, s90, 8448
    buffer_load_dwordx4 v29, s[56:59], s4 offen lds
    s_add_u32 m0, s91, 77824
    s_add_u32 s4, s90, 256
    buffer_load_dwordx4 v28, s[60:63], s4 offen lds
    s_add_u32 m0, s91, 78848
    s_add_u32 s4, s90, 8448
    buffer_load_dwordx4 v29, s[60:63], s4 offen lds
    s_waitcnt vmcnt(24)
    s_barrier
    s_add_u32 m0, s91, 4096
    s_add_u32 s4, s90, 384
    buffer_load_dwordx4 v28, s[56:59], s4 offen lds
    s_add_u32 m0, s91, 5120
    s_add_u32 s4, s90, 8576
    buffer_load_dwordx4 v29, s[56:59], s4 offen lds
    s_add_u32 m0, s91, 12288
    s_add_u32 s4, s90, 384
    buffer_load_dwordx4 v28, s[60:63], s4 offen lds
    s_add_u32 m0, s91, 13312
    s_add_u32 s4, s90, 8576
    buffer_load_dwordx4 v29, s[60:63], s4 offen lds
    s_waitcnt vmcnt(24)
    s_barrier
    s_add_u32 m0, s91, 20480
    s_add_u32 s4, s90, 512
    buffer_load_dwordx4 v28, s[56:59], s4 offen lds
    s_add_u32 m0, s91, 21504
    s_add_u32 s4, s90, 8704
    buffer_load_dwordx4 v29, s[56:59], s4 offen lds
    s_add_u32 m0, s91, 28672
    s_add_u32 s4, s90, 512
    buffer_load_dwordx4 v28, s[60:63], s4 offen lds
    s_add_u32 m0, s91, 29696
    s_add_u32 s4, s90, 8704
    buffer_load_dwordx4 v29, s[60:63], s4 offen lds
    s_waitcnt vmcnt(24)
    s_barrier
    s_add_u32 m0, s91, 36864
    s_add_u32 s4, s90, 640
    buffer_load_dwordx4 v28, s[56:59], s4 offen lds
    s_add_u32 m0, s91, 37888
    s_add_u32 s4, s90, 8832
    buffer_load_dwordx4 v29, s[56:59], s4 offen lds
    s_add_u32 m0, s91, 45056
    s_add_u32 s4, s90, 640
    buffer_load_dwordx4 v28, s[60:63], s4 offen lds
    s_add_u32 m0, s91, 46080
    s_add_u32 s4, s90, 8832
    buffer_load_dwordx4 v29, s[60:63], s4 offen lds
    s_waitcnt vmcnt(24)
    s_barrier
    s_add_u32 m0, s91, 110592
    s_add_u32 s4, s90, 768
    buffer_load_dwordx4 v28, s[56:59], s4 offen lds
    s_add_u32 m0, s91, 111616
    s_add_u32 s4, s90, 8960
    buffer_load_dwordx4 v29, s[56:59], s4 offen lds
    s_add_u32 m0, s91, 135168
    s_add_u32 s4, s90, 768
    buffer_load_dwordx4 v28, s[60:63], s4 offen lds
    s_add_u32 m0, s91, 136192
    s_add_u32 s4, s90, 8960
    buffer_load_dwordx4 v29, s[60:63], s4 offen lds
    s_waitcnt vmcnt(24)
    s_barrier
    s_add_u32 m0, s91, 86016
    s_add_u32 s4, s90, 896
    buffer_load_dwordx4 v28, s[56:59], s4 offen lds
    s_add_u32 m0, s91, 87040
    s_add_u32 s4, s90, 9088
    buffer_load_dwordx4 v29, s[56:59], s4 offen lds
    s_add_u32 m0, s91, 94208
    s_add_u32 s4, s90, 896
    buffer_load_dwordx4 v28, s[60:63], s4 offen lds
    s_add_u32 m0, s91, 95232
    s_add_u32 s4, s90, 9088
    buffer_load_dwordx4 v29, s[60:63], s4 offen lds
    s_waitcnt vmcnt(24)
    s_barrier
    s_add_u32 m0, s91, 118784
    s_add_u32 s4, s89, 65536
    buffer_load_dwordx4 v15, s[52:55], s4 offen lds
    s_add_u32 m0, s91, 119808
    s_add_u32 s4, s89, 73728
    buffer_load_dwordx4 v15, s[52:55], s4 offen lds
    s_add_u32 m0, s91, 143360
    s_add_u32 s4, s89, 196608
    buffer_load_dwordx4 v15, s[52:55], s4 offen lds
    s_add_u32 m0, s91, 144384
    s_add_u32 s4, s89, 204800
    buffer_load_dwordx4 v15, s[52:55], s4 offen lds
    s_waitcnt vmcnt(24)
    s_barrier
    s_add_u32 m0, s91, 53248
    s_add_u32 s4, s89, 327680
    buffer_load_dwordx4 v15, s[52:55], s4 offen lds
    s_add_u32 m0, s91, 54272
    s_add_u32 s4, s89, 335872
    buffer_load_dwordx4 v15, s[52:55], s4 offen lds
    s_add_u32 m0, s91, 61440
    s_add_u32 s4, s89, 393216
    buffer_load_dwordx4 v15, s[52:55], s4 offen lds
    s_add_u32 m0, s91, 62464
    s_add_u32 s4, s89, 401408
    buffer_load_dwordx4 v15, s[52:55], s4 offen lds
    s_waitcnt vmcnt(24)
    s_barrier
    s_add_u32 m0, s91, 102400
    s_add_u32 s4, s89, 524288
    buffer_load_dwordx4 v15, s[52:55], s4 offen lds
    s_add_u32 m0, s91, 103424
    s_add_u32 s4, s89, 532480
    buffer_load_dwordx4 v15, s[52:55], s4 offen lds
    s_add_u32 m0, s91, 126976
    s_add_u32 s4, s89, 655360
    buffer_load_dwordx4 v15, s[52:55], s4 offen lds
    s_add_u32 m0, s91, 128000
    s_add_u32 s4, s89, 663552
    buffer_load_dwordx4 v15, s[52:55], s4 offen lds
    s_waitcnt vmcnt(24)
    s_barrier
    s_add_u32 m0, s91, 69632
    s_add_u32 s4, s89, 786432
    buffer_load_dwordx4 v15, s[52:55], s4 offen lds
    s_add_u32 m0, s91, 70656
    s_add_u32 s4, s89, 794624
    buffer_load_dwordx4 v15, s[52:55], s4 offen lds
    s_add_u32 m0, s91, 77824
    s_add_u32 s4, s89, 851968
    buffer_load_dwordx4 v15, s[52:55], s4 offen lds
    s_add_u32 m0, s91, 78848
    s_add_u32 s4, s89, 860160
    buffer_load_dwordx4 v15, s[52:55], s4 offen lds
    s_waitcnt vmcnt(24)
    s_barrier
    s_add_u32 m0, s91, 4096
    s_add_u32 s4, s89, 983040
    buffer_load_dwordx4 v15, s[52:55], s4 offen lds
    s_add_u32 m0, s91, 5120
    s_add_u32 s4, s89, 991232
    buffer_load_dwordx4 v15, s[52:55], s4 offen lds
    s_add_u32 m0, s91, 12288
    s_add_u32 s4, s89, 1114112
    buffer_load_dwordx4 v15, s[52:55], s4 offen lds
    s_add_u32 m0, s91, 13312
    s_add_u32 s4, s89, 1122304
    buffer_load_dwordx4 v15, s[52:55], s4 offen lds
    s_waitcnt vmcnt(24)
    s_barrier
    s_add_u32 m0, s91, 20480
    s_add_u32 s4, s89, 1245184
    buffer_load_dwordx4 v15, s[52:55], s4 offen lds
    s_add_u32 m0, s91, 21504
    s_add_u32 s4, s89, 1253376
    buffer_load_dwordx4 v15, s[52:55], s4 offen lds
    s_add_u32 m0, s91, 28672
    s_add_u32 s4, s89, 1310720
    buffer_load_dwordx4 v15, s[52:55], s4 offen lds
    s_add_u32 m0, s91, 29696
    s_add_u32 s4, s89, 1318912
    buffer_load_dwordx4 v15, s[52:55], s4 offen lds
    s_waitcnt vmcnt(24)
    s_barrier
    s_add_u32 m0, s91, 36864
    s_add_u32 s4, s89, 1441792
    buffer_load_dwordx4 v15, s[52:55], s4 offen lds
    s_add_u32 m0, s91, 37888
    s_add_u32 s4, s89, 1449984
    buffer_load_dwordx4 v15, s[52:55], s4 offen lds
    s_add_u32 m0, s91, 45056
    s_add_u32 s4, s89, 1572864
    buffer_load_dwordx4 v15, s[52:55], s4 offen lds
    s_add_u32 m0, s91, 46080
    s_add_u32 s4, s89, 1581056
    buffer_load_dwordx4 v15, s[52:55], s4 offen lds
    s_waitcnt vmcnt(24)
    s_barrier
    s_add_u32 m0, s91, 110592
    s_add_u32 s4, s89, 1703936
    buffer_load_dwordx4 v15, s[52:55], s4 offen lds
    s_add_u32 m0, s91, 111616
    s_add_u32 s4, s89, 1712128
    buffer_load_dwordx4 v15, s[52:55], s4 offen lds
    s_add_u32 m0, s91, 135168
    s_add_u32 s4, s89, 1769472
    buffer_load_dwordx4 v15, s[52:55], s4 offen lds
    s_add_u32 m0, s91, 136192
    s_add_u32 s4, s89, 1777664
    buffer_load_dwordx4 v15, s[52:55], s4 offen lds
    s_waitcnt vmcnt(24)
    s_barrier
    s_waitcnt vmcnt(20)
    s_barrier
    s_waitcnt vmcnt(16)
    s_barrier
    s_waitcnt vmcnt(12)
    s_barrier
    s_waitcnt vmcnt(8)
    s_barrier
    s_waitcnt vmcnt(4)
    s_barrier
    s_waitcnt vmcnt(0)
    s_barrier
    s_barrier
    s_endpgm
L_2:
    s_cmp_lg_u32 s3, 3
    s_cbranch_scc1 L_23
    s_mov_b32 s4, L_code_end - gated_mix__ssm_conv_s5__glu_gated_glu__prompt_kernel - 8
    v_lshlrev_b32 v1, 7, v0
    s_lshr_b32 s5, s2, 3
    s_and_b32 s5, s5, 7
    s_lshl_b32 s5, s5, 13
    v_add_u32 v2, s5, v1
    v_min_u32 v2, s4, v2
    global_load_dword v8, v2, s[90:91]
L_23:
    s_waitcnt lgkmcnt(0)
    s_mov_b32 s64, s48
    s_mov_b32 s65, s49
    s_mov_b32 s66, 11796480
    s_mov_b32 s67, 0x20000
    s_cmp_lg_u32 s3, 0
    s_cbranch_scc1 L_25
    s_mov_b32 s60, s46
    s_mov_b32 s61, s47
    s_mov_b32 s62, 256
    s_mov_b32 s63, 0x20000
    s_memrealtime s[14:15]
    v_mov_b32 v9, 0
    v_mov_b32 v11, 0
    s_waitcnt lgkmcnt(0)
    s_or_b32 s14, s14, 1
    v_mov_b32 v10, s14
    s_mov_b64 exec, 1
    buffer_atomic_cmpswap v[10:11], v9, s[60:63], 0 offen sc0
    s_mov_b64 exec, -1
L_25:
    s_cmp_lg_u32 s3, 1
    s_cbranch_scc1 L_28
    s_mov_b32 s52, s16
    s_mov_b32 s53, s17
    s_mov_b32 s54, 2097152
    s_mov_b32 s55, 0x20000
    s_mov_b32 s56, s36
    s_mov_b32 s57, s37
    s_mov_b32 s58, 1835008
    s_mov_b32 s59, 0x20000
    s_mov_b32 s60, s38
    s_mov_b32 s61, s39
    s_mov_b32 s62, 1835008
    s_mov_b32 s63, 0x20000
    v_and_b32 v1, 7, v0
    v_min_u32 v1, 2, v1
    v_lshlrev_b32 v1, 7, v1
    v_lshrrev_b32 v2, 3, v0
    v_lshl_add_u32 v1, v2, 10, v1
    s_lshl_b32 s4, s2, 13
    s_add_u32 s4, s4, 128
    buffer_load_dword v8, v1, s[52:55], s4 offen
    v_min_u32 v1, 20, v0
    v_lshlrev_b32 v1, 7, v1
    s_mul_i32 s4, s2, 2688
    s_add_u32 s4, s4, 229376
    buffer_load_dword v8, v1, s[56:59], s4 offen
    buffer_load_dword v8, v1, s[60:63], s4 offen
L_28:
    s_cmp_lg_u32 s3, 2
    s_cbranch_scc1 L_29
    s_mov_b32 s52, s22
    s_mov_b32 s53, s23
    s_mov_b32 s54, 524288
    s_mov_b32 s55, 0x20000
    s_mov_b32 s56, s24
    s_mov_b32 s57, s25
    s_mov_b32 s58, 524288
    s_mov_b32 s59, 0x20000
    v_and_b32 v1, 15, v0
    v_lshlrev_b32 v1, 7, v1
    s_lshl_b32 s4, s2, 11
    buffer_load_dword v8, v1, s[52:55], s4 offen
    buffer_load_dword v8, v1, s[56:59], s4 offen
L_29:
    v_bfe_u32 v1, v0, 2, 2
    v_and_b32 v2, 3, v0
    v_lshl_add_u32 v3, v1, 3, v2
    v_and_b32 v4, 2, v0
    v_bfe_u32 v5, v0, 3, 1
    v_lshl_or_b32 v4, v5, 2, v4
    v_lshrrev_b32 v5, 4, v0
    v_xor_b32 v4, v4, v5
    v_lshlrev_b32 v4, 4, v4
    v_lshl_add_u32 v24, v3, 7, v4
    s_lshl_b32 s4, s3, 12
    v_add_u32 v24, s4, v24
    v_xor_b32 v25, 64, v24
    v_xor_b32 v26, 16, v24
    v_add_u32 v26, 512, v26
    v_xor_b32 v27, 64, v26
    v_and_b32 v3, 15, v0
    v_lshrrev_b32 v4, 1, v3
    v_xor_b32 v4, v4, v5
    v_lshlrev_b32 v4, 4, v4
    v_lshl_add_u32 v28, v3, 7, v4
    v_add_u32 v28, 151552, v28
    v_xor_b32 v29, 64, v28
    s_lshr_b32 s4, s3, 1
    s_lshl_b32 s4, s4, 13
    s_and_b32 s51, s3, 1
    v_and_b32 v1, 31, v0
    v_bfe_u32 v2, v1, 2, 1
    v_and_b32 v3, 2, v1
    v_or_b32 v2, v2, v3
    v_bfe_u32 v3, v1, 4, 1
    v_lshl_or_b32 v2, v3, 2, v2
    v_lshrrev_b32 v3, 5, v0
    v_xor_b32 v2, v2, v3
    v_lshlrev_b32 v2, 4, v2
    v_lshl_add_u32 v16, v1, 7, v2
    v_add_u32 v16, s4, v16
    v_xor_b32 v17, 32, v16
    v_xor_b32 v18, 64, v16
    v_xor_b32 v19, 96, v16
    v_bfe_u32 v1, v0, 2, 1
    v_lshlrev_b32 v1, 5, v1
    v_and_b32 v2, 1, v0
    v_lshl_or_b32 v1, v2, 4, v1
    v_bfe_u32 v2, v0, 3, 2
    v_lshl_or_b32 v1, v2, 1, v1
    v_bfe_u32 v2, v0, 1, 1
    v_or_b32 v1, v1, v2
    v_bfe_u32 v2, v1, 2, 1
    v_and_b32 v3, 2, v1
    v_or_b32 v2, v2, v3
    v_bfe_u32 v3, v1, 4, 1
    v_lshl_or_b32 v2, v3, 2, v2
    v_lshrrev_b32 v3, 5, v0
    v_xor_b32 v2, v2, v3
    v_lshlrev_b32 v2, 4, v2
    v_lshl_add_u32 v12, v1, 7, v2
    v_add_u32 v12, s4, v12
    v_xor_b32 v13, 32, v12
    v_xor_b32 v14, 64, v12
    v_xor_b32 v15, 96, v12
    v_lshrrev_b32 v1, 5, v0
    v_lshlrev_b32 v1, 3, v1
    v_bfe_u32 v2, v0, 2, 2
    v_add_u32 v1, v1, v2
    v_bfe_u32 v2, v0, 4, 1
    v_lshlrev_b32 v2, 5, v2
    v_and_b32 v3, 3, v0
    v_lshl_add_u32 v2, v3, 3, v2
    v_bfe_u32 v3, v0, 3, 1
    v_lshlrev_b32 v3, 6, v3
    v_xor_b32 v2, v2, v3
    s_lshl_b32 s5, s51, 6
    v_xor_b32 v2, s5, v2
    v_lshl_add_u32 v30, v1, 7, v2
    v_add_u32 v30, 102400, v30
    s_lshl_b32 s5, s51, 12
    s_add_u32 s5, s5, 102400
    v_and_b32 v1, 31, v0
    v_bfe_u32 v2, v0, 1, 3
    v_lshrrev_b32 v3, 5, v0
    v_xor_b32 v2, v2, v3
    v_lshlrev_b32 v2, 4, v2
    v_lshl_add_u32 v20, v1, 7, v2
    v_add_u32 v20, s5, v20
    v_xor_b32 v21, 32, v20
    v_xor_b32 v22, 64, v20
    v_xor_b32 v23, 96, v20
    v_lshlrev_b32 v6, 4, v0
    s_lshl_b32 s81, s6, 10
    s_lshl_b32 s4, s13, 4
    s_add_u32 s81, s81, s4
    s_lshl_b32 s4, s3, 2
    s_add_u32 s81, s81, s4
    s_add_u32 s81, s81, 11730944
    s_lshr_b32 s4, s3, 1
    s_lshl_b32 s4, s4, 1
    s_lshl_b32 s5, s6, 2
    s_add_u32 s4, s4, s5
    s_mul_i32 s79, s4, 176
    s_lshl_b32 s5, s51, 1
    s_add_u32 s4, s79, s5
    s_lshr_b32 s5, s9, 4
    s_add_u32 s4, s4, s5
    s_lshl_b32 s78, s4, 10
    s_xor_b32 s5, s12, 1
    s_lshl_b32 s5, s5, 12
    s_add_u32 s77, s78, s5
    s_lshl_b32 s5, s8, 4
    s_add_u32 s4, s79, s5
    s_add_u32 s4, s4, 120
    s_lshl_b32 s5, s51, 1
    s_add_u32 s4, s4, s5
    s_lshl_b32 s80, s4, 10
    s_lshl_b32 s4, s6, 2
    s_add_u32 s4, s4, s3
    s_mul_i32 s4, s4, 176
    s_lshl_b32 s5, s8, 4
    s_add_u32 s4, s4, s5
    s_add_u32 s4, s4, s7
    s_add_u32 s4, s4, 112
    s_lshl_b32 s82, s4, 10
    s_add_u32 s83, s82, 4096
    s_mov_b32 s50, 3216550459
    s_mov_b32 s51, 3216550459
    s_cmp_eq_u32 s12, 1
    s_cbranch_scc1 L_3
    s_barrier
    ds_read_b128 v[176:179], v16 offset:4096
    ds_read_b64_tr_b16 v[184:185], v30 offset:0
    ds_read_b64_tr_b16 v[186:187], v30 offset:512
    ds_read_b128 v[180:183], v16 offset:8192
    ds_read_b64_tr_b16 v[188:189], v30 offset:24576
    ds_read_b64_tr_b16 v[190:191], v30 offset:25088
    s_waitcnt lgkmcnt(3)
    v_mfma_f32_32x32x16_bf16 v[32:47], v[184:187], v[176:179], 0
    ds_read_b128 v[192:195], v17 offset:4096
    ds_read_b64_tr_b16 v[200:201], v30 offset:2048
    s_waitcnt lgkmcnt(4)
    v_mfma_f32_32x32x16_bf16 v[48:63], v[184:187], v[180:183], 0
    ds_read_b64_tr_b16 v[202:203], v30 offset:2560
    ds_read_b128 v[196:199], v17 offset:8192
    s_waitcnt lgkmcnt(4)
    v_mfma_f32_32x32x16_bf16 v[64:79], v[188:191], v[176:179], 0
    ds_read_b64_tr_b16 v[204:205], v30 offset:26624
    ds_read_b64_tr_b16 v[206:207], v30 offset:27136
    v_mfma_f32_32x32x16_bf16 v[80:95], v[188:191], v[180:183], 0
    ds_read_b128 v[208:211], v24 offset:4096
    ds_read_b128 v[212:215], v26 offset:4096
    ds_read_b128 v[216:219], v28 offset:0
    ds_read_b128 v[220:223], v28 offset:2048
    s_waitcnt lgkmcnt(7)
    v_mfma_f32_32x32x16_bf16 v[32:47], v[200:203], v[192:195], v[32:47]
    ds_read_b128 v[176:179], v18 offset:4096
    ds_read_b64_tr_b16 v[184:185], v30 offset:4096
    s_waitcnt lgkmcnt(8)
    v_mfma_f32_32x32x16_bf16 v[48:63], v[200:203], v[196:199], v[48:63]
    ds_read_b64_tr_b16 v[186:187], v30 offset:4608
    ds_read_b128 v[180:183], v18 offset:8192
    s_waitcnt lgkmcnt(5)
    v_mfma_f32_16x16x32_bf16 v[160:163], v[208:211], v[216:219], 0
    ds_read_b64_tr_b16 v[188:189], v30 offset:28672
    ds_read_b64_tr_b16 v[190:191], v30 offset:29184
    v_mfma_f32_16x16x32_bf16 v[164:167], v[212:215], v[216:219], 0
    s_waitcnt lgkmcnt(6)
    v_mfma_f32_16x16x32_bf16 v[168:171], v[208:211], v[220:223], 0
    v_mfma_f32_16x16x32_bf16 v[172:175], v[212:215], v[220:223], 0
    v_mfma_f32_32x32x16_bf16 v[64:79], v[204:207], v[192:195], v[64:79]
    v_mfma_f32_32x32x16_bf16 v[80:95], v[204:207], v[196:199], v[80:95]
    s_waitcnt lgkmcnt(3)
    v_mfma_f32_32x32x16_bf16 v[32:47], v[184:187], v[176:179], v[32:47]
    ds_read_b128 v[192:195], v19 offset:4096
    ds_read_b64_tr_b16 v[200:201], v30 offset:6144
    s_waitcnt lgkmcnt(4)
    v_mfma_f32_32x32x16_bf16 v[48:63], v[184:187], v[180:183], v[48:63]
    ds_read_b64_tr_b16 v[202:203], v30 offset:6656
    ds_read_b128 v[196:199], v19 offset:8192
    s_waitcnt lgkmcnt(4)
    v_mfma_f32_32x32x16_bf16 v[64:79], v[188:191], v[176:179], v[64:79]
    ds_read_b64_tr_b16 v[204:205], v30 offset:30720
    ds_read_b64_tr_b16 v[206:207], v30 offset:31232
    v_mfma_f32_32x32x16_bf16 v[80:95], v[188:191], v[180:183], v[80:95]
    ds_read_b128 v[208:211], v25 offset:4096
    ds_read_b128 v[212:215], v27 offset:4096
    ds_read_b128 v[216:219], v29 offset:0
    ds_read_b128 v[220:223], v29 offset:2048
    s_waitcnt lgkmcnt(0)
    s_barrier
    v_mfma_f32_32x32x16_bf16 v[32:47], v[200:203], v[192:195], v[32:47]
    ds_read_b128 v[176:179], v16 offset:20480
    ds_read_b64_tr_b16 v[184:185], v30 offset:8192
    v_mfma_f32_32x32x16_bf16 v[48:63], v[200:203], v[196:199], v[48:63]
    ds_read_b64_tr_b16 v[186:187], v30 offset:8704
    ds_read_b128 v[180:183], v16 offset:24576
    v_mfma_f32_16x16x32_bf16 v[160:163], v[208:211], v[216:219], v[160:163]
    ds_read_b64_tr_b16 v[188:189], v30 offset:32768
    ds_read_b64_tr_b16 v[190:191], v30 offset:33280
    v_mfma_f32_16x16x32_bf16 v[164:167], v[212:215], v[216:219], v[164:167]
    v_mfma_f32_16x16x32_bf16 v[168:171], v[208:211], v[220:223], v[168:171]
    v_mfma_f32_16x16x32_bf16 v[172:175], v[212:215], v[220:223], v[172:175]
    v_mfma_f32_32x32x16_bf16 v[64:79], v[204:207], v[192:195], v[64:79]
    v_mfma_f32_32x32x16_bf16 v[80:95], v[204:207], v[196:199], v[80:95]
    s_waitcnt lgkmcnt(3)
    v_mfma_f32_32x32x16_bf16 v[32:47], v[184:187], v[176:179], v[32:47]
    ds_read_b128 v[192:195], v17 offset:20480
    ds_read_b64_tr_b16 v[200:201], v30 offset:10240
    s_waitcnt lgkmcnt(4)
    v_mfma_f32_32x32x16_bf16 v[48:63], v[184:187], v[180:183], v[48:63]
    ds_read_b64_tr_b16 v[202:203], v30 offset:10752
    ds_read_b128 v[196:199], v17 offset:24576
    s_waitcnt lgkmcnt(4)
    v_mfma_f32_32x32x16_bf16 v[64:79], v[188:191], v[176:179], v[64:79]
    ds_read_b64_tr_b16 v[204:205], v30 offset:34816
    ds_read_b64_tr_b16 v[206:207], v30 offset:35328
    v_mfma_f32_32x32x16_bf16 v[80:95], v[188:191], v[180:183], v[80:95]
    ds_read_b128 v[208:211], v24 offset:20480
    ds_read_b128 v[212:215], v26 offset:20480
    ds_read_b128 v[216:219], v28 offset:4096
    ds_read_b128 v[220:223], v28 offset:6144
    s_waitcnt lgkmcnt(7)
    v_mfma_f32_32x32x16_bf16 v[32:47], v[200:203], v[192:195], v[32:47]
    ds_read_b128 v[176:179], v18 offset:20480
    ds_read_b64_tr_b16 v[184:185], v30 offset:12288
    s_waitcnt lgkmcnt(8)
    v_mfma_f32_32x32x16_bf16 v[48:63], v[200:203], v[196:199], v[48:63]
    ds_read_b64_tr_b16 v[186:187], v30 offset:12800
    ds_read_b128 v[180:183], v18 offset:24576
    s_waitcnt lgkmcnt(5)
    v_mfma_f32_16x16x32_bf16 v[160:163], v[208:211], v[216:219], v[160:163]
    ds_read_b64_tr_b16 v[188:189], v30 offset:36864
    ds_read_b64_tr_b16 v[190:191], v30 offset:37376
    v_mfma_f32_16x16x32_bf16 v[164:167], v[212:215], v[216:219], v[164:167]
    s_waitcnt lgkmcnt(6)
    v_mfma_f32_16x16x32_bf16 v[168:171], v[208:211], v[220:223], v[168:171]
    v_mfma_f32_16x16x32_bf16 v[172:175], v[212:215], v[220:223], v[172:175]
    v_mfma_f32_32x32x16_bf16 v[64:79], v[204:207], v[192:195], v[64:79]
    v_mfma_f32_32x32x16_bf16 v[80:95], v[204:207], v[196:199], v[80:95]
    s_waitcnt lgkmcnt(3)
    v_mfma_f32_32x32x16_bf16 v[32:47], v[184:187], v[176:179], v[32:47]
    ds_read_b128 v[192:195], v19 offset:20480
    ds_read_b64_tr_b16 v[200:201], v30 offset:14336
    s_waitcnt lgkmcnt(4)
    v_mfma_f32_32x32x16_bf16 v[48:63], v[184:187], v[180:183], v[48:63]
    ds_read_b64_tr_b16 v[202:203], v30 offset:14848
    ds_read_b128 v[196:199], v19 offset:24576
    s_waitcnt lgkmcnt(4)
    v_mfma_f32_32x32x16_bf16 v[64:79], v[188:191], v[176:179], v[64:79]
    ds_read_b64_tr_b16 v[204:205], v30 offset:38912
    ds_read_b64_tr_b16 v[206:207], v30 offset:39424
    v_mfma_f32_32x32x16_bf16 v[80:95], v[188:191], v[180:183], v[80:95]
    ds_read_b128 v[208:211], v25 offset:20480
    ds_read_b128 v[212:215], v27 offset:20480
    ds_read_b128 v[216:219], v29 offset:4096
    ds_read_b128 v[220:223], v29 offset:6144
    s_waitcnt lgkmcnt(0)
    s_barrier
    v_mfma_f32_32x32x16_bf16 v[32:47], v[200:203], v[192:195], v[32:47]
    ds_read_b128 v[176:179], v16 offset:36864
    ds_read_b64_tr_b16 v[184:185], v30 offset:16384
    v_mfma_f32_32x32x16_bf16 v[48:63], v[200:203], v[196:199], v[48:63]
    ds_read_b64_tr_b16 v[186:187], v30 offset:16896
    ds_read_b128 v[180:183], v16 offset:40960
    v_mfma_f32_16x16x32_bf16 v[160:163], v[208:211], v[216:219], v[160:163]
    ds_read_b64_tr_b16 v[188:189], v30 offset:40960
    ds_read_b64_tr_b16 v[190:191], v30 offset:41472
    v_mfma_f32_16x16x32_bf16 v[164:167], v[212:215], v[216:219], v[164:167]
    v_mfma_f32_16x16x32_bf16 v[168:171], v[208:211], v[220:223], v[168:171]
    v_mfma_f32_16x16x32_bf16 v[172:175], v[212:215], v[220:223], v[172:175]
    v_mfma_f32_32x32x16_bf16 v[64:79], v[204:207], v[192:195], v[64:79]
    v_mfma_f32_32x32x16_bf16 v[80:95], v[204:207], v[196:199], v[80:95]
    s_waitcnt lgkmcnt(3)
    v_mfma_f32_32x32x16_bf16 v[32:47], v[184:187], v[176:179], v[32:47]
    ds_read_b128 v[192:195], v17 offset:36864
    ds_read_b64_tr_b16 v[200:201], v30 offset:18432
    s_waitcnt lgkmcnt(4)
    v_mfma_f32_32x32x16_bf16 v[48:63], v[184:187], v[180:183], v[48:63]
    ds_read_b64_tr_b16 v[202:203], v30 offset:18944
    ds_read_b128 v[196:199], v17 offset:40960
    s_waitcnt lgkmcnt(4)
    v_mfma_f32_32x32x16_bf16 v[64:79], v[188:191], v[176:179], v[64:79]
    ds_read_b64_tr_b16 v[204:205], v30 offset:43008
    ds_read_b64_tr_b16 v[206:207], v30 offset:43520
    v_mfma_f32_32x32x16_bf16 v[80:95], v[188:191], v[180:183], v[80:95]
    ds_read_b128 v[208:211], v24 offset:36864
    ds_read_b128 v[212:215], v26 offset:36864
    ds_read_b128 v[216:219], v28 offset:8192
    ds_read_b128 v[220:223], v28 offset:10240
    s_waitcnt lgkmcnt(7)
    v_mfma_f32_32x32x16_bf16 v[32:47], v[200:203], v[192:195], v[32:47]
    ds_read_b128 v[176:179], v18 offset:36864
    ds_read_b64_tr_b16 v[184:185], v30 offset:20480
    s_waitcnt lgkmcnt(8)
    v_mfma_f32_32x32x16_bf16 v[48:63], v[200:203], v[196:199], v[48:63]
    ds_read_b64_tr_b16 v[186:187], v30 offset:20992
    ds_read_b128 v[180:183], v18 offset:40960
    s_waitcnt lgkmcnt(5)
    v_mfma_f32_16x16x32_bf16 v[160:163], v[208:211], v[216:219], v[160:163]
    ds_read_b64_tr_b16 v[188:189], v30 offset:45056
    ds_read_b64_tr_b16 v[190:191], v30 offset:45568
    v_mfma_f32_16x16x32_bf16 v[164:167], v[212:215], v[216:219], v[164:167]
    s_waitcnt lgkmcnt(6)
    v_mfma_f32_16x16x32_bf16 v[168:171], v[208:211], v[220:223], v[168:171]
    v_mfma_f32_16x16x32_bf16 v[172:175], v[212:215], v[220:223], v[172:175]
    v_mfma_f32_32x32x16_bf16 v[64:79], v[204:207], v[192:195], v[64:79]
    v_mfma_f32_32x32x16_bf16 v[80:95], v[204:207], v[196:199], v[80:95]
    s_waitcnt lgkmcnt(3)
    v_mfma_f32_32x32x16_bf16 v[32:47], v[184:187], v[176:179], v[32:47]
    ds_read_b128 v[192:195], v19 offset:36864
    ds_read_b64_tr_b16 v[200:201], v30 offset:22528
    s_waitcnt lgkmcnt(4)
    v_mfma_f32_32x32x16_bf16 v[48:63], v[184:187], v[180:183], v[48:63]
    ds_read_b64_tr_b16 v[202:203], v30 offset:23040
    ds_read_b128 v[196:199], v19 offset:40960
    s_waitcnt lgkmcnt(4)
    v_mfma_f32_32x32x16_bf16 v[64:79], v[188:191], v[176:179], v[64:79]
    ds_read_b64_tr_b16 v[204:205], v30 offset:47104
    ds_read_b64_tr_b16 v[206:207], v30 offset:47616
    v_mfma_f32_32x32x16_bf16 v[80:95], v[188:191], v[180:183], v[80:95]
    ds_read_b128 v[208:211], v25 offset:36864
    ds_read_b128 v[212:215], v27 offset:36864
    ds_read_b128 v[216:219], v29 offset:8192
    ds_read_b128 v[220:223], v29 offset:10240
    s_waitcnt lgkmcnt(0)
    s_barrier
    v_add_u32 v12, 49152, v12
    v_add_u32 v13, 49152, v13
    v_add_u32 v14, 49152, v14
    v_add_u32 v15, 49152, v15
    v_add_u32 v16, 49152, v16
    v_add_u32 v17, 49152, v17
    v_add_u32 v18, 49152, v18
    v_add_u32 v19, 49152, v19
    v_add_u32 v24, 49152, v24
    v_add_u32 v25, 49152, v25
    v_add_u32 v26, 49152, v26
    v_add_u32 v27, 49152, v27
    v_mfma_f32_32x32x16_bf16 v[32:47], v[200:203], v[192:195], v[32:47]
    ds_read_b128 v[176:179], v16 offset:4096
    ds_read_b64_tr_b16 v[184:185], v30 offset:0
    v_mfma_f32_32x32x16_bf16 v[48:63], v[200:203], v[196:199], v[48:63]
    ds_read_b64_tr_b16 v[186:187], v30 offset:512
    ds_read_b128 v[180:183], v16 offset:8192
    v_mfma_f32_16x16x32_bf16 v[160:163], v[208:211], v[216:219], v[160:163]
    ds_read_b64_tr_b16 v[188:189], v30 offset:24576
    ds_read_b64_tr_b16 v[190:191], v30 offset:25088
    v_mfma_f32_16x16x32_bf16 v[164:167], v[212:215], v[216:219], v[164:167]
    v_mfma_f32_16x16x32_bf16 v[168:171], v[208:211], v[220:223], v[168:171]
    v_mfma_f32_16x16x32_bf16 v[172:175], v[212:215], v[220:223], v[172:175]
    v_mfma_f32_32x32x16_bf16 v[64:79], v[204:207], v[192:195], v[64:79]
    v_mfma_f32_32x32x16_bf16 v[80:95], v[204:207], v[196:199], v[80:95]
    s_cmp_lg_u32 s3, 1
    s_cbranch_scc1 L_31
    s_mov_b32 s52, s16
    s_mov_b32 s53, s17
    s_mov_b32 s54, 2097152
    s_mov_b32 s55, 0x20000
    s_mov_b32 s56, s36
    s_mov_b32 s57, s37
    s_mov_b32 s58, 1835008
    s_mov_b32 s59, 0x20000
    v_and_b32 v1, 7, v0
    v_min_u32 v1, 3, v1
    v_lshlrev_b32 v1, 7, v1
    v_lshrrev_b32 v2, 3, v0
    v_lshl_add_u32 v1, v2, 10, v1
    s_lshl_b32 s4, s2, 13
    s_add_u32 s4, s4, 512
    buffer_load_dword v8, v1, s[52:55], s4 offen
    v_min_u32 v1, 27, v0
    v_lshlrev_b32 v1, 7, v1
    s_mul_i32 s4, s2, 3584
    s_add_u32 s4, s4, 917504
    buffer_load_dword v8, v1, s[56:59], s4 offen
    s_mov_b32 s60, s38
    s_mov_b32 s61, s39
    s_mov_b32 s62, 1835008
    s_mov_b32 s63, 0x20000
    buffer_load_dword v8, v1, s[60:63], s4 offen
L_31:
    s_waitcnt lgkmcnt(3)
    v_mfma_f32_32x32x16_bf16 v[32:47], v[184:187], v[176:179], v[32:47]
    ds_read_b128 v[192:195], v17 offset:4096
    ds_read_b64_tr_b16 v[200:201], v30 offset:2048
    s_waitcnt lgkmcnt(4)
    v_mfma_f32_32x32x16_bf16 v[48:63], v[184:187], v[180:183], v[48:63]
    ds_read_b64_tr_b16 v[202:203], v30 offset:2560
    ds_read_b128 v[196:199], v17 offset:8192
    s_waitcnt lgkmcnt(4)
    v_mfma_f32_32x32x16_bf16 v[64:79], v[188:191], v[176:179], v[64:79]
    ds_read_b64_tr_b16 v[204:205], v30 offset:26624
    ds_read_b64_tr_b16 v[206:207], v30 offset:27136
    v_mfma_f32_32x32x16_bf16 v[80:95], v[188:191], v[180:183], v[80:95]
    ds_read_b128 v[208:211], v24 offset:4096
    ds_read_b128 v[212:215], v26 offset:4096
    ds_read_b128 v[216:219], v28 offset:0
    ds_read_b128 v[220:223], v28 offset:2048
    s_waitcnt lgkmcnt(7)
    v_mfma_f32_32x32x16_bf16 v[32:47], v[200:203], v[192:195], v[32:47]
    ds_read_b128 v[176:179], v18 offset:4096
    ds_read_b64_tr_b16 v[184:185], v30 offset:4096
    s_waitcnt lgkmcnt(8)
    v_mfma_f32_32x32x16_bf16 v[48:63], v[200:203], v[196:199], v[48:63]
    ds_read_b64_tr_b16 v[186:187], v30 offset:4608
    ds_read_b128 v[180:183], v18 offset:8192
    s_waitcnt lgkmcnt(5)
    v_mfma_f32_16x16x32_bf16 v[160:163], v[208:211], v[216:219], v[160:163]
    ds_read_b64_tr_b16 v[188:189], v30 offset:28672
    ds_read_b64_tr_b16 v[190:191], v30 offset:29184
    v_mfma_f32_16x16x32_bf16 v[164:167], v[212:215], v[216:219], v[164:167]
    s_waitcnt lgkmcnt(6)
    v_mfma_f32_16x16x32_bf16 v[168:171], v[208:211], v[220:223], v[168:171]
    v_mfma_f32_16x16x32_bf16 v[172:175], v[212:215], v[220:223], v[172:175]
    v_mfma_f32_32x32x16_bf16 v[64:79], v[204:207], v[192:195], v[64:79]
    v_mfma_f32_32x32x16_bf16 v[80:95], v[204:207], v[196:199], v[80:95]
    s_waitcnt lgkmcnt(3)
    v_mfma_f32_32x32x16_bf16 v[32:47], v[184:187], v[176:179], v[32:47]
    ds_read_b128 v[192:195], v19 offset:4096
    ds_read_b64_tr_b16 v[200:201], v30 offset:6144
    s_waitcnt lgkmcnt(4)
    v_mfma_f32_32x32x16_bf16 v[48:63], v[184:187], v[180:183], v[48:63]
    ds_read_b64_tr_b16 v[202:203], v30 offset:6656
    ds_read_b128 v[196:199], v19 offset:8192
    s_waitcnt lgkmcnt(4)
    v_mfma_f32_32x32x16_bf16 v[64:79], v[188:191], v[176:179], v[64:79]
    ds_read_b64_tr_b16 v[204:205], v30 offset:30720
    ds_read_b64_tr_b16 v[206:207], v30 offset:31232
    v_mfma_f32_32x32x16_bf16 v[80:95], v[188:191], v[180:183], v[80:95]
    ds_read_b128 v[208:211], v25 offset:4096
    ds_read_b128 v[212:215], v27 offset:4096
    ds_read_b128 v[216:219], v29 offset:0
    ds_read_b128 v[220:223], v29 offset:2048
    s_waitcnt lgkmcnt(0)
    s_barrier
    v_mfma_f32_32x32x16_bf16 v[32:47], v[200:203], v[192:195], v[32:47]
    ds_read_b128 v[176:179], v16 offset:20480
    ds_read_b64_tr_b16 v[184:185], v30 offset:8192
    v_mfma_f32_32x32x16_bf16 v[48:63], v[200:203], v[196:199], v[48:63]
    ds_read_b64_tr_b16 v[186:187], v30 offset:8704
    ds_read_b128 v[180:183], v16 offset:24576
    v_mfma_f32_16x16x32_bf16 v[160:163], v[208:211], v[216:219], v[160:163]
    ds_read_b64_tr_b16 v[188:189], v30 offset:32768
    ds_read_b64_tr_b16 v[190:191], v30 offset:33280
    v_mfma_f32_16x16x32_bf16 v[164:167], v[212:215], v[216:219], v[164:167]
    v_mfma_f32_16x16x32_bf16 v[168:171], v[208:211], v[220:223], v[168:171]
    v_mfma_f32_16x16x32_bf16 v[172:175], v[212:215], v[220:223], v[172:175]
    v_mfma_f32_32x32x16_bf16 v[64:79], v[204:207], v[192:195], v[64:79]
    v_mfma_f32_32x32x16_bf16 v[80:95], v[204:207], v[196:199], v[80:95]
    s_waitcnt lgkmcnt(3)
    v_mfma_f32_32x32x16_bf16 v[32:47], v[184:187], v[176:179], v[32:47]
    ds_read_b128 v[192:195], v17 offset:20480
    ds_read_b64_tr_b16 v[200:201], v30 offset:10240
    s_waitcnt lgkmcnt(4)
    v_mfma_f32_32x32x16_bf16 v[48:63], v[184:187], v[180:183], v[48:63]
    ds_read_b64_tr_b16 v[202:203], v30 offset:10752
    ds_read_b128 v[196:199], v17 offset:24576
    s_waitcnt lgkmcnt(4)
    v_mfma_f32_32x32x16_bf16 v[64:79], v[188:191], v[176:179], v[64:79]
    ds_read_b64_tr_b16 v[204:205], v30 offset:34816
    ds_read_b64_tr_b16 v[206:207], v30 offset:35328
    v_mfma_f32_32x32x16_bf16 v[80:95], v[188:191], v[180:183], v[80:95]
    ds_read_b128 v[208:211], v24 offset:20480
    ds_read_b128 v[212:215], v26 offset:20480
    ds_read_b128 v[216:219], v28 offset:4096
    ds_read_b128 v[220:223], v28 offset:6144
    s_waitcnt lgkmcnt(7)
    v_mfma_f32_32x32x16_bf16 v[32:47], v[200:203], v[192:195], v[32:47]
    ds_read_b128 v[176:179], v18 offset:20480
    ds_read_b64_tr_b16 v[184:185], v30 offset:12288
    s_waitcnt lgkmcnt(8)
    v_mfma_f32_32x32x16_bf16 v[48:63], v[200:203], v[196:199], v[48:63]
    ds_read_b64_tr_b16 v[186:187], v30 offset:12800
    ds_read_b128 v[180:183], v18 offset:24576
    s_waitcnt lgkmcnt(5)
    v_mfma_f32_16x16x32_bf16 v[160:163], v[208:211], v[216:219], v[160:163]
    ds_read_b64_tr_b16 v[188:189], v30 offset:36864
    ds_read_b64_tr_b16 v[190:191], v30 offset:37376
    v_mfma_f32_16x16x32_bf16 v[164:167], v[212:215], v[216:219], v[164:167]
    s_waitcnt lgkmcnt(6)
    v_mfma_f32_16x16x32_bf16 v[168:171], v[208:211], v[220:223], v[168:171]
    v_mfma_f32_16x16x32_bf16 v[172:175], v[212:215], v[220:223], v[172:175]
    v_mfma_f32_32x32x16_bf16 v[64:79], v[204:207], v[192:195], v[64:79]
    v_mfma_f32_32x32x16_bf16 v[80:95], v[204:207], v[196:199], v[80:95]
    s_waitcnt lgkmcnt(3)
    v_mfma_f32_32x32x16_bf16 v[32:47], v[184:187], v[176:179], v[32:47]
    ds_read_b128 v[192:195], v19 offset:20480
    ds_read_b64_tr_b16 v[200:201], v30 offset:14336
    s_waitcnt lgkmcnt(4)
    v_mfma_f32_32x32x16_bf16 v[48:63], v[184:187], v[180:183], v[48:63]
    ds_read_b64_tr_b16 v[202:203], v30 offset:14848
    ds_read_b128 v[196:199], v19 offset:24576
    s_waitcnt lgkmcnt(4)
    v_mfma_f32_32x32x16_bf16 v[64:79], v[188:191], v[176:179], v[64:79]
    ds_read_b64_tr_b16 v[204:205], v30 offset:38912
    ds_read_b64_tr_b16 v[206:207], v30 offset:39424
    v_mfma_f32_32x32x16_bf16 v[80:95], v[188:191], v[180:183], v[80:95]
    ds_read_b128 v[208:211], v25 offset:20480
    ds_read_b128 v[212:215], v27 offset:20480
    ds_read_b128 v[216:219], v29 offset:4096
    ds_read_b128 v[220:223], v29 offset:6144
    s_waitcnt lgkmcnt(0)
    s_barrier
    v_mfma_f32_32x32x16_bf16 v[32:47], v[200:203], v[192:195], v[32:47]
    ds_read_b128 v[176:179], v16 offset:36864
    ds_read_b64_tr_b16 v[184:185], v30 offset:16384
    v_mfma_f32_32x32x16_bf16 v[48:63], v[200:203], v[196:199], v[48:63]
    ds_read_b64_tr_b16 v[186:187], v30 offset:16896
    ds_read_b128 v[180:183], v16 offset:40960
    v_mfma_f32_16x16x32_bf16 v[160:163], v[208:211], v[216:219], v[160:163]
    ds_read_b64_tr_b16 v[188:189], v30 offset:40960
    ds_read_b64_tr_b16 v[190:191], v30 offset:41472
    v_mfma_f32_16x16x32_bf16 v[164:167], v[212:215], v[216:219], v[164:167]
    v_mfma_f32_16x16x32_bf16 v[168:171], v[208:211], v[220:223], v[168:171]
    v_mfma_f32_16x16x32_bf16 v[172:175], v[212:215], v[220:223], v[172:175]
    v_mfma_f32_32x32x16_bf16 v[64:79], v[204:207], v[192:195], v[64:79]
    v_mfma_f32_32x32x16_bf16 v[80:95], v[204:207], v[196:199], v[80:95]
    s_waitcnt lgkmcnt(3)
    v_mfma_f32_32x32x16_bf16 v[32:47], v[184:187], v[176:179], v[32:47]
    ds_read_b128 v[192:195], v17 offset:36864
    ds_read_b64_tr_b16 v[200:201], v30 offset:18432
    s_waitcnt lgkmcnt(4)
    v_mfma_f32_32x32x16_bf16 v[48:63], v[184:187], v[180:183], v[48:63]
    ds_read_b64_tr_b16 v[202:203], v30 offset:18944
    ds_read_b128 v[196:199], v17 offset:40960
    s_waitcnt lgkmcnt(4)
    v_mfma_f32_32x32x16_bf16 v[64:79], v[188:191], v[176:179], v[64:79]
    ds_read_b64_tr_b16 v[204:205], v30 offset:43008
    ds_read_b64_tr_b16 v[206:207], v30 offset:43520
    v_mfma_f32_32x32x16_bf16 v[80:95], v[188:191], v[180:183], v[80:95]
    ds_read_b128 v[208:211], v24 offset:36864
    ds_read_b128 v[212:215], v26 offset:36864
    ds_read_b128 v[216:219], v28 offset:8192
    ds_read_b128 v[220:223], v28 offset:10240
    s_waitcnt lgkmcnt(7)
    v_mfma_f32_32x32x16_bf16 v[32:47], v[200:203], v[192:195], v[32:47]
    ds_read_b128 v[176:179], v18 offset:36864
    ds_read_b64_tr_b16 v[184:185], v30 offset:20480
    s_waitcnt lgkmcnt(8)
    v_mfma_f32_32x32x16_bf16 v[48:63], v[200:203], v[196:199], v[48:63]
    ds_read_b64_tr_b16 v[186:187], v30 offset:20992
    ds_read_b128 v[180:183], v18 offset:40960
    s_waitcnt lgkmcnt(5)
    v_mfma_f32_16x16x32_bf16 v[160:163], v[208:211], v[216:219], v[160:163]
    ds_read_b64_tr_b16 v[188:189], v30 offset:45056
    ds_read_b64_tr_b16 v[190:191], v30 offset:45568
    v_mfma_f32_16x16x32_bf16 v[164:167], v[212:215], v[216:219], v[164:167]
    s_waitcnt lgkmcnt(6)
    v_mfma_f32_16x16x32_bf16 v[168:171], v[208:211], v[220:223], v[168:171]
    v_mfma_f32_16x16x32_bf16 v[172:175], v[212:215], v[220:223], v[172:175]
    v_mfma_f32_32x32x16_bf16 v[64:79], v[204:207], v[192:195], v[64:79]
    v_mfma_f32_32x32x16_bf16 v[80:95], v[204:207], v[196:199], v[80:95]
    s_waitcnt lgkmcnt(3)
    v_mfma_f32_32x32x16_bf16 v[32:47], v[184:187], v[176:179], v[32:47]
    ds_read_b128 v[192:195], v19 offset:36864
    ds_read_b64_tr_b16 v[200:201], v30 offset:22528
    s_waitcnt lgkmcnt(4)
    v_mfma_f32_32x32x16_bf16 v[48:63], v[184:187], v[180:183], v[48:63]
    ds_read_b64_tr_b16 v[202:203], v30 offset:23040
    ds_read_b128 v[196:199], v19 offset:40960
    s_waitcnt lgkmcnt(4)
    v_mfma_f32_32x32x16_bf16 v[64:79], v[188:191], v[176:179], v[64:79]
    ds_read_b64_tr_b16 v[204:205], v30 offset:47104
    ds_read_b64_tr_b16 v[206:207], v30 offset:47616
    v_mfma_f32_32x32x16_bf16 v[80:95], v[188:191], v[180:183], v[80:95]
    ds_read_b128 v[208:211], v25 offset:36864
    ds_read_b128 v[212:215], v27 offset:36864
    ds_read_b128 v[216:219], v29 offset:8192
    ds_read_b128 v[220:223], v29 offset:10240
    s_waitcnt lgkmcnt(0)
    s_barrier
    v_mfma_f32_32x32x16_bf16 v[32:47], v[200:203], v[192:195], v[32:47]
    ds_read_b128 v[176:179], v16 offset:4096
    ds_read_b64_tr_b16 v[184:185], v30 offset:0
    v_mfma_f32_32x32x16_bf16 v[48:63], v[200:203], v[196:199], v[48:63]
    ds_read_b64_tr_b16 v[186:187], v30 offset:512
    ds_read_b128 v[180:183], v16 offset:8192
    v_mfma_f32_16x16x32_bf16 v[160:163], v[208:211], v[216:219], v[160:163]
    ds_read_b64_tr_b16 v[188:189], v30 offset:24576
    ds_read_b64_tr_b16 v[190:191], v30 offset:25088
    v_mfma_f32_16x16x32_bf16 v[164:167], v[212:215], v[216:219], v[164:167]
    v_mfma_f32_16x16x32_bf16 v[168:171], v[208:211], v[220:223], v[168:171]
    v_mfma_f32_16x16x32_bf16 v[172:175], v[212:215], v[220:223], v[172:175]
    v_mfma_f32_32x32x16_bf16 v[64:79], v[204:207], v[192:195], v[64:79]
    v_mfma_f32_32x32x16_bf16 v[80:95], v[204:207], v[196:199], v[80:95]
    s_cmp_lg_u32 s3, 1
    s_cbranch_scc1 L_32
    s_mov_b32 s56, s36
    s_mov_b32 s57, s37
    s_mov_b32 s58, 1835008
    s_mov_b32 s59, 0x20000
    s_mov_b32 s60, s38
    s_mov_b32 s61, s39
    s_mov_b32 s62, 1835008
    s_mov_b32 s63, 0x20000
    v_min_u32 v1, 6, v0
    v_lshlrev_b32 v1, 7, v1
    s_mul_i32 s4, s2, 896
    buffer_load_dword v8, v1, s[56:59], s4 offen
    buffer_load_dword v8, v1, s[60:63], s4 offen
L_32:
    s_waitcnt lgkmcnt(3)
    v_mfma_f32_32x32x16_bf16 v[32:47], v[184:187], v[176:179], v[32:47]
    ds_read_b128 v[192:195], v17 offset:4096
    ds_read_b64_tr_b16 v[200:201], v30 offset:2048
    s_waitcnt lgkmcnt(4)
    v_mfma_f32_32x32x16_bf16 v[48:63], v[184:187], v[180:183], v[48:63]
    ds_read_b64_tr_b16 v[202:203], v30 offset:2560
    ds_read_b128 v[196:199], v17 offset:8192
    s_waitcnt lgkmcnt(4)
    v_mfma_f32_32x32x16_bf16 v[64:79], v[188:191], v[176:179], v[64:79]
    ds_read_b64_tr_b16 v[204:205], v30 offset:26624
    ds_read_b64_tr_b16 v[206:207], v30 offset:27136
    v_mfma_f32_32x32x16_bf16 v[80:95], v[188:191], v[180:183], v[80:95]
    ds_read_b128 v[208:211], v24 offset:4096
    ds_read_b128 v[212:215], v26 offset:4096
    ds_read_b128 v[216:219], v28 offset:0
    ds_read_b128 v[220:223], v28 offset:2048
    s_waitcnt lgkmcnt(7)
    v_mfma_f32_32x32x16_bf16 v[32:47], v[200:203], v[192:195], v[32:47]
    ds_read_b128 v[176:179], v18 offset:4096
    ds_read_b64_tr_b16 v[184:185], v30 offset:4096
    s_waitcnt lgkmcnt(8)
    v_mfma_f32_32x32x16_bf16 v[48:63], v[200:203], v[196:199], v[48:63]
    ds_read_b64_tr_b16 v[186:187], v30 offset:4608
    ds_read_b128 v[180:183], v18 offset:8192
    s_waitcnt lgkmcnt(5)
    v_mfma_f32_16x16x32_bf16 v[160:163], v[208:211], v[216:219], v[160:163]
    ds_read_b64_tr_b16 v[188:189], v30 offset:28672
    ds_read_b64_tr_b16 v[190:191], v30 offset:29184
    v_mfma_f32_16x16x32_bf16 v[164:167], v[212:215], v[216:219], v[164:167]
    s_waitcnt lgkmcnt(6)
    v_mfma_f32_16x16x32_bf16 v[168:171], v[208:211], v[220:223], v[168:171]
    v_mfma_f32_16x16x32_bf16 v[172:175], v[212:215], v[220:223], v[172:175]
    v_mfma_f32_32x32x16_bf16 v[64:79], v[204:207], v[192:195], v[64:79]
    v_mfma_f32_32x32x16_bf16 v[80:95], v[204:207], v[196:199], v[80:95]
    s_waitcnt lgkmcnt(3)
    v_mfma_f32_32x32x16_bf16 v[32:47], v[184:187], v[176:179], v[32:47]
    ds_read_b128 v[192:195], v19 offset:4096
    ds_read_b64_tr_b16 v[200:201], v30 offset:6144
    s_waitcnt lgkmcnt(4)
    v_mfma_f32_32x32x16_bf16 v[48:63], v[184:187], v[180:183], v[48:63]
    ds_read_b64_tr_b16 v[202:203], v30 offset:6656
    ds_read_b128 v[196:199], v19 offset:8192
    s_waitcnt lgkmcnt(4)
    v_mfma_f32_32x32x16_bf16 v[64:79], v[188:191], v[176:179], v[64:79]
    ds_read_b64_tr_b16 v[204:205], v30 offset:30720
    ds_read_b64_tr_b16 v[206:207], v30 offset:31232
    v_mfma_f32_32x32x16_bf16 v[80:95], v[188:191], v[180:183], v[80:95]
    ds_read_b128 v[208:211], v25 offset:4096
    ds_read_b128 v[212:215], v27 offset:4096
    ds_read_b128 v[216:219], v29 offset:0
    ds_read_b128 v[220:223], v29 offset:2048
    s_waitcnt lgkmcnt(0)
    s_barrier
    v_mfma_f32_32x32x16_bf16 v[32:47], v[200:203], v[192:195], v[32:47]
    ds_read_b128 v[176:179], v16 offset:20480
    ds_read_b64_tr_b16 v[184:185], v30 offset:8192
    v_mfma_f32_32x32x16_bf16 v[48:63], v[200:203], v[196:199], v[48:63]
    ds_read_b64_tr_b16 v[186:187], v30 offset:8704
    ds_read_b128 v[180:183], v16 offset:24576
    v_mfma_f32_16x16x32_bf16 v[160:163], v[208:211], v[216:219], v[160:163]
    ds_read_b64_tr_b16 v[188:189], v30 offset:32768
    ds_read_b64_tr_b16 v[190:191], v30 offset:33280
    v_mfma_f32_16x16x32_bf16 v[164:167], v[212:215], v[216:219], v[164:167]
    v_mfma_f32_16x16x32_bf16 v[168:171], v[208:211], v[220:223], v[168:171]
    v_mfma_f32_16x16x32_bf16 v[172:175], v[212:215], v[220:223], v[172:175]
    v_mfma_f32_32x32x16_bf16 v[64:79], v[204:207], v[192:195], v[64:79]
    v_mfma_f32_32x32x16_bf16 v[80:95], v[204:207], v[196:199], v[80:95]
    s_cmp_lg_u32 s3, 2
    s_cbranch_scc1 L_33
    s_mov_b32 s52, s40
    s_mov_b32 s53, s41
    s_mov_b32 s54, 1835008
    s_mov_b32 s55, 0x20000
    v_min_u32 v1, 55, v0
    v_lshlrev_b32 v1, 7, v1
    s_mul_i32 s4, s2, 7168
    buffer_load_dword v8, v1, s[52:55], s4 offen
L_33:
    s_cmp_lg_u32 s3, 2
    s_cbranch_scc1 L_34
    s_mov_b32 s56, s26
    s_mov_b32 s57, s27
    s_mov_b32 s58, 524288
    s_mov_b32 s59, 0x20000
    s_mov_b32 s60, s28
    s_mov_b32 s61, s29
    s_mov_b32 s62, 524288
    s_mov_b32 s63, 0x20000
    v_and_b32 v1, 15, v0
    v_lshlrev_b32 v1, 7, v1
    s_lshl_b32 s4, s2, 11
    buffer_load_dword v8, v1, s[56:59], s4 offen
    buffer_load_dword v8, v1, s[60:63], s4 offen
L_34:
    s_waitcnt lgkmcnt(3)
    v_mfma_f32_32x32x16_bf16 v[32:47], v[184:187], v[176:179], v[32:47]
    ds_read_b128 v[192:195], v17 offset:20480
    ds_read_b64_tr_b16 v[200:201], v30 offset:10240
    s_cmp_lg_u32 s3, 0
    s_cbranch_scc1 L_30
    s_waitcnt vmcnt(0)
    v_mov_b32 v9, s14
    v_cmp_eq_u32 vcc, 0, v10
    s_mov_b64 exec, 1
    v_mov_b32 v11, 0
    v_cndmask_b32 v10, v10, v9, vcc
    ds_write_b32 v11, v10 offset:2048
    s_waitcnt lgkmcnt(0)
    s_mov_b64 exec, -1
    L_30:
    s_mov_b32 s14, s78
    s_waitcnt lgkmcnt(4)
    v_mfma_f32_32x32x16_bf16 v[48:63], v[184:187], v[180:183], v[48:63]
    ds_read_b64_tr_b16 v[202:203], v30 offset:10752
    ds_read_b128 v[196:199], v17 offset:24576
    v_and_b32 v1, 15, v0
    s_waitcnt lgkmcnt(4)
    v_mfma_f32_32x32x16_bf16 v[64:79], v[188:191], v[176:179], v[64:79]
    ds_read_b64_tr_b16 v[204:205], v30 offset:34816
    ds_read_b64_tr_b16 v[206:207], v30 offset:35328
    v_mfma_f32_32x32x16_bf16 v[80:95], v[188:191], v[180:183], v[80:95]
    ds_read_b128 v[208:211], v24 offset:20480
    ds_read_b128 v[212:215], v26 offset:20480
    ds_read_b128 v[216:219], v28 offset:4096
    ds_read_b128 v[220:223], v28 offset:6144
    s_waitcnt lgkmcnt(7)
    v_mfma_f32_32x32x16_bf16 v[32:47], v[200:203], v[192:195], v[32:47]
    ds_read_b128 v[176:179], v18 offset:20480
    ds_read_b64_tr_b16 v[184:185], v30 offset:12288
    v_lshlrev_b32 v1, 4, v1
    s_waitcnt lgkmcnt(8)
    v_mfma_f32_32x32x16_bf16 v[48:63], v[200:203], v[196:199], v[48:63]
    ds_read_b64_tr_b16 v[186:187], v30 offset:12800
    ds_read_b128 v[180:183], v18 offset:24576
    ds_read_b128 v[224:227], v1 offset:0
    s_waitcnt lgkmcnt(6)
    v_mfma_f32_16x16x32_bf16 v[160:163], v[208:211], v[216:219], v[160:163]
    ds_read_b64_tr_b16 v[188:189], v30 offset:36864
    ds_read_b64_tr_b16 v[190:191], v30 offset:37376
    v_mfma_f32_16x16x32_bf16 v[164:167], v[212:215], v[216:219], v[164:167]
    s_waitcnt lgkmcnt(7)
    v_mfma_f32_16x16x32_bf16 v[168:171], v[208:211], v[220:223], v[168:171]
    v_mfma_f32_16x16x32_bf16 v[172:175], v[212:215], v[220:223], v[172:175]
    v_mfma_f32_32x32x16_bf16 v[64:79], v[204:207], v[192:195], v[64:79]
    v_mfma_f32_32x32x16_bf16 v[80:95], v[204:207], v[196:199], v[80:95]
    s_waitcnt lgkmcnt(4)
    v_mfma_f32_32x32x16_bf16 v[32:47], v[184:187], v[176:179], v[32:47]
    ds_read_b128 v[192:195], v19 offset:20480
    ds_read_b64_tr_b16 v[200:201], v30 offset:14336
    s_lshl_b32 s4, s3, 8
    s_add_u32 s4, s4, 151552
    v_lshlrev_b32 v5, 2, v0
    s_waitcnt lgkmcnt(5)
    v_mfma_f32_32x32x16_bf16 v[48:63], v[184:187], v[180:183], v[48:63]
    ds_read_b64_tr_b16 v[202:203], v30 offset:14848
    ds_read_b128 v[196:199], v19 offset:24576
    v_add_u32 v5, s4, v5
    s_waitcnt lgkmcnt(4)
    v_mfma_f32_32x32x16_bf16 v[64:79], v[188:191], v[176:179], v[64:79]
    ds_read_b64_tr_b16 v[204:205], v30 offset:38912
    ds_read_b64_tr_b16 v[206:207], v30 offset:39424
    v_mfma_f32_32x32x16_bf16 v[80:95], v[188:191], v[180:183], v[80:95]
    ds_read_b128 v[208:211], v25 offset:20480
    ds_read_b128 v[212:215], v27 offset:20480
    ds_read_b128 v[216:219], v29 offset:4096
    ds_read_b128 v[220:223], v29 offset:6144
    s_waitcnt lgkmcnt(0)
    s_barrier
    v_mfma_f32_32x32x16_bf16 v[32:47], v[200:203], v[192:195], v[32:47]
    ds_read_b128 v[176:179], v16 offset:36864
    ds_read_b64_tr_b16 v[184:185], v30 offset:16384
    v_mfma_f32_32x32x16_bf16 v[48:63], v[200:203], v[196:199], v[48:63]
    ds_read_b64_tr_b16 v[186:187], v30 offset:16896
    ds_read_b128 v[180:183], v16 offset:40960
    v_mfma_f32_16x16x32_bf16 v[160:163], v[208:211], v[216:219], v[160:163]
    ds_read_b64_tr_b16 v[188:189], v30 offset:40960
    ds_read_b64_tr_b16 v[190:191], v30 offset:41472
    v_mfma_f32_16x16x32_bf16 v[164:167], v[212:215], v[216:219], v[164:167]
    v_mfma_f32_16x16x32_bf16 v[168:171], v[208:211], v[220:223], v[168:171]
    v_mfma_f32_16x16x32_bf16 v[172:175], v[212:215], v[220:223], v[172:175]
    v_mfma_f32_32x32x16_bf16 v[64:79], v[204:207], v[192:195], v[64:79]
    v_mfma_f32_32x32x16_bf16 v[80:95], v[204:207], v[196:199], v[80:95]
    s_waitcnt lgkmcnt(3)
    v_mfma_f32_32x32x16_bf16 v[96:111], v[184:187], v[176:179], 0
    ds_read_b128 v[192:195], v17 offset:36864
    ds_read_b64_tr_b16 v[200:201], v30 offset:18432
    s_waitcnt lgkmcnt(4)
    v_mfma_f32_32x32x16_bf16 v[112:127], v[184:187], v[180:183], 0
    ds_read_b64_tr_b16 v[202:203], v30 offset:18944
    ds_read_b128 v[196:199], v17 offset:40960
    s_waitcnt lgkmcnt(4)
    v_mfma_f32_32x32x16_bf16 v[128:143], v[188:191], v[176:179], 0
    ds_read_b64_tr_b16 v[204:205], v30 offset:43008
    ds_read_b64_tr_b16 v[206:207], v30 offset:43520
    v_fma_f32 v210, v160, v224, v161
    v_fma_f32 v211, v168, v224, v169
    v_fma_f32 v210, -v168, v225, v210
    v_fma_f32 v211, v160, v225, v211
    v_fma_f32 v208, v210, v224, v162
    v_fma_f32 v209, v211, v224, v170
    v_mfma_f32_32x32x16_bf16 v[144:159], v[188:191], v[180:183], 0
    v_fma_f32 v208, -v211, v225, v208
    v_fma_f32 v209, v210, v225, v209
    v_fma_f32 v210, v208, v224, v163
    v_fma_f32 v211, v209, v224, v171
    s_waitcnt lgkmcnt(3)
    v_mfma_f32_32x32x16_bf16 v[96:111], v[200:203], v[192:195], v[96:111]
    ds_read_b128 v[176:179], v18 offset:36864
    ds_read_b64_tr_b16 v[184:185], v30 offset:20480
    v_fma_f32 v210, -v209, v225, v210
    v_fma_f32 v211, v208, v225, v211
    v_fma_f32 v208, v210, v224, v164
    s_waitcnt lgkmcnt(4)
    v_mfma_f32_32x32x16_bf16 v[112:127], v[200:203], v[196:199], v[112:127]
    ds_read_b64_tr_b16 v[186:187], v30 offset:20992
    ds_read_b128 v[180:183], v18 offset:40960
    v_fma_f32 v209, v211, v224, v172
    v_fma_f32 v208, -v211, v225, v208
    v_fma_f32 v209, v210, v225, v209
    s_waitcnt lgkmcnt(4)
    v_mfma_f32_32x32x16_bf16 v[128:143], v[204:207], v[192:195], v[128:143]
    ds_read_b64_tr_b16 v[188:189], v30 offset:45056
    ds_read_b64_tr_b16 v[190:191], v30 offset:45568
    v_fma_f32 v210, v208, v224, v165
    v_fma_f32 v211, v209, v224, v173
    v_fma_f32 v210, -v209, v225, v210
    v_mfma_f32_32x32x16_bf16 v[144:159], v[204:207], v[196:199], v[144:159]
    v_fma_f32 v211, v208, v225, v211
    s_waitcnt lgkmcnt(3)
    v_mfma_f32_32x32x16_bf16 v[96:111], v[184:187], v[176:179], v[96:111]
    ds_read_b128 v[192:195], v19 offset:36864
    ds_read_b64_tr_b16 v[200:201], v30 offset:22528
    v_fma_f32 v208, v210, v224, v166
    v_fma_f32 v209, v211, v224, v174
    v_fma_f32 v208, -v211, v225, v208
    s_waitcnt lgkmcnt(4)
    v_mfma_f32_32x32x16_bf16 v[112:127], v[184:187], v[180:183], v[112:127]
    ds_read_b64_tr_b16 v[202:203], v30 offset:23040
    ds_read_b128 v[196:199], v19 offset:40960
    v_fma_f32 v209, v210, v225, v209
    v_fma_f32 v210, v208, v224, v167
    v_fma_f32 v211, v209, v224, v175
    s_waitcnt lgkmcnt(4)
    v_mfma_f32_32x32x16_bf16 v[128:143], v[188:191], v[176:179], v[128:143]
    ds_read_b64_tr_b16 v[204:205], v30 offset:47104
    ds_read_b64_tr_b16 v[206:207], v30 offset:47616
    v_fma_f32 v210, -v209, v225, v210
    v_fma_f32 v211, v208, v225, v211
    ds_write_b32 v5, v210 offset:0
    v_mfma_f32_32x32x16_bf16 v[144:159], v[188:191], v[180:183], v[144:159]
    ds_write_b32 v5, v211 offset:1024
    s_waitcnt lgkmcnt(0)
    s_barrier
    v_mfma_f32_32x32x16_bf16 v[96:111], v[200:203], v[192:195], v[96:111]
    ds_read_b128 v[176:179], v16 offset:4096
    ds_read_b64_tr_b16 v[184:185], v30 offset:0
    s_waitcnt vmcnt(0)
    v_mov_b32 v1, 0
    ds_read_b32 v1, v1 offset:2048
    v_mul_f32 v232, s50, v32
    v_mul_f32 v233, s50, v33
    v_mfma_f32_32x32x16_bf16 v[112:127], v[200:203], v[196:199], v[112:127]
    ds_read_b64_tr_b16 v[186:187], v30 offset:512
    ds_read_b128 v[180:183], v16 offset:8192
    v_mul_f32 v234, s50, v34
    v_mul_f32 v235, s50, v35
    v_mul_f32 v236, s50, v36
    v_mul_f32 v237, s50, v37
    v_mul_f32 v238, s50, v38
    v_mfma_f32_32x32x16_bf16 v[128:143], v[204:207], v[192:195], v[128:143]
    ds_read_b64_tr_b16 v[188:189], v30 offset:24576
    ds_read_b64_tr_b16 v[190:191], v30 offset:25088
    v_mul_f32 v239, s50, v39
    v_exp_f32 v232, v232
    v_exp_f32 v233, v233
    v_exp_f32 v234, v234
    v_exp_f32 v235, v235
    v_mfma_f32_32x32x16_bf16 v[144:159], v[204:207], v[196:199], v[144:159]
    v_exp_f32 v236, v236
    v_exp_f32 v237, v237
    s_waitcnt lgkmcnt(3)
    v_mfma_f32_32x32x16_bf16 v[96:111], v[184:187], v[176:179], v[96:111]
    ds_read_b128 v[192:195], v17 offset:4096
    ds_read_b64_tr_b16 v[200:201], v30 offset:2048
    v_exp_f32 v238, v238
    v_exp_f32 v239, v239
    v_add_f32 v232, 1.0, v232
    v_add_f32 v233, 1.0, v233
    v_add_f32 v234, 1.0, v234
    s_waitcnt lgkmcnt(4)
    v_mfma_f32_32x32x16_bf16 v[112:127], v[184:187], v[180:183], v[112:127]
    ds_read_b64_tr_b16 v[202:203], v30 offset:2560
    ds_read_b128 v[196:199], v17 offset:8192
    v_add_f32 v235, 1.0, v235
    v_add_f32 v236, 1.0, v236
    v_add_f32 v237, 1.0, v237
    v_add_f32 v238, 1.0, v238
    v_add_f32 v239, 1.0, v239
    s_waitcnt lgkmcnt(4)
    v_mfma_f32_32x32x16_bf16 v[128:143], v[188:191], v[176:179], v[128:143]
    ds_read_b64_tr_b16 v[204:205], v30 offset:26624
    ds_read_b64_tr_b16 v[206:207], v30 offset:27136
    v_rcp_f32 v232, v232
    v_rcp_f32 v233, v233
    v_rcp_f32 v234, v234
    v_rcp_f32 v235, v235
    v_rcp_f32 v236, v236
    v_mfma_f32_32x32x16_bf16 v[144:159], v[188:191], v[180:183], v[144:159]
    v_rcp_f32 v237, v237
    v_rcp_f32 v238, v238
    s_waitcnt lgkmcnt(3)
    v_mfma_f32_32x32x16_bf16 v[96:111], v[200:203], v[192:195], v[96:111]
    ds_read_b128 v[176:179], v18 offset:4096
    ds_read_b64_tr_b16 v[184:185], v30 offset:4096
    v_rcp_f32 v239, v239
    v_mul_f32 v232, v232, v64
    v_mul_f32 v233, v233, v65
    v_mul_f32 v234, v234, v66
    v_mul_f32 v235, v235, v67
    s_waitcnt lgkmcnt(4)
    v_mfma_f32_32x32x16_bf16 v[112:127], v[200:203], v[196:199], v[112:127]
    ds_read_b64_tr_b16 v[186:187], v30 offset:4608
    ds_read_b128 v[180:183], v18 offset:8192
    v_mul_f32 v236, v236, v68
    v_mul_f32 v237, v237, v69
    v_mul_f32 v238, v238, v70
    v_mul_f32 v239, v239, v71
    v_cvt_pk_bf16_f32 v248, v232, v233
    s_waitcnt lgkmcnt(4)
    v_mfma_f32_32x32x16_bf16 v[128:143], v[204:207], v[192:195], v[128:143]
    ds_read_b64_tr_b16 v[188:189], v30 offset:28672
    ds_read_b64_tr_b16 v[190:191], v30 offset:29184
    v_cvt_pk_bf16_f32 v249, v234, v235
    v_cvt_pk_bf16_f32 v250, v236, v237
    v_cvt_pk_bf16_f32 v251, v238, v239
    v_mul_f32 v240, s50, v40
    v_mul_f32 v241, s50, v41
    v_mfma_f32_32x32x16_bf16 v[144:159], v[204:207], v[196:199], v[144:159]
    v_mul_f32 v242, s50, v42
    v_mul_f32 v243, s50, v43
    s_waitcnt lgkmcnt(3)
    v_mfma_f32_32x32x16_bf16 v[96:111], v[184:187], v[176:179], v[96:111]
    ds_read_b128 v[192:195], v19 offset:4096
    ds_read_b64_tr_b16 v[200:201], v30 offset:6144
    v_mul_f32 v244, s50, v44
    v_mul_f32 v245, s50, v45
    v_mul_f32 v246, s50, v46
    v_mul_f32 v247, s50, v47
    v_exp_f32 v240, v240
    s_waitcnt lgkmcnt(4)
    v_mfma_f32_32x32x16_bf16 v[112:127], v[184:187], v[180:183], v[112:127]
    ds_read_b64_tr_b16 v[202:203], v30 offset:6656
    ds_read_b128 v[196:199], v19 offset:8192
    v_exp_f32 v241, v241
    v_exp_f32 v242, v242
    v_exp_f32 v243, v243
    v_exp_f32 v244, v244
    v_exp_f32 v245, v245
    s_waitcnt lgkmcnt(4)
    v_mfma_f32_32x32x16_bf16 v[128:143], v[188:191], v[176:179], v[128:143]
    ds_read_b64_tr_b16 v[204:205], v30 offset:30720
    ds_read_b64_tr_b16 v[206:207], v30 offset:31232
    v_exp_f32 v246, v246
    v_exp_f32 v247, v247
    v_add_f32 v240, 1.0, v240
    v_add_f32 v241, 1.0, v241
    v_add_f32 v242, 1.0, v242
    v_mfma_f32_32x32x16_bf16 v[144:159], v[188:191], v[180:183], v[144:159]
    v_add_f32 v243, 1.0, v243
    s_add_u32 s5, s14, 0
    buffer_store_dwordx4 v[248:251], v6, s[64:67], s5 offen sc1
    s_waitcnt lgkmcnt(0)
    s_barrier
    v_mfma_f32_32x32x16_bf16 v[96:111], v[200:203], v[192:195], v[96:111]
    ds_read_b128 v[176:179], v16 offset:20480
    ds_read_b64_tr_b16 v[184:185], v30 offset:8192
    v_add_f32 v244, 1.0, v244
    v_add_f32 v245, 1.0, v245
    v_add_f32 v246, 1.0, v246
    v_add_f32 v247, 1.0, v247
    v_rcp_f32 v240, v240
    v_mfma_f32_32x32x16_bf16 v[112:127], v[200:203], v[196:199], v[112:127]
    ds_read_b64_tr_b16 v[186:187], v30 offset:8704
    ds_read_b128 v[180:183], v16 offset:24576
    v_rcp_f32 v241, v241
    v_rcp_f32 v242, v242
    v_rcp_f32 v243, v243
    v_rcp_f32 v244, v244
    v_rcp_f32 v245, v245
    v_mfma_f32_32x32x16_bf16 v[128:143], v[204:207], v[192:195], v[128:143]
    ds_read_b64_tr_b16 v[188:189], v30 offset:32768
    ds_read_b64_tr_b16 v[190:191], v30 offset:33280
    v_rcp_f32 v246, v246
    v_rcp_f32 v247, v247
    v_mul_f32 v240, v240, v72
    v_mul_f32 v241, v241, v73
    v_mul_f32 v242, v242, v74
    v_mfma_f32_32x32x16_bf16 v[144:159], v[204:207], v[196:199], v[144:159]
    v_mul_f32 v243, v243, v75
    v_mul_f32 v244, v244, v76
    s_waitcnt lgkmcnt(3)
    v_mfma_f32_32x32x16_bf16 v[96:111], v[184:187], v[176:179], v[96:111]
    ds_read_b128 v[192:195], v17 offset:20480
    ds_read_b64_tr_b16 v[200:201], v30 offset:10240
    v_mul_f32 v245, v245, v77
    v_mul_f32 v246, v246, v78
    v_mul_f32 v247, v247, v79
    v_cvt_pk_bf16_f32 v252, v240, v241
    v_cvt_pk_bf16_f32 v253, v242, v243
    s_waitcnt lgkmcnt(4)
    v_mfma_f32_32x32x16_bf16 v[112:127], v[184:187], v[180:183], v[112:127]
    ds_read_b64_tr_b16 v[202:203], v30 offset:10752
    ds_read_b128 v[196:199], v17 offset:24576
    v_cvt_pk_bf16_f32 v254, v244, v245
    v_cvt_pk_bf16_f32 v255, v246, v247
    v_mul_f32 v232, s50, v48
    v_mul_f32 v233, s50, v49
    v_mul_f32 v234, s50, v50
    s_waitcnt lgkmcnt(4)
    v_mfma_f32_32x32x16_bf16 v[128:143], v[188:191], v[176:179], v[128:143]
    ds_read_b64_tr_b16 v[204:205], v30 offset:34816
    ds_read_b64_tr_b16 v[206:207], v30 offset:35328
    v_mul_f32 v235, s50, v51
    v_mul_f32 v236, s50, v52
    v_mul_f32 v237, s50, v53
    v_mul_f32 v238, s50, v54
    v_mul_f32 v239, s50, v55
    v_mfma_f32_32x32x16_bf16 v[144:159], v[188:191], v[180:183], v[144:159]
    v_exp_f32 v232, v232
    v_exp_f32 v233, v233
    s_waitcnt lgkmcnt(3)
    v_mfma_f32_32x32x16_bf16 v[96:111], v[200:203], v[192:195], v[96:111]
    ds_read_b128 v[176:179], v18 offset:20480
    ds_read_b64_tr_b16 v[184:185], v30 offset:12288
    v_exp_f32 v234, v234
    v_exp_f32 v235, v235
    v_exp_f32 v236, v236
    v_exp_f32 v237, v237
    v_exp_f32 v238, v238
    s_waitcnt lgkmcnt(4)
    v_mfma_f32_32x32x16_bf16 v[112:127], v[200:203], v[196:199], v[112:127]
    ds_read_b64_tr_b16 v[186:187], v30 offset:12800
    ds_read_b128 v[180:183], v18 offset:24576
    v_exp_f32 v239, v239
    v_add_f32 v232, 1.0, v232
    v_add_f32 v233, 1.0, v233
    v_add_f32 v234, 1.0, v234
    v_add_f32 v235, 1.0, v235
    s_waitcnt lgkmcnt(4)
    v_mfma_f32_32x32x16_bf16 v[128:143], v[204:207], v[192:195], v[128:143]
    ds_read_b64_tr_b16 v[188:189], v30 offset:36864
    ds_read_b64_tr_b16 v[190:191], v30 offset:37376
    v_add_f32 v236, 1.0, v236
    v_add_f32 v237, 1.0, v237
    v_add_f32 v238, 1.0, v238
    v_add_f32 v239, 1.0, v239
    v_rcp_f32 v232, v232
    v_mfma_f32_32x32x16_bf16 v[144:159], v[204:207], v[196:199], v[144:159]
    v_rcp_f32 v233, v233
    v_rcp_f32 v234, v234
    s_waitcnt lgkmcnt(3)
    v_mfma_f32_32x32x16_bf16 v[96:111], v[184:187], v[176:179], v[96:111]
    ds_read_b128 v[192:195], v19 offset:20480
    ds_read_b64_tr_b16 v[200:201], v30 offset:14336
    v_rcp_f32 v235, v235
    v_rcp_f32 v236, v236
    v_rcp_f32 v237, v237
    v_rcp_f32 v238, v238
    s_waitcnt lgkmcnt(4)
    v_mfma_f32_32x32x16_bf16 v[112:127], v[184:187], v[180:183], v[112:127]
    ds_read_b64_tr_b16 v[202:203], v30 offset:14848
    ds_read_b128 v[196:199], v19 offset:24576
    v_rcp_f32 v239, v239
    v_mul_f32 v232, v232, v80
    v_mul_f32 v233, v233, v81
    v_mul_f32 v234, v234, v82
    s_waitcnt lgkmcnt(4)
    v_mfma_f32_32x32x16_bf16 v[128:143], v[188:191], v[176:179], v[128:143]
    ds_read_b64_tr_b16 v[204:205], v30 offset:38912
    ds_read_b64_tr_b16 v[206:207], v30 offset:39424
    v_mul_f32 v235, v235, v83
    v_mul_f32 v236, v236, v84
    v_mul_f32 v237, v237, v85
    v_mul_f32 v238, v238, v86
    v_mfma_f32_32x32x16_bf16 v[144:159], v[188:191], v[180:183], v[144:159]
    v_mul_f32 v239, v239, v87
    s_add_u32 s5, s14, 1024
    buffer_store_dwordx4 v[252:255], v6, s[64:67], s5 offen sc1
    s_waitcnt lgkmcnt(0)
    s_barrier
    v_subrev_u32 v16, 49152, v16
    v_subrev_u32 v17, 49152, v17
    v_subrev_u32 v18, 49152, v18
    v_subrev_u32 v19, 49152, v19
    v_mfma_f32_32x32x16_bf16 v[96:111], v[200:203], v[192:195], v[96:111]
    ds_read_b128 v[176:179], v16 offset:4096
    ds_read_b64_tr_b16 v[184:185], v30 offset:16384
    v_cvt_pk_bf16_f32 v248, v232, v233
    v_cvt_pk_bf16_f32 v249, v234, v235
    v_cvt_pk_bf16_f32 v250, v236, v237
    v_cvt_pk_bf16_f32 v251, v238, v239
    v_mfma_f32_32x32x16_bf16 v[112:127], v[200:203], v[196:199], v[112:127]
    ds_read_b64_tr_b16 v[186:187], v30 offset:16896
    ds_read_b128 v[180:183], v16 offset:8192
    s_add_u32 s5, s14, 180224
    buffer_store_dwordx4 v[248:251], v6, s[64:67], s5 offen sc1
    v_mul_f32 v240, s50, v56
    v_mul_f32 v241, s50, v57
    v_mul_f32 v242, s50, v58
    v_mfma_f32_32x32x16_bf16 v[128:143], v[204:207], v[192:195], v[128:143]
    ds_read_b64_tr_b16 v[188:189], v30 offset:40960
    ds_read_b64_tr_b16 v[190:191], v30 offset:41472
    v_mul_f32 v243, s50, v59
    v_mul_f32 v244, s50, v60
    v_mul_f32 v245, s50, v61
    v_mul_f32 v246, s50, v62
    v_mfma_f32_32x32x16_bf16 v[144:159], v[204:207], v[196:199], v[144:159]
    v_mul_f32 v247, s50, v63
    s_waitcnt lgkmcnt(3)
    v_mfma_f32_32x32x16_bf16 v[96:111], v[184:187], v[176:179], v[96:111]
    ds_read_b128 v[192:195], v17 offset:4096
    ds_read_b64_tr_b16 v[200:201], v30 offset:18432
    v_exp_f32 v240, v240
    v_exp_f32 v241, v241
    v_exp_f32 v242, v242
    v_exp_f32 v243, v243
    s_waitcnt lgkmcnt(4)
    v_mfma_f32_32x32x16_bf16 v[112:127], v[184:187], v[180:183], v[112:127]
    ds_read_b64_tr_b16 v[202:203], v30 offset:18944
    ds_read_b128 v[196:199], v17 offset:8192
    v_exp_f32 v244, v244
    v_exp_f32 v245, v245
    v_exp_f32 v246, v246
    v_exp_f32 v247, v247
    s_waitcnt lgkmcnt(4)
    v_mfma_f32_32x32x16_bf16 v[128:143], v[188:191], v[176:179], v[128:143]
    ds_read_b64_tr_b16 v[204:205], v30 offset:43008
    ds_read_b64_tr_b16 v[206:207], v30 offset:43520
    v_add_f32 v240, 1.0, v240
    v_add_f32 v241, 1.0, v241
    v_add_f32 v242, 1.0, v242
    v_add_f32 v243, 1.0, v243
    v_mfma_f32_32x32x16_bf16 v[144:159], v[188:191], v[180:183], v[144:159]
    v_add_f32 v244, 1.0, v244
    s_waitcnt lgkmcnt(3)
    v_mfma_f32_32x32x16_bf16 v[96:111], v[200:203], v[192:195], v[96:111]
    ds_read_b128 v[176:179], v18 offset:4096
    ds_read_b64_tr_b16 v[184:185], v30 offset:20480
    v_add_f32 v245, 1.0, v245
    v_add_f32 v246, 1.0, v246
    v_add_f32 v247, 1.0, v247
    v_rcp_f32 v240, v240
    s_waitcnt lgkmcnt(4)
    v_mfma_f32_32x32x16_bf16 v[112:127], v[200:203], v[196:199], v[112:127]
    ds_read_b64_tr_b16 v[186:187], v30 offset:20992
    ds_read_b128 v[180:183], v18 offset:8192
    v_rcp_f32 v241, v241
    v_rcp_f32 v242, v242
    v_rcp_f32 v243, v243
    v_rcp_f32 v244, v244
    s_waitcnt lgkmcnt(4)
    v_mfma_f32_32x32x16_bf16 v[128:143], v[204:207], v[192:195], v[128:143]
    ds_read_b64_tr_b16 v[188:189], v30 offset:45056
    ds_read_b64_tr_b16 v[190:191], v30 offset:45568
    v_rcp_f32 v245, v245
    v_rcp_f32 v246, v246
    v_rcp_f32 v247, v247
    v_mul_f32 v240, v240, v88
    v_mfma_f32_32x32x16_bf16 v[144:159], v[204:207], v[196:199], v[144:159]
    v_mul_f32 v241, v241, v89
    s_waitcnt lgkmcnt(3)
    v_mfma_f32_32x32x16_bf16 v[96:111], v[184:187], v[176:179], v[96:111]
    ds_read_b128 v[192:195], v19 offset:4096
    ds_read_b64_tr_b16 v[200:201], v30 offset:22528
    v_mul_f32 v242, v242, v90
    v_mul_f32 v243, v243, v91
    v_mul_f32 v244, v244, v92
    s_waitcnt lgkmcnt(4)
    v_mfma_f32_32x32x16_bf16 v[112:127], v[184:187], v[180:183], v[112:127]
    ds_read_b64_tr_b16 v[202:203], v30 offset:23040
    ds_read_b128 v[196:199], v19 offset:8192
    v_mul_f32 v245, v245, v93
    v_mul_f32 v246, v246, v94
    v_mul_f32 v247, v247, v95
    s_waitcnt lgkmcnt(4)
    v_mfma_f32_32x32x16_bf16 v[128:143], v[188:191], v[176:179], v[128:143]
    ds_read_b64_tr_b16 v[204:205], v30 offset:47104
    ds_read_b64_tr_b16 v[206:207], v30 offset:47616
    v_cvt_pk_bf16_f32 v252, v240, v241
    v_cvt_pk_bf16_f32 v253, v242, v243
    v_cvt_pk_bf16_f32 v254, v244, v245
    v_mfma_f32_32x32x16_bf16 v[144:159], v[188:191], v[180:183], v[144:159]
    v_cvt_pk_bf16_f32 v255, v246, v247
    s_add_u32 s5, s14, 181248
    buffer_store_dwordx4 v[252:255], v6, s[64:67], s5 offen sc1
    s_waitcnt lgkmcnt(0)
    s_barrier
    v_mfma_f32_32x32x16_bf16 v[96:111], v[200:203], v[192:195], v[96:111]
    ds_read_b128 v[176:179], v16 offset:20480
    ds_read_b64_tr_b16 v[184:185], v30 offset:0
    v_readfirstlane_b32 s15, v1
    v_mul_f32 v212, v160, v226
    v_mul_f32 v213, v160, v227
    v_fma_f32 v160, -v168, v227, v212
    v_mfma_f32_32x32x16_bf16 v[112:127], v[200:203], v[196:199], v[112:127]
    ds_read_b64_tr_b16 v[186:187], v30 offset:512
    ds_read_b128 v[180:183], v16 offset:24576
    v_fma_f32 v168, -v168, v226, -v213
    v_mul_f32 v214, v161, v226
    v_mul_f32 v215, v161, v227
    v_fma_f32 v161, -v169, v227, v214
    v_mfma_f32_32x32x16_bf16 v[128:143], v[204:207], v[192:195], v[128:143]
    ds_read_b64_tr_b16 v[188:189], v30 offset:24576
    ds_read_b64_tr_b16 v[190:191], v30 offset:25088
    v_fma_f32 v169, -v169, v226, -v215
    v_mul_f32 v212, v162, v226
    v_mul_f32 v213, v162, v227
    v_fma_f32 v162, -v170, v227, v212
    v_mfma_f32_32x32x16_bf16 v[144:159], v[204:207], v[196:199], v[144:159]
    v_fma_f32 v170, -v170, v226, -v213
    s_waitcnt lgkmcnt(3)
    v_mfma_f32_32x32x16_bf16 v[96:111], v[184:187], v[176:179], v[96:111]
    ds_read_b128 v[192:195], v17 offset:20480
    ds_read_b64_tr_b16 v[200:201], v30 offset:2048
    v_mul_f32 v214, v163, v226
    v_mul_f32 v215, v163, v227
    v_fma_f32 v163, -v171, v227, v214
    v_fma_f32 v171, -v171, v226, -v215
    s_waitcnt lgkmcnt(4)
    v_mfma_f32_32x32x16_bf16 v[112:127], v[184:187], v[180:183], v[112:127]
    ds_read_b64_tr_b16 v[202:203], v30 offset:2560
    ds_read_b128 v[196:199], v17 offset:24576
    v_mul_f32 v212, v164, v226
    v_mul_f32 v213, v164, v227
    v_fma_f32 v164, -v172, v227, v212
    v_fma_f32 v172, -v172, v226, -v213
    s_waitcnt lgkmcnt(4)
    v_mfma_f32_32x32x16_bf16 v[128:143], v[188:191], v[176:179], v[128:143]
    ds_read_b64_tr_b16 v[204:205], v30 offset:26624
    ds_read_b64_tr_b16 v[206:207], v30 offset:27136
    v_mul_f32 v214, v165, v226
    v_mul_f32 v215, v165, v227
    v_fma_f32 v165, -v173, v227, v214
    v_fma_f32 v173, -v173, v226, -v215
    v_mfma_f32_32x32x16_bf16 v[144:159], v[188:191], v[180:183], v[144:159]
    v_mul_f32 v212, v166, v226
    s_waitcnt lgkmcnt(3)
    v_mfma_f32_32x32x16_bf16 v[96:111], v[200:203], v[192:195], v[96:111]
    ds_read_b128 v[176:179], v18 offset:20480
    ds_read_b64_tr_b16 v[184:185], v30 offset:4096
    v_mul_f32 v213, v166, v227
    v_fma_f32 v166, -v174, v227, v212
    v_fma_f32 v174, -v174, v226, -v213
    v_mul_f32 v214, v167, v226
    s_waitcnt lgkmcnt(4)
    v_mfma_f32_32x32x16_bf16 v[112:127], v[200:203], v[196:199], v[112:127]
    ds_read_b64_tr_b16 v[186:187], v30 offset:4608
    ds_read_b128 v[180:183], v18 offset:24576
    v_mul_f32 v215, v167, v227
    v_fma_f32 v167, -v175, v227, v214
    v_fma_f32 v175, -v175, v226, -v215
    s_lshl_b32 s4, s3, 10
    s_add_u32 s4, s4, 155648
    v_and_b32 v7, 15, v0
    s_waitcnt lgkmcnt(4)
    v_mfma_f32_32x32x16_bf16 v[128:143], v[204:207], v[192:195], v[128:143]
    ds_read_b64_tr_b16 v[188:189], v30 offset:28672
    ds_read_b64_tr_b16 v[190:191], v30 offset:29184
    v_lshlrev_b32 v7, 6, v7
    v_lshrrev_b32 v8, 4, v0
    v_lshl_add_u32 v7, v8, 4, v7
    v_add_u32 v7, s4, v7
    v_mfma_f32_32x32x16_bf16 v[144:159], v[204:207], v[196:199], v[144:159]
    v_lshrrev_b32 v9, 5, v0
    s_waitcnt lgkmcnt(3)
    v_mfma_f32_32x32x16_bf16 v[96:111], v[184:187], v[176:179], v[96:111]
    ds_read_b128 v[192:195], v19 offset:20480
    ds_read_b64_tr_b16 v[200:201], v30 offset:6144
    v_lshlrev_b32 v9, 3, v9
    v_bfe_u32 v10, v0, 2, 2
    v_add_u32 v9, v9, v10
    s_waitcnt lgkmcnt(4)
    v_mfma_f32_32x32x16_bf16 v[112:127], v[184:187], v[180:183], v[112:127]
    ds_read_b64_tr_b16 v[202:203], v30 offset:6656
    ds_read_b128 v[196:199], v19 offset:24576
    v_bfe_u32 v10, v0, 4, 1
    v_lshlrev_b32 v10, 5, v10
    v_and_b32 v11, 3, v0
    s_waitcnt lgkmcnt(4)
    v_mfma_f32_32x32x16_bf16 v[128:143], v[188:191], v[176:179], v[128:143]
    ds_read_b64_tr_b16 v[204:205], v30 offset:30720
    ds_read_b64_tr_b16 v[206:207], v30 offset:31232
    v_lshl_add_u32 v10, v11, 3, v10
    v_lshl_add_u32 v8, v9, 6, v10
    v_add_u32 v8, s4, v8
    v_mfma_f32_32x32x16_bf16 v[144:159], v[188:191], v[180:183], v[144:159]
    s_waitcnt vmcnt(0)
    v_mov_b32 v1, s15
    v_mov_b32 v2, 0
    s_mov_b64 exec, 1
    buffer_store_dword v1, v2, s[64:67], s81 offen offset:0 sc1
    s_mov_b64 exec, -1
    s_waitcnt lgkmcnt(0)
    s_barrier
    v_mfma_f32_32x32x16_bf16 v[96:111], v[200:203], v[192:195], v[96:111]
    ds_read_b128 v[176:179], v16 offset:36864
    ds_read_b64_tr_b16 v[184:185], v30 offset:8192
    v_mfma_f32_32x32x16_bf16 v[112:127], v[200:203], v[196:199], v[112:127]
    ds_read_b64_tr_b16 v[186:187], v30 offset:8704
    ds_read_b128 v[180:183], v16 offset:40960
    v_mfma_f32_32x32x16_bf16 v[128:143], v[204:207], v[192:195], v[128:143]
    ds_read_b64_tr_b16 v[188:189], v30 offset:32768
    ds_read_b64_tr_b16 v[190:191], v30 offset:33280
    v_mfma_f32_32x32x16_bf16 v[144:159], v[204:207], v[196:199], v[144:159]
    s_waitcnt lgkmcnt(3)
    v_mfma_f32_32x32x16_bf16 v[96:111], v[184:187], v[176:179], v[96:111]
    ds_read_b128 v[192:195], v17 offset:36864
    ds_read_b64_tr_b16 v[200:201], v30 offset:10240
    s_waitcnt lgkmcnt(4)
    v_mfma_f32_32x32x16_bf16 v[112:127], v[184:187], v[180:183], v[112:127]
    ds_read_b64_tr_b16 v[202:203], v30 offset:10752
    ds_read_b128 v[196:199], v17 offset:40960
    s_waitcnt lgkmcnt(4)
    v_mfma_f32_32x32x16_bf16 v[128:143], v[188:191], v[176:179], v[128:143]
    ds_read_b64_tr_b16 v[204:205], v30 offset:34816
    ds_read_b64_tr_b16 v[206:207], v30 offset:35328
    v_mfma_f32_32x32x16_bf16 v[144:159], v[188:191], v[180:183], v[144:159]
    s_waitcnt lgkmcnt(3)
    v_mfma_f32_32x32x16_bf16 v[96:111], v[200:203], v[192:195], v[96:111]
    ds_read_b128 v[176:179], v18 offset:36864
    ds_read_b64_tr_b16 v[184:185], v30 offset:12288
    s_waitcnt lgkmcnt(4)
    v_mfma_f32_32x32x16_bf16 v[112:127], v[200:203], v[196:199], v[112:127]
    ds_read_b64_tr_b16 v[186:187], v30 offset:12800
    ds_read_b128 v[180:183], v18 offset:40960
    s_waitcnt lgkmcnt(4)
    v_mfma_f32_32x32x16_bf16 v[128:143], v[204:207], v[192:195], v[128:143]
    ds_read_b64_tr_b16 v[188:189], v30 offset:36864
    ds_read_b64_tr_b16 v[190:191], v30 offset:37376
    v_mfma_f32_32x32x16_bf16 v[144:159], v[204:207], v[196:199], v[144:159]
    s_waitcnt lgkmcnt(3)
    v_mfma_f32_32x32x16_bf16 v[96:111], v[184:187], v[176:179], v[96:111]
    ds_read_b128 v[192:195], v19 offset:36864
    ds_read_b64_tr_b16 v[200:201], v30 offset:14336
    s_waitcnt lgkmcnt(4)
    v_mfma_f32_32x32x16_bf16 v[112:127], v[184:187], v[180:183], v[112:127]
    ds_read_b64_tr_b16 v[202:203], v30 offset:14848
    ds_read_b128 v[196:199], v19 offset:40960
    s_waitcnt lgkmcnt(4)
    v_mfma_f32_32x32x16_bf16 v[128:143], v[188:191], v[176:179], v[128:143]
    ds_read_b64_tr_b16 v[204:205], v30 offset:38912
    ds_read_b64_tr_b16 v[206:207], v30 offset:39424
    v_mfma_f32_32x32x16_bf16 v[144:159], v[188:191], v[180:183], v[144:159]
    s_waitcnt lgkmcnt(0)
    s_barrier
    v_add_u32 v16, 49152, v16
    v_add_u32 v17, 49152, v17
    v_add_u32 v18, 49152, v18
    v_add_u32 v19, 49152, v19
    v_mfma_f32_32x32x16_bf16 v[96:111], v[200:203], v[192:195], v[96:111]
    ds_read_b128 v[176:179], v16 offset:36864
    ds_read_b64_tr_b16 v[184:185], v30 offset:16384
    ds_read_b32 v208, v5 offset:0
    ds_read_b32 v209, v5 offset:1024
    s_waitcnt lgkmcnt(0)
    v_mul_f32 v212, v208, v226
    v_mul_f32 v213, v208, v227
    v_mfma_f32_32x32x16_bf16 v[112:127], v[200:203], v[196:199], v[112:127]
    ds_read_b64_tr_b16 v[186:187], v30 offset:16896
    ds_read_b128 v[180:183], v16 offset:40960
    v_fma_f32 v208, -v209, v227, v212
    v_fma_f32 v209, -v209, v226, -v213
    v_fma_f32 v160, v208, v224, v160
    v_fma_f32 v168, v209, v224, v168
    v_mfma_f32_32x32x16_bf16 v[128:143], v[204:207], v[192:195], v[128:143]
    ds_read_b64_tr_b16 v[188:189], v30 offset:40960
    ds_read_b64_tr_b16 v[190:191], v30 offset:41472
    v_fma_f32 v160, v209, v225, v160
    v_fma_f32 v168, -v208, v225, v168
    v_fma_f32 v161, v160, v224, v161
    v_fma_f32 v169, v168, v224, v169
    v_mfma_f32_32x32x16_bf16 v[144:159], v[204:207], v[196:199], v[144:159]
    v_fma_f32 v161, v168, v225, v161
    v_fma_f32 v169, -v160, v225, v169
    v_fma_f32 v162, v161, v224, v162
    s_waitcnt lgkmcnt(3)
    v_mfma_f32_32x32x16_bf16 v[96:111], v[184:187], v[176:179], v[96:111]
    ds_read_b128 v[192:195], v17 offset:36864
    ds_read_b64_tr_b16 v[200:201], v30 offset:18432
    v_fma_f32 v170, v169, v224, v170
    v_fma_f32 v162, v169, v225, v162
    v_fma_f32 v170, -v161, v225, v170
    v_fma_f32 v163, v162, v224, v163
    s_waitcnt lgkmcnt(4)
    v_mfma_f32_32x32x16_bf16 v[112:127], v[184:187], v[180:183], v[112:127]
    ds_read_b64_tr_b16 v[202:203], v30 offset:18944
    ds_read_b128 v[196:199], v17 offset:40960
    v_fma_f32 v171, v170, v224, v171
    v_fma_f32 v163, v170, v225, v163
    v_fma_f32 v171, -v162, v225, v171
    v_fma_f32 v164, v163, v224, v164
    s_waitcnt lgkmcnt(4)
    v_mfma_f32_32x32x16_bf16 v[128:143], v[188:191], v[176:179], v[128:143]
    ds_read_b64_tr_b16 v[204:205], v30 offset:43008
    ds_read_b64_tr_b16 v[206:207], v30 offset:43520
    v_fma_f32 v172, v171, v224, v172
    v_fma_f32 v164, v171, v225, v164
    v_fma_f32 v172, -v163, v225, v172
    v_fma_f32 v165, v164, v224, v165
    v_mfma_f32_32x32x16_bf16 v[144:159], v[188:191], v[180:183], v[144:159]
    v_fma_f32 v173, v172, v224, v173
    v_fma_f32 v165, v172, v225, v165
    v_fma_f32 v173, -v164, v225, v173
    s_waitcnt lgkmcnt(3)
    v_mfma_f32_32x32x16_bf16 v[96:111], v[200:203], v[192:195], v[96:111]
    ds_read_b128 v[176:179], v18 offset:36864
    ds_read_b64_tr_b16 v[184:185], v30 offset:20480
    v_fma_f32 v166, v165, v224, v166
    v_fma_f32 v174, v173, v224, v174
    v_fma_f32 v166, v173, v225, v166
    v_fma_f32 v174, -v165, v225, v174
    s_waitcnt lgkmcnt(4)
    v_mfma_f32_32x32x16_bf16 v[112:127], v[200:203], v[196:199], v[112:127]
    ds_read_b64_tr_b16 v[186:187], v30 offset:20992
    ds_read_b128 v[180:183], v18 offset:40960
    v_fma_f32 v167, v166, v224, v167
    v_fma_f32 v175, v174, v224, v175
    v_fma_f32 v167, v174, v225, v167
    v_fma_f32 v175, -v166, v225, v175
    s_waitcnt lgkmcnt(4)
    v_mfma_f32_32x32x16_bf16 v[128:143], v[204:207], v[192:195], v[128:143]
    ds_read_b64_tr_b16 v[188:189], v30 offset:45056
    ds_read_b64_tr_b16 v[190:191], v30 offset:45568
    v_cvt_pk_bf16_f32 v232, v160, v161
    v_cvt_pk_bf16_f32 v233, v162, v163
    v_cvt_pk_bf16_f32 v234, v164, v165
    v_cvt_pk_bf16_f32 v235, v166, v167
    v_mfma_f32_32x32x16_bf16 v[144:159], v[204:207], v[196:199], v[144:159]
    v_cvt_pk_bf16_f32 v236, v168, v169
    v_cvt_pk_bf16_f32 v237, v170, v171
    v_cvt_pk_bf16_f32 v238, v172, v173
    s_waitcnt lgkmcnt(3)
    v_mfma_f32_32x32x16_bf16 v[96:111], v[184:187], v[176:179], v[96:111]
    ds_read_b128 v[192:195], v19 offset:36864
    ds_read_b64_tr_b16 v[200:201], v30 offset:22528
    v_cvt_pk_bf16_f32 v239, v174, v175
    ds_write_b128 v7, v[232:235]
    ds_read_b64_tr_b16 v[240:241], v8
    ds_read_b64_tr_b16 v[242:243], v8 offset:256
    s_waitcnt lgkmcnt(7)
    v_mfma_f32_32x32x16_bf16 v[112:127], v[184:187], v[180:183], v[112:127]
    ds_read_b64_tr_b16 v[202:203], v30 offset:23040
    ds_read_b128 v[196:199], v19 offset:40960
    ds_write_b128 v7, v[236:239]
    ds_read_b64_tr_b16 v[244:245], v8
    ds_read_b64_tr_b16 v[246:247], v8 offset:256
    s_nop 0
    s_waitcnt lgkmcnt(10)
    v_mfma_f32_32x32x16_bf16 v[128:143], v[188:191], v[176:179], v[128:143]
    ds_read_b64_tr_b16 v[204:205], v30 offset:47104
    ds_read_b64_tr_b16 v[206:207], v30 offset:47616
    s_nop 0
    s_nop 0
    s_nop 0
    s_nop 0
    v_mfma_f32_32x32x16_bf16 v[144:159], v[188:191], v[180:183], v[144:159]
    s_nop 0
    s_waitcnt lgkmcnt(7)
    buffer_store_dwordx4 v[240:243], v6, s[64:67], s82 offen sc1
    s_waitcnt lgkmcnt(2)
    buffer_store_dwordx4 v[244:247], v6, s[64:67], s83 offen sc1
    s_waitcnt lgkmcnt(0)
    s_barrier
    v_mfma_f32_32x32x16_bf16 v[96:111], v[200:203], v[192:195], v[96:111]
    ds_read_b128 v[176:179], v16 offset:4096
    ds_read_b64_tr_b16 v[184:185], v30 offset:0
    v_mfma_f32_32x32x16_bf16 v[112:127], v[200:203], v[196:199], v[112:127]
    ds_read_b64_tr_b16 v[186:187], v30 offset:512
    ds_read_b128 v[180:183], v16 offset:8192
    v_mfma_f32_32x32x16_bf16 v[128:143], v[204:207], v[192:195], v[128:143]
    ds_read_b64_tr_b16 v[188:189], v30 offset:24576
    ds_read_b64_tr_b16 v[190:191], v30 offset:25088
    v_mfma_f32_32x32x16_bf16 v[144:159], v[204:207], v[196:199], v[144:159]
    s_waitcnt lgkmcnt(3)
    v_mfma_f32_32x32x16_bf16 v[96:111], v[184:187], v[176:179], v[96:111]
    ds_read_b128 v[192:195], v17 offset:4096
    ds_read_b64_tr_b16 v[200:201], v30 offset:2048
    s_waitcnt lgkmcnt(4)
    v_mfma_f32_32x32x16_bf16 v[112:127], v[184:187], v[180:183], v[112:127]
    ds_read_b64_tr_b16 v[202:203], v30 offset:2560
    ds_read_b128 v[196:199], v17 offset:8192
    s_waitcnt lgkmcnt(4)
    v_mfma_f32_32x32x16_bf16 v[128:143], v[188:191], v[176:179], v[128:143]
    ds_read_b64_tr_b16 v[204:205], v30 offset:26624
    ds_read_b64_tr_b16 v[206:207], v30 offset:27136
    v_mfma_f32_32x32x16_bf16 v[144:159], v[188:191], v[180:183], v[144:159]
    s_waitcnt lgkmcnt(3)
    v_mfma_f32_32x32x16_bf16 v[96:111], v[200:203], v[192:195], v[96:111]
    ds_read_b128 v[176:179], v18 offset:4096
    ds_read_b64_tr_b16 v[184:185], v30 offset:4096
    s_waitcnt lgkmcnt(4)
    v_mfma_f32_32x32x16_bf16 v[112:127], v[200:203], v[196:199], v[112:127]
    ds_read_b64_tr_b16 v[186:187], v30 offset:4608
    ds_read_b128 v[180:183], v18 offset:8192
    s_waitcnt lgkmcnt(4)
    v_mfma_f32_32x32x16_bf16 v[128:143], v[204:207], v[192:195], v[128:143]
    ds_read_b64_tr_b16 v[188:189], v30 offset:28672
    ds_read_b64_tr_b16 v[190:191], v30 offset:29184
    v_mfma_f32_32x32x16_bf16 v[144:159], v[204:207], v[196:199], v[144:159]
    s_waitcnt lgkmcnt(3)
    v_mfma_f32_32x32x16_bf16 v[96:111], v[184:187], v[176:179], v[96:111]
    ds_read_b128 v[192:195], v19 offset:4096
    ds_read_b64_tr_b16 v[200:201], v30 offset:6144
    s_waitcnt lgkmcnt(4)
    v_mfma_f32_32x32x16_bf16 v[112:127], v[184:187], v[180:183], v[112:127]
    ds_read_b64_tr_b16 v[202:203], v30 offset:6656
    ds_read_b128 v[196:199], v19 offset:8192
    s_waitcnt lgkmcnt(4)
    v_mfma_f32_32x32x16_bf16 v[128:143], v[188:191], v[176:179], v[128:143]
    ds_read_b64_tr_b16 v[204:205], v30 offset:30720
    ds_read_b64_tr_b16 v[206:207], v30 offset:31232
    v_mfma_f32_32x32x16_bf16 v[144:159], v[188:191], v[180:183], v[144:159]
    s_waitcnt lgkmcnt(3)
    v_mfma_f32_32x32x16_bf16 v[96:111], v[200:203], v[192:195], v[96:111]
    s_waitcnt lgkmcnt(2)
    v_mfma_f32_32x32x16_bf16 v[112:127], v[200:203], v[196:199], v[112:127]
    s_waitcnt lgkmcnt(0)
    v_mfma_f32_32x32x16_bf16 v[128:143], v[204:207], v[192:195], v[128:143]
    v_mfma_f32_32x32x16_bf16 v[144:159], v[204:207], v[196:199], v[144:159]
    s_branch L_4
L_3:
    s_barrier
    ds_read_b128 v[176:179], v12 offset:4096
    ds_read_b128 v[184:187], v20 offset:0
    ds_read_b128 v[180:183], v12 offset:5120
    ds_read_b128 v[188:191], v20 offset:24576
    s_waitcnt lgkmcnt(2)
    v_mfma_f32_32x32x16_bf16 v[32:47], v[176:179], v[184:187], 0
    ds_read_b128 v[192:195], v13 offset:4096
    ds_read_b128 v[200:203], v21 offset:0
    s_waitcnt lgkmcnt(3)
    v_mfma_f32_32x32x16_bf16 v[48:63], v[180:183], v[184:187], 0
    ds_read_b128 v[196:199], v13 offset:5120
    ds_read_b128 v[204:207], v21 offset:24576
    s_waitcnt lgkmcnt(4)
    v_mfma_f32_32x32x16_bf16 v[64:79], v[176:179], v[188:191], 0
    ds_read_b128 v[208:211], v24 offset:4096
    ds_read_b128 v[212:215], v26 offset:4096
    v_mfma_f32_32x32x16_bf16 v[80:95], v[180:183], v[188:191], 0
    ds_read_b128 v[216:219], v28 offset:0
    ds_read_b128 v[220:223], v28 offset:2048
    s_waitcnt lgkmcnt(6)
    v_mfma_f32_32x32x16_bf16 v[32:47], v[192:195], v[200:203], v[32:47]
    ds_read_b128 v[176:179], v14 offset:4096
    ds_read_b128 v[184:187], v22 offset:0
    s_waitcnt lgkmcnt(7)
    v_mfma_f32_32x32x16_bf16 v[48:63], v[196:199], v[200:203], v[48:63]
    ds_read_b128 v[180:183], v14 offset:5120
    ds_read_b128 v[188:191], v22 offset:24576
    s_waitcnt lgkmcnt(5)
    v_mfma_f32_16x16x32_bf16 v[160:163], v[208:211], v[216:219], 0
    v_mfma_f32_16x16x32_bf16 v[164:167], v[212:215], v[216:219], 0
    s_waitcnt lgkmcnt(4)
    v_mfma_f32_16x16x32_bf16 v[168:171], v[208:211], v[220:223], 0
    v_mfma_f32_16x16x32_bf16 v[172:175], v[212:215], v[220:223], 0
    v_mfma_f32_32x32x16_bf16 v[64:79], v[192:195], v[204:207], v[64:79]
    v_mfma_f32_32x32x16_bf16 v[80:95], v[196:199], v[204:207], v[80:95]
    s_waitcnt lgkmcnt(2)
    v_mfma_f32_32x32x16_bf16 v[32:47], v[176:179], v[184:187], v[32:47]
    ds_read_b128 v[192:195], v15 offset:4096
    ds_read_b128 v[200:203], v23 offset:0
    s_waitcnt lgkmcnt(3)
    v_mfma_f32_32x32x16_bf16 v[48:63], v[180:183], v[184:187], v[48:63]
    ds_read_b128 v[196:199], v15 offset:5120
    ds_read_b128 v[204:207], v23 offset:24576
    s_waitcnt lgkmcnt(4)
    v_mfma_f32_32x32x16_bf16 v[64:79], v[176:179], v[188:191], v[64:79]
    ds_read_b128 v[208:211], v25 offset:4096
    ds_read_b128 v[212:215], v27 offset:4096
    v_mfma_f32_32x32x16_bf16 v[80:95], v[180:183], v[188:191], v[80:95]
    ds_read_b128 v[216:219], v29 offset:0
    ds_read_b128 v[220:223], v29 offset:2048
    s_waitcnt lgkmcnt(0)
    s_barrier
    v_mfma_f32_32x32x16_bf16 v[32:47], v[192:195], v[200:203], v[32:47]
    ds_read_b128 v[176:179], v12 offset:20480
    ds_read_b128 v[184:187], v20 offset:8192
    v_mfma_f32_32x32x16_bf16 v[48:63], v[196:199], v[200:203], v[48:63]
    ds_read_b128 v[180:183], v12 offset:21504
    ds_read_b128 v[188:191], v20 offset:32768
    v_mfma_f32_16x16x32_bf16 v[160:163], v[208:211], v[216:219], v[160:163]
    v_mfma_f32_16x16x32_bf16 v[164:167], v[212:215], v[216:219], v[164:167]
    v_mfma_f32_16x16x32_bf16 v[168:171], v[208:211], v[220:223], v[168:171]
    v_mfma_f32_16x16x32_bf16 v[172:175], v[212:215], v[220:223], v[172:175]
    v_mfma_f32_32x32x16_bf16 v[64:79], v[192:195], v[204:207], v[64:79]
    v_mfma_f32_32x32x16_bf16 v[80:95], v[196:199], v[204:207], v[80:95]
    s_waitcnt lgkmcnt(2)
    v_mfma_f32_32x32x16_bf16 v[32:47], v[176:179], v[184:187], v[32:47]
    ds_read_b128 v[192:195], v13 offset:20480
    ds_read_b128 v[200:203], v21 offset:8192
    s_waitcnt lgkmcnt(3)
    v_mfma_f32_32x32x16_bf16 v[48:63], v[180:183], v[184:187], v[48:63]
    ds_read_b128 v[196:199], v13 offset:21504
    ds_read_b128 v[204:207], v21 offset:32768
    s_waitcnt lgkmcnt(4)
    v_mfma_f32_32x32x16_bf16 v[64:79], v[176:179], v[188:191], v[64:79]
    ds_read_b128 v[208:211], v24 offset:20480
    ds_read_b128 v[212:215], v26 offset:20480
    v_mfma_f32_32x32x16_bf16 v[80:95], v[180:183], v[188:191], v[80:95]
    ds_read_b128 v[216:219], v28 offset:4096
    ds_read_b128 v[220:223], v28 offset:6144
    s_waitcnt lgkmcnt(6)
    v_mfma_f32_32x32x16_bf16 v[32:47], v[192:195], v[200:203], v[32:47]
    ds_read_b128 v[176:179], v14 offset:20480
    ds_read_b128 v[184:187], v22 offset:8192
    s_waitcnt lgkmcnt(7)
    v_mfma_f32_32x32x16_bf16 v[48:63], v[196:199], v[200:203], v[48:63]
    ds_read_b128 v[180:183], v14 offset:21504
    ds_read_b128 v[188:191], v22 offset:32768
    s_waitcnt lgkmcnt(5)
    v_mfma_f32_16x16x32_bf16 v[160:163], v[208:211], v[216:219], v[160:163]
    v_mfma_f32_16x16x32_bf16 v[164:167], v[212:215], v[216:219], v[164:167]
    s_waitcnt lgkmcnt(4)
    v_mfma_f32_16x16x32_bf16 v[168:171], v[208:211], v[220:223], v[168:171]
    v_mfma_f32_16x16x32_bf16 v[172:175], v[212:215], v[220:223], v[172:175]
    v_mfma_f32_32x32x16_bf16 v[64:79], v[192:195], v[204:207], v[64:79]
    v_mfma_f32_32x32x16_bf16 v[80:95], v[196:199], v[204:207], v[80:95]
    s_waitcnt lgkmcnt(2)
    v_mfma_f32_32x32x16_bf16 v[32:47], v[176:179], v[184:187], v[32:47]
    ds_read_b128 v[192:195], v15 offset:20480
    ds_read_b128 v[200:203], v23 offset:8192
    s_waitcnt lgkmcnt(3)
    v_mfma_f32_32x32x16_bf16 v[48:63], v[180:183], v[184:187], v[48:63]
    ds_read_b128 v[196:199], v15 offset:21504
    ds_read_b128 v[204:207], v23 offset:32768
    s_waitcnt lgkmcnt(4)
    v_mfma_f32_32x32x16_bf16 v[64:79], v[176:179], v[188:191], v[64:79]
    ds_read_b128 v[208:211], v25 offset:20480
    ds_read_b128 v[212:215], v27 offset:20480
    v_mfma_f32_32x32x16_bf16 v[80:95], v[180:183], v[188:191], v[80:95]
    ds_read_b128 v[216:219], v29 offset:4096
    ds_read_b128 v[220:223], v29 offset:6144
    s_waitcnt lgkmcnt(0)
    s_barrier
    v_mfma_f32_32x32x16_bf16 v[32:47], v[192:195], v[200:203], v[32:47]
    ds_read_b128 v[176:179], v12 offset:36864
    ds_read_b128 v[184:187], v20 offset:16384
    v_mfma_f32_32x32x16_bf16 v[48:63], v[196:199], v[200:203], v[48:63]
    ds_read_b128 v[180:183], v12 offset:37888
    ds_read_b128 v[188:191], v20 offset:40960
    v_mfma_f32_16x16x32_bf16 v[160:163], v[208:211], v[216:219], v[160:163]
    v_mfma_f32_16x16x32_bf16 v[164:167], v[212:215], v[216:219], v[164:167]
    v_mfma_f32_16x16x32_bf16 v[168:171], v[208:211], v[220:223], v[168:171]
    v_mfma_f32_16x16x32_bf16 v[172:175], v[212:215], v[220:223], v[172:175]
    v_mfma_f32_32x32x16_bf16 v[64:79], v[192:195], v[204:207], v[64:79]
    v_mfma_f32_32x32x16_bf16 v[80:95], v[196:199], v[204:207], v[80:95]
    s_waitcnt lgkmcnt(2)
    v_mfma_f32_32x32x16_bf16 v[32:47], v[176:179], v[184:187], v[32:47]
    ds_read_b128 v[192:195], v13 offset:36864
    ds_read_b128 v[200:203], v21 offset:16384
    s_waitcnt lgkmcnt(3)
    v_mfma_f32_32x32x16_bf16 v[48:63], v[180:183], v[184:187], v[48:63]
    ds_read_b128 v[196:199], v13 offset:37888
    ds_read_b128 v[204:207], v21 offset:40960
    s_waitcnt lgkmcnt(4)
    v_mfma_f32_32x32x16_bf16 v[64:79], v[176:179], v[188:191], v[64:79]
    ds_read_b128 v[208:211], v24 offset:36864
    ds_read_b128 v[212:215], v26 offset:36864
    v_mfma_f32_32x32x16_bf16 v[80:95], v[180:183], v[188:191], v[80:95]
    ds_read_b128 v[216:219], v28 offset:8192
    ds_read_b128 v[220:223], v28 offset:10240
    s_waitcnt lgkmcnt(6)
    v_mfma_f32_32x32x16_bf16 v[32:47], v[192:195], v[200:203], v[32:47]
    ds_read_b128 v[176:179], v14 offset:36864
    ds_read_b128 v[184:187], v22 offset:16384
    s_waitcnt lgkmcnt(7)
    v_mfma_f32_32x32x16_bf16 v[48:63], v[196:199], v[200:203], v[48:63]
    ds_read_b128 v[180:183], v14 offset:37888
    ds_read_b128 v[188:191], v22 offset:40960
    s_waitcnt lgkmcnt(5)
    v_mfma_f32_16x16x32_bf16 v[160:163], v[208:211], v[216:219], v[160:163]
    v_mfma_f32_16x16x32_bf16 v[164:167], v[212:215], v[216:219], v[164:167]
    s_waitcnt lgkmcnt(4)
    v_mfma_f32_16x16x32_bf16 v[168:171], v[208:211], v[220:223], v[168:171]
    v_mfma_f32_16x16x32_bf16 v[172:175], v[212:215], v[220:223], v[172:175]
    v_mfma_f32_32x32x16_bf16 v[64:79], v[192:195], v[204:207], v[64:79]
    v_mfma_f32_32x32x16_bf16 v[80:95], v[196:199], v[204:207], v[80:95]
    s_waitcnt lgkmcnt(2)
    v_mfma_f32_32x32x16_bf16 v[32:47], v[176:179], v[184:187], v[32:47]
    ds_read_b128 v[192:195], v15 offset:36864
    ds_read_b128 v[200:203], v23 offset:16384
    s_waitcnt lgkmcnt(3)
    v_mfma_f32_32x32x16_bf16 v[48:63], v[180:183], v[184:187], v[48:63]
    ds_read_b128 v[196:199], v15 offset:37888
    ds_read_b128 v[204:207], v23 offset:40960
    s_waitcnt lgkmcnt(4)
    v_mfma_f32_32x32x16_bf16 v[64:79], v[176:179], v[188:191], v[64:79]
    ds_read_b128 v[208:211], v25 offset:36864
    ds_read_b128 v[212:215], v27 offset:36864
    v_mfma_f32_32x32x16_bf16 v[80:95], v[180:183], v[188:191], v[80:95]
    ds_read_b128 v[216:219], v29 offset:8192
    ds_read_b128 v[220:223], v29 offset:10240
    s_waitcnt lgkmcnt(0)
    s_barrier
    v_add_u32 v12, 49152, v12
    v_add_u32 v13, 49152, v13
    v_add_u32 v14, 49152, v14
    v_add_u32 v15, 49152, v15
    v_add_u32 v16, 49152, v16
    v_add_u32 v17, 49152, v17
    v_add_u32 v18, 49152, v18
    v_add_u32 v19, 49152, v19
    v_add_u32 v24, 49152, v24
    v_add_u32 v25, 49152, v25
    v_add_u32 v26, 49152, v26
    v_add_u32 v27, 49152, v27
    v_mfma_f32_32x32x16_bf16 v[32:47], v[192:195], v[200:203], v[32:47]
    ds_read_b128 v[176:179], v12 offset:4096
    ds_read_b128 v[184:187], v20 offset:0
    v_mfma_f32_32x32x16_bf16 v[48:63], v[196:199], v[200:203], v[48:63]
    ds_read_b128 v[180:183], v12 offset:5120
    ds_read_b128 v[188:191], v20 offset:24576
    v_mfma_f32_16x16x32_bf16 v[160:163], v[208:211], v[216:219], v[160:163]
    v_mfma_f32_16x16x32_bf16 v[164:167], v[212:215], v[216:219], v[164:167]
    v_mfma_f32_16x16x32_bf16 v[168:171], v[208:211], v[220:223], v[168:171]
    v_mfma_f32_16x16x32_bf16 v[172:175], v[212:215], v[220:223], v[172:175]
    v_mfma_f32_32x32x16_bf16 v[64:79], v[192:195], v[204:207], v[64:79]
    v_mfma_f32_32x32x16_bf16 v[80:95], v[196:199], v[204:207], v[80:95]
    s_cmp_lg_u32 s3, 1
    s_cbranch_scc1 L_36
    s_mov_b32 s52, s16
    s_mov_b32 s53, s17
    s_mov_b32 s54, 2097152
    s_mov_b32 s55, 0x20000
    s_mov_b32 s56, s36
    s_mov_b32 s57, s37
    s_mov_b32 s58, 1835008
    s_mov_b32 s59, 0x20000
    v_and_b32 v1, 7, v0
    v_min_u32 v1, 3, v1
    v_lshlrev_b32 v1, 7, v1
    v_lshrrev_b32 v2, 3, v0
    v_lshl_add_u32 v1, v2, 10, v1
    s_lshl_b32 s4, s2, 13
    s_add_u32 s4, s4, 512
    buffer_load_dword v8, v1, s[52:55], s4 offen
    v_min_u32 v1, 27, v0
    v_lshlrev_b32 v1, 7, v1
    s_mul_i32 s4, s2, 3584
    s_add_u32 s4, s4, 917504
    buffer_load_dword v8, v1, s[56:59], s4 offen
    s_mov_b32 s60, s38
    s_mov_b32 s61, s39
    s_mov_b32 s62, 1835008
    s_mov_b32 s63, 0x20000
    buffer_load_dword v8, v1, s[60:63], s4 offen
L_36:
    s_waitcnt lgkmcnt(2)
    v_mfma_f32_32x32x16_bf16 v[32:47], v[176:179], v[184:187], v[32:47]
    ds_read_b128 v[192:195], v13 offset:4096
    ds_read_b128 v[200:203], v21 offset:0
    s_waitcnt lgkmcnt(3)
    v_mfma_f32_32x32x16_bf16 v[48:63], v[180:183], v[184:187], v[48:63]
    ds_read_b128 v[196:199], v13 offset:5120
    ds_read_b128 v[204:207], v21 offset:24576
    s_waitcnt lgkmcnt(4)
    v_mfma_f32_32x32x16_bf16 v[64:79], v[176:179], v[188:191], v[64:79]
    ds_read_b128 v[208:211], v24 offset:4096
    ds_read_b128 v[212:215], v26 offset:4096
    v_mfma_f32_32x32x16_bf16 v[80:95], v[180:183], v[188:191], v[80:95]
    ds_read_b128 v[216:219], v28 offset:0
    ds_read_b128 v[220:223], v28 offset:2048
    s_waitcnt lgkmcnt(6)
    v_mfma_f32_32x32x16_bf16 v[32:47], v[192:195], v[200:203], v[32:47]
    ds_read_b128 v[176:179], v14 offset:4096
    ds_read_b128 v[184:187], v22 offset:0
    s_waitcnt lgkmcnt(7)
    v_mfma_f32_32x32x16_bf16 v[48:63], v[196:199], v[200:203], v[48:63]
    ds_read_b128 v[180:183], v14 offset:5120
    ds_read_b128 v[188:191], v22 offset:24576
    s_waitcnt lgkmcnt(5)
    v_mfma_f32_16x16x32_bf16 v[160:163], v[208:211], v[216:219], v[160:163]
    v_mfma_f32_16x16x32_bf16 v[164:167], v[212:215], v[216:219], v[164:167]
    s_waitcnt lgkmcnt(4)
    v_mfma_f32_16x16x32_bf16 v[168:171], v[208:211], v[220:223], v[168:171]
    v_mfma_f32_16x16x32_bf16 v[172:175], v[212:215], v[220:223], v[172:175]
    v_mfma_f32_32x32x16_bf16 v[64:79], v[192:195], v[204:207], v[64:79]
    v_mfma_f32_32x32x16_bf16 v[80:95], v[196:199], v[204:207], v[80:95]
    s_waitcnt lgkmcnt(2)
    v_mfma_f32_32x32x16_bf16 v[32:47], v[176:179], v[184:187], v[32:47]
    ds_read_b128 v[192:195], v15 offset:4096
    ds_read_b128 v[200:203], v23 offset:0
    s_waitcnt lgkmcnt(3)
    v_mfma_f32_32x32x16_bf16 v[48:63], v[180:183], v[184:187], v[48:63]
    ds_read_b128 v[196:199], v15 offset:5120
    ds_read_b128 v[204:207], v23 offset:24576
    s_waitcnt lgkmcnt(4)
    v_mfma_f32_32x32x16_bf16 v[64:79], v[176:179], v[188:191], v[64:79]
    ds_read_b128 v[208:211], v25 offset:4096
    ds_read_b128 v[212:215], v27 offset:4096
    v_mfma_f32_32x32x16_bf16 v[80:95], v[180:183], v[188:191], v[80:95]
    ds_read_b128 v[216:219], v29 offset:0
    ds_read_b128 v[220:223], v29 offset:2048
    s_waitcnt lgkmcnt(0)
    s_barrier
    v_mfma_f32_32x32x16_bf16 v[32:47], v[192:195], v[200:203], v[32:47]
    ds_read_b128 v[176:179], v12 offset:20480
    ds_read_b128 v[184:187], v20 offset:8192
    v_mfma_f32_32x32x16_bf16 v[48:63], v[196:199], v[200:203], v[48:63]
    ds_read_b128 v[180:183], v12 offset:21504
    ds_read_b128 v[188:191], v20 offset:32768
    v_mfma_f32_16x16x32_bf16 v[160:163], v[208:211], v[216:219], v[160:163]
    v_mfma_f32_16x16x32_bf16 v[164:167], v[212:215], v[216:219], v[164:167]
    v_mfma_f32_16x16x32_bf16 v[168:171], v[208:211], v[220:223], v[168:171]
    v_mfma_f32_16x16x32_bf16 v[172:175], v[212:215], v[220:223], v[172:175]
    v_mfma_f32_32x32x16_bf16 v[64:79], v[192:195], v[204:207], v[64:79]
    v_mfma_f32_32x32x16_bf16 v[80:95], v[196:199], v[204:207], v[80:95]
    s_waitcnt lgkmcnt(2)
    v_mfma_f32_32x32x16_bf16 v[32:47], v[176:179], v[184:187], v[32:47]
    ds_read_b128 v[192:195], v13 offset:20480
    ds_read_b128 v[200:203], v21 offset:8192
    s_waitcnt lgkmcnt(3)
    v_mfma_f32_32x32x16_bf16 v[48:63], v[180:183], v[184:187], v[48:63]
    ds_read_b128 v[196:199], v13 offset:21504
    ds_read_b128 v[204:207], v21 offset:32768
    s_waitcnt lgkmcnt(4)
    v_mfma_f32_32x32x16_bf16 v[64:79], v[176:179], v[188:191], v[64:79]
    ds_read_b128 v[208:211], v24 offset:20480
    ds_read_b128 v[212:215], v26 offset:20480
    v_mfma_f32_32x32x16_bf16 v[80:95], v[180:183], v[188:191], v[80:95]
    ds_read_b128 v[216:219], v28 offset:4096
    ds_read_b128 v[220:223], v28 offset:6144
    s_waitcnt lgkmcnt(6)
    v_mfma_f32_32x32x16_bf16 v[32:47], v[192:195], v[200:203], v[32:47]
    ds_read_b128 v[176:179], v14 offset:20480
    ds_read_b128 v[184:187], v22 offset:8192
    s_waitcnt lgkmcnt(7)
    v_mfma_f32_32x32x16_bf16 v[48:63], v[196:199], v[200:203], v[48:63]
    ds_read_b128 v[180:183], v14 offset:21504
    ds_read_b128 v[188:191], v22 offset:32768
    s_waitcnt lgkmcnt(5)
    v_mfma_f32_16x16x32_bf16 v[160:163], v[208:211], v[216:219], v[160:163]
    v_mfma_f32_16x16x32_bf16 v[164:167], v[212:215], v[216:219], v[164:167]
    s_waitcnt lgkmcnt(4)
    v_mfma_f32_16x16x32_bf16 v[168:171], v[208:211], v[220:223], v[168:171]
    v_mfma_f32_16x16x32_bf16 v[172:175], v[212:215], v[220:223], v[172:175]
    v_mfma_f32_32x32x16_bf16 v[64:79], v[192:195], v[204:207], v[64:79]
    v_mfma_f32_32x32x16_bf16 v[80:95], v[196:199], v[204:207], v[80:95]
    s_waitcnt lgkmcnt(2)
    v_mfma_f32_32x32x16_bf16 v[32:47], v[176:179], v[184:187], v[32:47]
    ds_read_b128 v[192:195], v15 offset:20480
    ds_read_b128 v[200:203], v23 offset:8192
    s_waitcnt lgkmcnt(3)
    v_mfma_f32_32x32x16_bf16 v[48:63], v[180:183], v[184:187], v[48:63]
    ds_read_b128 v[196:199], v15 offset:21504
    ds_read_b128 v[204:207], v23 offset:32768
    s_waitcnt lgkmcnt(4)
    v_mfma_f32_32x32x16_bf16 v[64:79], v[176:179], v[188:191], v[64:79]
    ds_read_b128 v[208:211], v25 offset:20480
    ds_read_b128 v[212:215], v27 offset:20480
    v_mfma_f32_32x32x16_bf16 v[80:95], v[180:183], v[188:191], v[80:95]
    ds_read_b128 v[216:219], v29 offset:4096
    ds_read_b128 v[220:223], v29 offset:6144
    s_waitcnt lgkmcnt(0)
    s_barrier
    v_mfma_f32_32x32x16_bf16 v[32:47], v[192:195], v[200:203], v[32:47]
    ds_read_b128 v[176:179], v12 offset:36864
    ds_read_b128 v[184:187], v20 offset:16384
    v_mfma_f32_32x32x16_bf16 v[48:63], v[196:199], v[200:203], v[48:63]
    ds_read_b128 v[180:183], v12 offset:37888
    ds_read_b128 v[188:191], v20 offset:40960
    v_mfma_f32_16x16x32_bf16 v[160:163], v[208:211], v[216:219], v[160:163]
    v_mfma_f32_16x16x32_bf16 v[164:167], v[212:215], v[216:219], v[164:167]
    v_mfma_f32_16x16x32_bf16 v[168:171], v[208:211], v[220:223], v[168:171]
    v_mfma_f32_16x16x32_bf16 v[172:175], v[212:215], v[220:223], v[172:175]
    v_mfma_f32_32x32x16_bf16 v[64:79], v[192:195], v[204:207], v[64:79]
    v_mfma_f32_32x32x16_bf16 v[80:95], v[196:199], v[204:207], v[80:95]
    s_waitcnt lgkmcnt(2)
    v_mfma_f32_32x32x16_bf16 v[32:47], v[176:179], v[184:187], v[32:47]
    ds_read_b128 v[192:195], v13 offset:36864
    ds_read_b128 v[200:203], v21 offset:16384
    s_waitcnt lgkmcnt(3)
    v_mfma_f32_32x32x16_bf16 v[48:63], v[180:183], v[184:187], v[48:63]
    ds_read_b128 v[196:199], v13 offset:37888
    ds_read_b128 v[204:207], v21 offset:40960
    s_waitcnt lgkmcnt(4)
    v_mfma_f32_32x32x16_bf16 v[64:79], v[176:179], v[188:191], v[64:79]
    ds_read_b128 v[208:211], v24 offset:36864
    ds_read_b128 v[212:215], v26 offset:36864
    v_mfma_f32_32x32x16_bf16 v[80:95], v[180:183], v[188:191], v[80:95]
    ds_read_b128 v[216:219], v28 offset:8192
    ds_read_b128 v[220:223], v28 offset:10240
    s_waitcnt lgkmcnt(6)
    v_mfma_f32_32x32x16_bf16 v[32:47], v[192:195], v[200:203], v[32:47]
    ds_read_b128 v[176:179], v14 offset:36864
    ds_read_b128 v[184:187], v22 offset:16384
    s_waitcnt lgkmcnt(7)
    v_mfma_f32_32x32x16_bf16 v[48:63], v[196:199], v[200:203], v[48:63]
    ds_read_b128 v[180:183], v14 offset:37888
    ds_read_b128 v[188:191], v22 offset:40960
    s_waitcnt lgkmcnt(5)
    v_mfma_f32_16x16x32_bf16 v[160:163], v[208:211], v[216:219], v[160:163]
    v_mfma_f32_16x16x32_bf16 v[164:167], v[212:215], v[216:219], v[164:167]
    s_waitcnt lgkmcnt(4)
    v_mfma_f32_16x16x32_bf16 v[168:171], v[208:211], v[220:223], v[168:171]
    v_mfma_f32_16x16x32_bf16 v[172:175], v[212:215], v[220:223], v[172:175]
    v_mfma_f32_32x32x16_bf16 v[64:79], v[192:195], v[204:207], v[64:79]
    v_mfma_f32_32x32x16_bf16 v[80:95], v[196:199], v[204:207], v[80:95]
    s_waitcnt lgkmcnt(2)
    v_mfma_f32_32x32x16_bf16 v[32:47], v[176:179], v[184:187], v[32:47]
    ds_read_b128 v[192:195], v15 offset:36864
    ds_read_b128 v[200:203], v23 offset:16384
    s_waitcnt lgkmcnt(3)
    v_mfma_f32_32x32x16_bf16 v[48:63], v[180:183], v[184:187], v[48:63]
    ds_read_b128 v[196:199], v15 offset:37888
    ds_read_b128 v[204:207], v23 offset:40960
    s_waitcnt lgkmcnt(4)
    v_mfma_f32_32x32x16_bf16 v[64:79], v[176:179], v[188:191], v[64:79]
    ds_read_b128 v[208:211], v25 offset:36864
    ds_read_b128 v[212:215], v27 offset:36864
    v_mfma_f32_32x32x16_bf16 v[80:95], v[180:183], v[188:191], v[80:95]
    ds_read_b128 v[216:219], v29 offset:8192
    ds_read_b128 v[220:223], v29 offset:10240
    s_waitcnt lgkmcnt(0)
    s_barrier
    v_mfma_f32_32x32x16_bf16 v[32:47], v[192:195], v[200:203], v[32:47]
    ds_read_b128 v[176:179], v12 offset:4096
    ds_read_b128 v[184:187], v20 offset:0
    v_mfma_f32_32x32x16_bf16 v[48:63], v[196:199], v[200:203], v[48:63]
    ds_read_b128 v[180:183], v12 offset:5120
    ds_read_b128 v[188:191], v20 offset:24576
    v_mfma_f32_16x16x32_bf16 v[160:163], v[208:211], v[216:219], v[160:163]
    v_mfma_f32_16x16x32_bf16 v[164:167], v[212:215], v[216:219], v[164:167]
    v_mfma_f32_16x16x32_bf16 v[168:171], v[208:211], v[220:223], v[168:171]
    v_mfma_f32_16x16x32_bf16 v[172:175], v[212:215], v[220:223], v[172:175]
    v_mfma_f32_32x32x16_bf16 v[64:79], v[192:195], v[204:207], v[64:79]
    v_mfma_f32_32x32x16_bf16 v[80:95], v[196:199], v[204:207], v[80:95]
    s_cmp_lg_u32 s3, 1
    s_cbranch_scc1 L_37
    s_mov_b32 s56, s36
    s_mov_b32 s57, s37
    s_mov_b32 s58, 1835008
    s_mov_b32 s59, 0x20000
    s_mov_b32 s60, s38
    s_mov_b32 s61, s39
    s_mov_b32 s62, 1835008
    s_mov_b32 s63, 0x20000
    v_min_u32 v1, 6, v0
    v_lshlrev_b32 v1, 7, v1
    s_mul_i32 s4, s2, 896
    buffer_load_dword v8, v1, s[56:59], s4 offen
    buffer_load_dword v8, v1, s[60:63], s4 offen
L_37:
    s_waitcnt lgkmcnt(2)
    v_mfma_f32_32x32x16_bf16 v[32:47], v[176:179], v[184:187], v[32:47]
    ds_read_b128 v[192:195], v13 offset:4096
    ds_read_b128 v[200:203], v21 offset:0
    s_waitcnt lgkmcnt(3)
    v_mfma_f32_32x32x16_bf16 v[48:63], v[180:183], v[184:187], v[48:63]
    ds_read_b128 v[196:199], v13 offset:5120
    ds_read_b128 v[204:207], v21 offset:24576
    s_waitcnt lgkmcnt(4)
    v_mfma_f32_32x32x16_bf16 v[64:79], v[176:179], v[188:191], v[64:79]
    ds_read_b128 v[208:211], v24 offset:4096
    ds_read_b128 v[212:215], v26 offset:4096
    v_mfma_f32_32x32x16_bf16 v[80:95], v[180:183], v[188:191], v[80:95]
    ds_read_b128 v[216:219], v28 offset:0
    ds_read_b128 v[220:223], v28 offset:2048
    s_waitcnt lgkmcnt(6)
    v_mfma_f32_32x32x16_bf16 v[32:47], v[192:195], v[200:203], v[32:47]
    ds_read_b128 v[176:179], v14 offset:4096
    ds_read_b128 v[184:187], v22 offset:0
    s_waitcnt lgkmcnt(7)
    v_mfma_f32_32x32x16_bf16 v[48:63], v[196:199], v[200:203], v[48:63]
    ds_read_b128 v[180:183], v14 offset:5120
    ds_read_b128 v[188:191], v22 offset:24576
    s_waitcnt lgkmcnt(5)
    v_mfma_f32_16x16x32_bf16 v[160:163], v[208:211], v[216:219], v[160:163]
    v_mfma_f32_16x16x32_bf16 v[164:167], v[212:215], v[216:219], v[164:167]
    s_waitcnt lgkmcnt(4)
    v_mfma_f32_16x16x32_bf16 v[168:171], v[208:211], v[220:223], v[168:171]
    v_mfma_f32_16x16x32_bf16 v[172:175], v[212:215], v[220:223], v[172:175]
    v_mfma_f32_32x32x16_bf16 v[64:79], v[192:195], v[204:207], v[64:79]
    v_mfma_f32_32x32x16_bf16 v[80:95], v[196:199], v[204:207], v[80:95]
    s_waitcnt lgkmcnt(2)
    v_mfma_f32_32x32x16_bf16 v[32:47], v[176:179], v[184:187], v[32:47]
    ds_read_b128 v[192:195], v15 offset:4096
    ds_read_b128 v[200:203], v23 offset:0
    s_waitcnt lgkmcnt(3)
    v_mfma_f32_32x32x16_bf16 v[48:63], v[180:183], v[184:187], v[48:63]
    ds_read_b128 v[196:199], v15 offset:5120
    ds_read_b128 v[204:207], v23 offset:24576
    s_waitcnt lgkmcnt(4)
    v_mfma_f32_32x32x16_bf16 v[64:79], v[176:179], v[188:191], v[64:79]
    ds_read_b128 v[208:211], v25 offset:4096
    ds_read_b128 v[212:215], v27 offset:4096
    v_mfma_f32_32x32x16_bf16 v[80:95], v[180:183], v[188:191], v[80:95]
    ds_read_b128 v[216:219], v29 offset:0
    ds_read_b128 v[220:223], v29 offset:2048
    s_waitcnt lgkmcnt(0)
    s_barrier
    v_mfma_f32_32x32x16_bf16 v[32:47], v[192:195], v[200:203], v[32:47]
    ds_read_b128 v[176:179], v12 offset:20480
    ds_read_b128 v[184:187], v20 offset:8192
    v_mfma_f32_32x32x16_bf16 v[48:63], v[196:199], v[200:203], v[48:63]
    ds_read_b128 v[180:183], v12 offset:21504
    ds_read_b128 v[188:191], v20 offset:32768
    v_mfma_f32_16x16x32_bf16 v[160:163], v[208:211], v[216:219], v[160:163]
    v_mfma_f32_16x16x32_bf16 v[164:167], v[212:215], v[216:219], v[164:167]
    v_mfma_f32_16x16x32_bf16 v[168:171], v[208:211], v[220:223], v[168:171]
    v_mfma_f32_16x16x32_bf16 v[172:175], v[212:215], v[220:223], v[172:175]
    v_mfma_f32_32x32x16_bf16 v[64:79], v[192:195], v[204:207], v[64:79]
    v_mfma_f32_32x32x16_bf16 v[80:95], v[196:199], v[204:207], v[80:95]
    s_cmp_lg_u32 s3, 2
    s_cbranch_scc1 L_38
    s_mov_b32 s52, s40
    s_mov_b32 s53, s41
    s_mov_b32 s54, 1835008
    s_mov_b32 s55, 0x20000
    v_min_u32 v1, 55, v0
    v_lshlrev_b32 v1, 7, v1
    s_mul_i32 s4, s2, 7168
    buffer_load_dword v8, v1, s[52:55], s4 offen
L_38:
    s_cmp_lg_u32 s3, 2
    s_cbranch_scc1 L_39
    s_mov_b32 s56, s26
    s_mov_b32 s57, s27
    s_mov_b32 s58, 524288
    s_mov_b32 s59, 0x20000
    s_mov_b32 s60, s28
    s_mov_b32 s61, s29
    s_mov_b32 s62, 524288
    s_mov_b32 s63, 0x20000
    v_and_b32 v1, 15, v0
    v_lshlrev_b32 v1, 7, v1
    s_lshl_b32 s4, s2, 11
    buffer_load_dword v8, v1, s[56:59], s4 offen
    buffer_load_dword v8, v1, s[60:63], s4 offen
L_39:
    s_waitcnt lgkmcnt(2)
    v_mfma_f32_32x32x16_bf16 v[32:47], v[176:179], v[184:187], v[32:47]
    ds_read_b128 v[192:195], v13 offset:20480
    ds_read_b128 v[200:203], v21 offset:8192
    s_cmp_lg_u32 s3, 0
    s_cbranch_scc1 L_35
    s_waitcnt vmcnt(0)
    v_mov_b32 v9, s14
    v_cmp_eq_u32 vcc, 0, v10
    s_mov_b64 exec, 1
    v_mov_b32 v11, 0
    v_cndmask_b32 v10, v10, v9, vcc
    ds_write_b32 v11, v10 offset:2048
    s_waitcnt lgkmcnt(0)
    s_mov_b64 exec, -1
    L_35:
    s_mov_b32 s14, s78
    v_and_b32 v1, 15, v0
    s_waitcnt lgkmcnt(3)
    v_mfma_f32_32x32x16_bf16 v[48:63], v[180:183], v[184:187], v[48:63]
    ds_read_b128 v[196:199], v13 offset:21504
    ds_read_b128 v[204:207], v21 offset:32768
    v_lshlrev_b32 v1, 4, v1
    ds_read_b128 v[224:227], v1 offset:0
    s_waitcnt lgkmcnt(5)
    v_mfma_f32_32x32x16_bf16 v[64:79], v[176:179], v[188:191], v[64:79]
    ds_read_b128 v[208:211], v24 offset:20480
    ds_read_b128 v[212:215], v26 offset:20480
    v_and_b32 v2, 31, v0
    v_mfma_f32_32x32x16_bf16 v[80:95], v[180:183], v[188:191], v[80:95]
    ds_read_b128 v[216:219], v28 offset:4096
    ds_read_b128 v[220:223], v28 offset:6144
    s_waitcnt lgkmcnt(7)
    v_mfma_f32_32x32x16_bf16 v[32:47], v[192:195], v[200:203], v[32:47]
    ds_read_b128 v[176:179], v14 offset:20480
    ds_read_b128 v[184:187], v22 offset:8192
    v_lshlrev_b32 v2, 4, v2
    s_waitcnt lgkmcnt(8)
    v_mfma_f32_32x32x16_bf16 v[48:63], v[196:199], v[200:203], v[48:63]
    ds_read_b128 v[180:183], v14 offset:21504
    ds_read_b128 v[188:191], v22 offset:32768
    s_and_b32 s4, s3, 1
    s_lshl_b32 s4, s4, 9
    v_add_u32 v2, s4, v2
    s_waitcnt lgkmcnt(5)
    v_mfma_f32_16x16x32_bf16 v[160:163], v[208:211], v[216:219], v[160:163]
    ds_read_b128 v[228:231], v2 offset:256
    v_mfma_f32_16x16x32_bf16 v[164:167], v[212:215], v[216:219], v[164:167]
    s_lshl_b32 s4, s3, 8
    s_add_u32 s4, s4, 151552
    v_lshlrev_b32 v5, 2, v0
    s_waitcnt lgkmcnt(5)
    v_mfma_f32_16x16x32_bf16 v[168:171], v[208:211], v[220:223], v[168:171]
    v_add_u32 v5, s4, v5
    v_mfma_f32_16x16x32_bf16 v[172:175], v[212:215], v[220:223], v[172:175]
    v_mfma_f32_32x32x16_bf16 v[64:79], v[192:195], v[204:207], v[64:79]
    v_mfma_f32_32x32x16_bf16 v[80:95], v[196:199], v[204:207], v[80:95]
    s_waitcnt lgkmcnt(3)
    v_mfma_f32_32x32x16_bf16 v[32:47], v[176:179], v[184:187], v[32:47]
    ds_read_b128 v[192:195], v15 offset:20480
    ds_read_b128 v[200:203], v23 offset:8192
    v_lshrrev_b32 v3, 5, v0
    v_lshlrev_b32 v3, 9, v3
    s_waitcnt lgkmcnt(4)
    v_mfma_f32_32x32x16_bf16 v[48:63], v[180:183], v[184:187], v[48:63]
    ds_read_b128 v[196:199], v15 offset:21504
    ds_read_b128 v[204:207], v23 offset:32768
    v_lshrrev_b32 v4, 2, v2
    v_add_u32 v3, v3, v4
    s_waitcnt lgkmcnt(5)
    v_mfma_f32_32x32x16_bf16 v[64:79], v[176:179], v[188:191], v[64:79]
    ds_read_b128 v[208:211], v25 offset:20480
    ds_read_b128 v[212:215], v27 offset:20480
    s_lshr_b32 s4, s3, 1
    s_lshl_b32 s4, s4, 10
    s_add_u32 s4, s4, 151552
    v_add_u32 v3, s4, v3
    v_mfma_f32_32x32x16_bf16 v[80:95], v[180:183], v[188:191], v[80:95]
    ds_read_b128 v[216:219], v29 offset:4096
    ds_read_b128 v[220:223], v29 offset:6144
    s_waitcnt lgkmcnt(0)
    s_barrier
    v_mfma_f32_32x32x16_bf16 v[32:47], v[192:195], v[200:203], v[32:47]
    ds_read_b128 v[176:179], v16 offset:36864
    ds_read_b64_tr_b16 v[184:185], v30 offset:16384
    v_mfma_f32_32x32x16_bf16 v[48:63], v[196:199], v[200:203], v[48:63]
    ds_read_b64_tr_b16 v[186:187], v30 offset:16896
    ds_read_b128 v[180:183], v16 offset:40960
    v_mfma_f32_16x16x32_bf16 v[160:163], v[208:211], v[216:219], v[160:163]
    ds_read_b64_tr_b16 v[188:189], v30 offset:40960
    ds_read_b64_tr_b16 v[190:191], v30 offset:41472
    v_mfma_f32_16x16x32_bf16 v[164:167], v[212:215], v[216:219], v[164:167]
    v_mfma_f32_16x16x32_bf16 v[168:171], v[208:211], v[220:223], v[168:171]
    v_mfma_f32_16x16x32_bf16 v[172:175], v[212:215], v[220:223], v[172:175]
    v_mfma_f32_32x32x16_bf16 v[64:79], v[192:195], v[204:207], v[64:79]
    v_mfma_f32_32x32x16_bf16 v[80:95], v[196:199], v[204:207], v[80:95]
    s_nop 15
    s_nop 7
    v_pk_fma_f32 v[220:221], v[32:33], v[228:229], v[34:35] op_sel:[0,0,0] op_sel_hi:[1,0,1]
    v_fma_f32 v210, v160, v224, v161
    v_pk_fma_f32 v[222:223], v[64:65], v[228:229], v[66:67] op_sel:[0,0,0] op_sel_hi:[1,0,1]
    v_pk_fma_f32 v[220:221], v[64:65], v[228:229], v[220:221] op_sel:[0,1,0] op_sel_hi:[1,1,1] neg_lo:[0,1,0] neg_hi:[0,1,0]
    v_fma_f32 v211, v168, v224, v169
    v_pk_fma_f32 v[222:223], v[32:33], v[228:229], v[222:223] op_sel:[0,1,0] op_sel_hi:[1,1,1]
    v_pk_fma_f32 v[216:217], v[220:221], v[228:229], v[36:37] op_sel:[0,0,0] op_sel_hi:[1,0,1]
    v_fma_f32 v210, -v168, v225, v210
    v_pk_fma_f32 v[218:219], v[222:223], v[228:229], v[68:69] op_sel:[0,0,0] op_sel_hi:[1,0,1]
    v_pk_fma_f32 v[216:217], v[222:223], v[228:229], v[216:217] op_sel:[0,1,0] op_sel_hi:[1,1,1] neg_lo:[0,1,0] neg_hi:[0,1,0]
    v_fma_f32 v211, v160, v225, v211
    v_pk_fma_f32 v[218:219], v[220:221], v[228:229], v[218:219] op_sel:[0,1,0] op_sel_hi:[1,1,1]
    v_pk_fma_f32 v[220:221], v[216:217], v[228:229], v[38:39] op_sel:[0,0,0] op_sel_hi:[1,0,1]
    v_fma_f32 v208, v210, v224, v162
    v_pk_fma_f32 v[222:223], v[218:219], v[228:229], v[70:71] op_sel:[0,0,0] op_sel_hi:[1,0,1]
    v_pk_fma_f32 v[220:221], v[218:219], v[228:229], v[220:221] op_sel:[0,1,0] op_sel_hi:[1,1,1] neg_lo:[0,1,0] neg_hi:[0,1,0]
    v_fma_f32 v209, v211, v224, v170
    v_pk_fma_f32 v[222:223], v[216:217], v[228:229], v[222:223] op_sel:[0,1,0] op_sel_hi:[1,1,1]
    v_pk_fma_f32 v[216:217], v[220:221], v[228:229], v[40:41] op_sel:[0,0,0] op_sel_hi:[1,0,1]
    v_fma_f32 v208, -v211, v225, v208
    v_pk_fma_f32 v[218:219], v[222:223], v[228:229], v[72:73] op_sel:[0,0,0] op_sel_hi:[1,0,1]
    v_pk_fma_f32 v[216:217], v[222:223], v[228:229], v[216:217] op_sel:[0,1,0] op_sel_hi:[1,1,1] neg_lo:[0,1,0] neg_hi:[0,1,0]
    v_fma_f32 v209, v210, v225, v209
    v_pk_fma_f32 v[218:219], v[220:221], v[228:229], v[218:219] op_sel:[0,1,0] op_sel_hi:[1,1,1]
    v_pk_fma_f32 v[220:221], v[216:217], v[228:229], v[42:43] op_sel:[0,0,0] op_sel_hi:[1,0,1]
    v_pk_fma_f32 v[222:223], v[218:219], v[228:229], v[74:75] op_sel:[0,0,0] op_sel_hi:[1,0,1]
    v_fma_f32 v210, v208, v224, v163
    v_pk_fma_f32 v[220:221], v[218:219], v[228:229], v[220:221] op_sel:[0,1,0] op_sel_hi:[1,1,1] neg_lo:[0,1,0] neg_hi:[0,1,0]
    v_pk_fma_f32 v[222:223], v[216:217], v[228:229], v[222:223] op_sel:[0,1,0] op_sel_hi:[1,1,1]
    v_fma_f32 v211, v209, v224, v171
    v_pk_fma_f32 v[216:217], v[220:221], v[228:229], v[44:45] op_sel:[0,0,0] op_sel_hi:[1,0,1]
    v_pk_fma_f32 v[218:219], v[222:223], v[228:229], v[76:77] op_sel:[0,0,0] op_sel_hi:[1,0,1]
    v_fma_f32 v210, -v209, v225, v210
    v_pk_fma_f32 v[216:217], v[222:223], v[228:229], v[216:217] op_sel:[0,1,0] op_sel_hi:[1,1,1] neg_lo:[0,1,0] neg_hi:[0,1,0]
    v_pk_fma_f32 v[218:219], v[220:221], v[228:229], v[218:219] op_sel:[0,1,0] op_sel_hi:[1,1,1]
    v_fma_f32 v211, v208, v225, v211
    v_pk_fma_f32 v[220:221], v[216:217], v[228:229], v[46:47] op_sel:[0,0,0] op_sel_hi:[1,0,1]
    v_pk_fma_f32 v[222:223], v[218:219], v[228:229], v[78:79] op_sel:[0,0,0] op_sel_hi:[1,0,1]
    v_fma_f32 v208, v210, v224, v164
    v_pk_fma_f32 v[220:221], v[218:219], v[228:229], v[220:221] op_sel:[0,1,0] op_sel_hi:[1,1,1] neg_lo:[0,1,0] neg_hi:[0,1,0]
    v_pk_fma_f32 v[222:223], v[216:217], v[228:229], v[222:223] op_sel:[0,1,0] op_sel_hi:[1,1,1]
    v_fma_f32 v209, v211, v224, v172
    v_pk_fma_f32 v[216:217], v[220:221], v[228:229], v[48:49] op_sel:[0,0,0] op_sel_hi:[1,0,1]
    v_pk_fma_f32 v[218:219], v[222:223], v[228:229], v[80:81] op_sel:[0,0,0] op_sel_hi:[1,0,1]
    v_fma_f32 v208, -v211, v225, v208
    v_pk_fma_f32 v[216:217], v[222:223], v[228:229], v[216:217] op_sel:[0,1,0] op_sel_hi:[1,1,1] neg_lo:[0,1,0] neg_hi:[0,1,0]
    v_pk_fma_f32 v[218:219], v[220:221], v[228:229], v[218:219] op_sel:[0,1,0] op_sel_hi:[1,1,1]
    v_pk_fma_f32 v[220:221], v[216:217], v[228:229], v[50:51] op_sel:[0,0,0] op_sel_hi:[1,0,1]
    v_fma_f32 v209, v210, v225, v209
    v_pk_fma_f32 v[222:223], v[218:219], v[228:229], v[82:83] op_sel:[0,0,0] op_sel_hi:[1,0,1]
    v_pk_fma_f32 v[220:221], v[218:219], v[228:229], v[220:221] op_sel:[0,1,0] op_sel_hi:[1,1,1] neg_lo:[0,1,0] neg_hi:[0,1,0]
    v_fma_f32 v210, v208, v224, v165
    v_pk_fma_f32 v[222:223], v[216:217], v[228:229], v[222:223] op_sel:[0,1,0] op_sel_hi:[1,1,1]
    v_pk_fma_f32 v[216:217], v[220:221], v[228:229], v[52:53] op_sel:[0,0,0] op_sel_hi:[1,0,1]
    v_fma_f32 v211, v209, v224, v173
    v_pk_fma_f32 v[218:219], v[222:223], v[228:229], v[84:85] op_sel:[0,0,0] op_sel_hi:[1,0,1]
    v_pk_fma_f32 v[216:217], v[222:223], v[228:229], v[216:217] op_sel:[0,1,0] op_sel_hi:[1,1,1] neg_lo:[0,1,0] neg_hi:[0,1,0]
    v_fma_f32 v210, -v209, v225, v210
    v_pk_fma_f32 v[218:219], v[220:221], v[228:229], v[218:219] op_sel:[0,1,0] op_sel_hi:[1,1,1]
    v_pk_fma_f32 v[220:221], v[216:217], v[228:229], v[54:55] op_sel:[0,0,0] op_sel_hi:[1,0,1]
    v_fma_f32 v211, v208, v225, v211
    v_pk_fma_f32 v[222:223], v[218:219], v[228:229], v[86:87] op_sel:[0,0,0] op_sel_hi:[1,0,1]
    v_pk_fma_f32 v[220:221], v[218:219], v[228:229], v[220:221] op_sel:[0,1,0] op_sel_hi:[1,1,1] neg_lo:[0,1,0] neg_hi:[0,1,0]
    v_fma_f32 v208, v210, v224, v166
    v_pk_fma_f32 v[222:223], v[216:217], v[228:229], v[222:223] op_sel:[0,1,0] op_sel_hi:[1,1,1]
    v_pk_fma_f32 v[216:217], v[220:221], v[228:229], v[56:57] op_sel:[0,0,0] op_sel_hi:[1,0,1]
    v_fma_f32 v209, v211, v224, v174
    v_pk_fma_f32 v[218:219], v[222:223], v[228:229], v[88:89] op_sel:[0,0,0] op_sel_hi:[1,0,1]
    v_pk_fma_f32 v[216:217], v[222:223], v[228:229], v[216:217] op_sel:[0,1,0] op_sel_hi:[1,1,1] neg_lo:[0,1,0] neg_hi:[0,1,0]
    v_fma_f32 v208, -v211, v225, v208
    v_pk_fma_f32 v[218:219], v[220:221], v[228:229], v[218:219] op_sel:[0,1,0] op_sel_hi:[1,1,1]
    v_pk_fma_f32 v[220:221], v[216:217], v[228:229], v[58:59] op_sel:[0,0,0] op_sel_hi:[1,0,1]
    v_pk_fma_f32 v[222:223], v[218:219], v[228:229], v[90:91] op_sel:[0,0,0] op_sel_hi:[1,0,1]
    v_fma_f32 v209, v210, v225, v209
    v_pk_fma_f32 v[220:221], v[218:219], v[228:229], v[220:221] op_sel:[0,1,0] op_sel_hi:[1,1,1] neg_lo:[0,1,0] neg_hi:[0,1,0]
    v_pk_fma_f32 v[222:223], v[216:217], v[228:229], v[222:223] op_sel:[0,1,0] op_sel_hi:[1,1,1]
    v_fma_f32 v210, v208, v224, v167
    v_pk_fma_f32 v[216:217], v[220:221], v[228:229], v[60:61] op_sel:[0,0,0] op_sel_hi:[1,0,1]
    v_pk_fma_f32 v[218:219], v[222:223], v[228:229], v[92:93] op_sel:[0,0,0] op_sel_hi:[1,0,1]
    v_fma_f32 v211, v209, v224, v175
    v_pk_fma_f32 v[216:217], v[222:223], v[228:229], v[216:217] op_sel:[0,1,0] op_sel_hi:[1,1,1] neg_lo:[0,1,0] neg_hi:[0,1,0]
    v_pk_fma_f32 v[218:219], v[220:221], v[228:229], v[218:219] op_sel:[0,1,0] op_sel_hi:[1,1,1]
    v_fma_f32 v210, -v209, v225, v210
    v_pk_fma_f32 v[220:221], v[216:217], v[228:229], v[62:63] op_sel:[0,0,0] op_sel_hi:[1,0,1]
    v_pk_fma_f32 v[222:223], v[218:219], v[228:229], v[94:95] op_sel:[0,0,0] op_sel_hi:[1,0,1]
    v_fma_f32 v211, v208, v225, v211
    v_pk_fma_f32 v[220:221], v[218:219], v[228:229], v[220:221] op_sel:[0,1,0] op_sel_hi:[1,1,1] neg_lo:[0,1,0] neg_hi:[0,1,0]
    v_pk_fma_f32 v[222:223], v[216:217], v[228:229], v[222:223] op_sel:[0,1,0] op_sel_hi:[1,1,1]
    ds_write_b32 v5, v210 offset:0
    ds_write_b32 v3, v220 offset:2048
    ds_write_b32 v3, v222 offset:8192
    ds_write_b32 v5, v211 offset:1024
    ds_write_b32 v3, v221 offset:2304
    ds_write_b32 v3, v223 offset:8448
    s_nop 3
    s_waitcnt lgkmcnt(9)
    v_mfma_f32_32x32x16_bf16 v[96:111], v[184:187], v[176:179], 0
    ds_read_b128 v[192:195], v17 offset:36864
    ds_read_b64_tr_b16 v[200:201], v30 offset:18432
    s_waitcnt lgkmcnt(10)
    v_mfma_f32_32x32x16_bf16 v[112:127], v[184:187], v[180:183], 0
    ds_read_b64_tr_b16 v[202:203], v30 offset:18944
    ds_read_b128 v[196:199], v17 offset:40960
    s_waitcnt lgkmcnt(10)
    v_mfma_f32_32x32x16_bf16 v[128:143], v[188:191], v[176:179], 0
    ds_read_b64_tr_b16 v[204:205], v30 offset:43008
    ds_read_b64_tr_b16 v[206:207], v30 offset:43520
    s_waitcnt vmcnt(0)
    v_mov_b32 v1, 0
    ds_read_b32 v1, v1 offset:2048
    v_mul_f32 v232, v32, v230
    v_mul_f32 v234, v33, v230
    v_mul_f32 v233, v32, v231
    v_mfma_f32_32x32x16_bf16 v[144:159], v[188:191], v[180:183], 0
    v_mul_f32 v235, v33, v231
    v_fma_f32 v32, -v64, v231, v232
    v_fma_f32 v33, -v65, v231, v234
    v_fma_f32 v64, -v64, v230, -v233
    v_fma_f32 v65, -v65, v230, -v235
    v_mul_f32 v236, v34, v230
    s_waitcnt lgkmcnt(4)
    v_mfma_f32_32x32x16_bf16 v[96:111], v[200:203], v[192:195], v[96:111]
    ds_read_b128 v[176:179], v18 offset:36864
    ds_read_b64_tr_b16 v[184:185], v30 offset:20480
    v_mul_f32 v238, v35, v230
    v_mul_f32 v237, v34, v231
    v_mul_f32 v239, v35, v231
    s_waitcnt lgkmcnt(5)
    v_mfma_f32_32x32x16_bf16 v[112:127], v[200:203], v[196:199], v[112:127]
    ds_read_b64_tr_b16 v[186:187], v30 offset:20992
    ds_read_b128 v[180:183], v18 offset:40960
    v_fma_f32 v34, -v66, v231, v236
    v_fma_f32 v35, -v67, v231, v238
    v_fma_f32 v66, -v66, v230, -v237
    s_waitcnt lgkmcnt(5)
    v_mfma_f32_32x32x16_bf16 v[128:143], v[204:207], v[192:195], v[128:143]
    ds_read_b64_tr_b16 v[188:189], v30 offset:45056
    ds_read_b64_tr_b16 v[190:191], v30 offset:45568
    v_fma_f32 v67, -v67, v230, -v239
    v_mul_f32 v240, v36, v230
    v_mul_f32 v242, v37, v230
    v_mfma_f32_32x32x16_bf16 v[144:159], v[204:207], v[196:199], v[144:159]
    v_mul_f32 v241, v36, v231
    v_mul_f32 v243, v37, v231
    v_fma_f32 v36, -v68, v231, v240
    s_waitcnt lgkmcnt(3)
    v_mfma_f32_32x32x16_bf16 v[96:111], v[184:187], v[176:179], v[96:111]
    ds_read_b128 v[192:195], v19 offset:36864
    ds_read_b64_tr_b16 v[200:201], v30 offset:22528
    v_fma_f32 v37, -v69, v231, v242
    v_fma_f32 v68, -v68, v230, -v241
    v_fma_f32 v69, -v69, v230, -v243
    s_waitcnt lgkmcnt(4)
    v_mfma_f32_32x32x16_bf16 v[112:127], v[184:187], v[180:183], v[112:127]
    ds_read_b64_tr_b16 v[202:203], v30 offset:23040
    ds_read_b128 v[196:199], v19 offset:40960
    v_mul_f32 v244, v38, v230
    v_mul_f32 v246, v39, v230
    v_mul_f32 v245, v38, v231
    s_waitcnt lgkmcnt(4)
    v_mfma_f32_32x32x16_bf16 v[128:143], v[188:191], v[176:179], v[128:143]
    ds_read_b64_tr_b16 v[204:205], v30 offset:47104
    ds_read_b64_tr_b16 v[206:207], v30 offset:47616
    v_mul_f32 v247, v39, v231
    v_fma_f32 v38, -v70, v231, v244
    v_fma_f32 v39, -v71, v231, v246
    v_mfma_f32_32x32x16_bf16 v[144:159], v[188:191], v[180:183], v[144:159]
    v_fma_f32 v70, -v70, v230, -v245
    v_fma_f32 v71, -v71, v230, -v247
    s_waitcnt lgkmcnt(0)
    s_barrier
    v_mfma_f32_32x32x16_bf16 v[96:111], v[200:203], v[192:195], v[96:111]
    ds_read_b128 v[176:179], v16 offset:4096
    ds_read_b64_tr_b16 v[184:185], v30 offset:0
    v_mul_f32 v232, v40, v230
    v_mul_f32 v234, v41, v230
    v_mul_f32 v233, v40, v231
    v_mfma_f32_32x32x16_bf16 v[112:127], v[200:203], v[196:199], v[112:127]
    ds_read_b64_tr_b16 v[186:187], v30 offset:512
    ds_read_b128 v[180:183], v16 offset:8192
    v_mul_f32 v235, v41, v231
    v_fma_f32 v40, -v72, v231, v232
    v_fma_f32 v41, -v73, v231, v234
    v_mfma_f32_32x32x16_bf16 v[128:143], v[204:207], v[192:195], v[128:143]
    ds_read_b64_tr_b16 v[188:189], v30 offset:24576
    ds_read_b64_tr_b16 v[190:191], v30 offset:25088
    v_fma_f32 v72, -v72, v230, -v233
    v_fma_f32 v73, -v73, v230, -v235
    v_mul_f32 v236, v42, v230
    v_mfma_f32_32x32x16_bf16 v[144:159], v[204:207], v[196:199], v[144:159]
    s_waitcnt lgkmcnt(3)
    v_mfma_f32_32x32x16_bf16 v[96:111], v[184:187], v[176:179], v[96:111]
    ds_read_b128 v[192:195], v17 offset:4096
    ds_read_b64_tr_b16 v[200:201], v30 offset:2048
    v_mul_f32 v238, v43, v230
    v_mul_f32 v237, v42, v231
    v_mul_f32 v239, v43, v231
    s_waitcnt lgkmcnt(4)
    v_mfma_f32_32x32x16_bf16 v[112:127], v[184:187], v[180:183], v[112:127]
    ds_read_b64_tr_b16 v[202:203], v30 offset:2560
    ds_read_b128 v[196:199], v17 offset:8192
    v_fma_f32 v42, -v74, v231, v236
    v_fma_f32 v43, -v75, v231, v238
    v_fma_f32 v74, -v74, v230, -v237
    s_waitcnt lgkmcnt(4)
    v_mfma_f32_32x32x16_bf16 v[128:143], v[188:191], v[176:179], v[128:143]
    ds_read_b64_tr_b16 v[204:205], v30 offset:26624
    ds_read_b64_tr_b16 v[206:207], v30 offset:27136
    v_fma_f32 v75, -v75, v230, -v239
    v_mul_f32 v240, v44, v230
    v_mul_f32 v242, v45, v230
    v_mfma_f32_32x32x16_bf16 v[144:159], v[188:191], v[180:183], v[144:159]
    s_waitcnt lgkmcnt(3)
    v_mfma_f32_32x32x16_bf16 v[96:111], v[200:203], v[192:195], v[96:111]
    ds_read_b128 v[176:179], v18 offset:4096
    ds_read_b64_tr_b16 v[184:185], v30 offset:4096
    v_mul_f32 v241, v44, v231
    v_mul_f32 v243, v45, v231
    v_fma_f32 v44, -v76, v231, v240
    s_waitcnt lgkmcnt(4)
    v_mfma_f32_32x32x16_bf16 v[112:127], v[200:203], v[196:199], v[112:127]
    ds_read_b64_tr_b16 v[186:187], v30 offset:4608
    ds_read_b128 v[180:183], v18 offset:8192
    v_fma_f32 v45, -v77, v231, v242
    v_fma_f32 v76, -v76, v230, -v241
    v_fma_f32 v77, -v77, v230, -v243
    s_waitcnt lgkmcnt(4)
    v_mfma_f32_32x32x16_bf16 v[128:143], v[204:207], v[192:195], v[128:143]
    ds_read_b64_tr_b16 v[188:189], v30 offset:28672
    ds_read_b64_tr_b16 v[190:191], v30 offset:29184
    v_mul_f32 v244, v46, v230
    v_mul_f32 v246, v47, v230
    v_mul_f32 v245, v46, v231
    v_mfma_f32_32x32x16_bf16 v[144:159], v[204:207], v[196:199], v[144:159]
    s_waitcnt lgkmcnt(3)
    v_mfma_f32_32x32x16_bf16 v[96:111], v[184:187], v[176:179], v[96:111]
    ds_read_b128 v[192:195], v19 offset:4096
    ds_read_b64_tr_b16 v[200:201], v30 offset:6144
    v_mul_f32 v247, v47, v231
    v_fma_f32 v46, -v78, v231, v244
    s_waitcnt lgkmcnt(4)
    v_mfma_f32_32x32x16_bf16 v[112:127], v[184:187], v[180:183], v[112:127]
    ds_read_b64_tr_b16 v[202:203], v30 offset:6656
    ds_read_b128 v[196:199], v19 offset:8192
    v_fma_f32 v47, -v79, v231, v246
    v_fma_f32 v78, -v78, v230, -v245
    s_waitcnt lgkmcnt(4)
    v_mfma_f32_32x32x16_bf16 v[128:143], v[188:191], v[176:179], v[128:143]
    ds_read_b64_tr_b16 v[204:205], v30 offset:30720
    ds_read_b64_tr_b16 v[206:207], v30 offset:31232
    v_fma_f32 v79, -v79, v230, -v247
    v_mul_f32 v232, v48, v230
    v_mfma_f32_32x32x16_bf16 v[144:159], v[188:191], v[180:183], v[144:159]
    v_mul_f32 v234, v49, v230
    v_mul_f32 v233, v48, v231
    s_waitcnt lgkmcnt(0)
    s_barrier
    v_mfma_f32_32x32x16_bf16 v[96:111], v[200:203], v[192:195], v[96:111]
    ds_read_b128 v[176:179], v16 offset:20480
    ds_read_b64_tr_b16 v[184:185], v30 offset:8192
    v_mul_f32 v235, v49, v231
    v_fma_f32 v48, -v80, v231, v232
    v_fma_f32 v49, -v81, v231, v234
    v_mfma_f32_32x32x16_bf16 v[112:127], v[200:203], v[196:199], v[112:127]
    ds_read_b64_tr_b16 v[186:187], v30 offset:8704
    ds_read_b128 v[180:183], v16 offset:24576
    v_fma_f32 v80, -v80, v230, -v233
    v_fma_f32 v81, -v81, v230, -v235
    v_mul_f32 v236, v50, v230
    v_mfma_f32_32x32x16_bf16 v[128:143], v[204:207], v[192:195], v[128:143]
    ds_read_b64_tr_b16 v[188:189], v30 offset:32768
    ds_read_b64_tr_b16 v[190:191], v30 offset:33280
    v_mul_f32 v238, v51, v230
    v_mul_f32 v237, v50, v231
    v_mul_f32 v239, v51, v231
    v_mfma_f32_32x32x16_bf16 v[144:159], v[204:207], v[196:199], v[144:159]
    s_waitcnt lgkmcnt(3)
    v_mfma_f32_32x32x16_bf16 v[96:111], v[184:187], v[176:179], v[96:111]
    ds_read_b128 v[192:195], v17 offset:20480
    ds_read_b64_tr_b16 v[200:201], v30 offset:10240
    v_fma_f32 v50, -v82, v231, v236
    v_fma_f32 v51, -v83, v231, v238
    v_fma_f32 v82, -v82, v230, -v237
    s_waitcnt lgkmcnt(4)
    v_mfma_f32_32x32x16_bf16 v[112:127], v[184:187], v[180:183], v[112:127]
    ds_read_b64_tr_b16 v[202:203], v30 offset:10752
    ds_read_b128 v[196:199], v17 offset:24576
    v_fma_f32 v83, -v83, v230, -v239
    v_mul_f32 v240, v52, v230
    v_mul_f32 v242, v53, v230
    s_waitcnt lgkmcnt(4)
    v_mfma_f32_32x32x16_bf16 v[128:143], v[188:191], v[176:179], v[128:143]
    ds_read_b64_tr_b16 v[204:205], v30 offset:34816
    ds_read_b64_tr_b16 v[206:207], v30 offset:35328
    v_mul_f32 v241, v52, v231
    v_mul_f32 v243, v53, v231
    v_fma_f32 v52, -v84, v231, v240
    v_mfma_f32_32x32x16_bf16 v[144:159], v[188:191], v[180:183], v[144:159]
    s_waitcnt lgkmcnt(3)
    v_mfma_f32_32x32x16_bf16 v[96:111], v[200:203], v[192:195], v[96:111]
    ds_read_b128 v[176:179], v18 offset:20480
    ds_read_b64_tr_b16 v[184:185], v30 offset:12288
    v_fma_f32 v53, -v85, v231, v242
    v_fma_f32 v84, -v84, v230, -v241
    v_fma_f32 v85, -v85, v230, -v243
    s_waitcnt lgkmcnt(4)
    v_mfma_f32_32x32x16_bf16 v[112:127], v[200:203], v[196:199], v[112:127]
    ds_read_b64_tr_b16 v[186:187], v30 offset:12800
    ds_read_b128 v[180:183], v18 offset:24576
    v_mul_f32 v244, v54, v230
    v_mul_f32 v246, v55, v230
    v_mul_f32 v245, v54, v231
    s_waitcnt lgkmcnt(4)
    v_mfma_f32_32x32x16_bf16 v[128:143], v[204:207], v[192:195], v[128:143]
    ds_read_b64_tr_b16 v[188:189], v30 offset:36864
    ds_read_b64_tr_b16 v[190:191], v30 offset:37376
    v_mul_f32 v247, v55, v231
    v_fma_f32 v54, -v86, v231, v244
    v_fma_f32 v55, -v87, v231, v246
    v_mfma_f32_32x32x16_bf16 v[144:159], v[204:207], v[196:199], v[144:159]
    s_waitcnt lgkmcnt(3)
    v_mfma_f32_32x32x16_bf16 v[96:111], v[184:187], v[176:179], v[96:111]
    ds_read_b128 v[192:195], v19 offset:20480
    ds_read_b64_tr_b16 v[200:201], v30 offset:14336
    v_fma_f32 v86, -v86, v230, -v245
    v_fma_f32 v87, -v87, v230, -v247
    s_waitcnt lgkmcnt(4)
    v_mfma_f32_32x32x16_bf16 v[112:127], v[184:187], v[180:183], v[112:127]
    ds_read_b64_tr_b16 v[202:203], v30 offset:14848
    ds_read_b128 v[196:199], v19 offset:24576
    v_mul_f32 v232, v56, v230
    v_mul_f32 v234, v57, v230
    s_waitcnt lgkmcnt(4)
    v_mfma_f32_32x32x16_bf16 v[128:143], v[188:191], v[176:179], v[128:143]
    ds_read_b64_tr_b16 v[204:205], v30 offset:38912
    ds_read_b64_tr_b16 v[206:207], v30 offset:39424
    v_mul_f32 v233, v56, v231
    v_mul_f32 v235, v57, v231
    v_mfma_f32_32x32x16_bf16 v[144:159], v[188:191], v[180:183], v[144:159]
    v_fma_f32 v56, -v88, v231, v232
    v_fma_f32 v57, -v89, v231, v234
    s_waitcnt lgkmcnt(0)
    s_barrier
    v_subrev_u32 v16, 49152, v16
    v_subrev_u32 v17, 49152, v17
    v_subrev_u32 v18, 49152, v18
    v_subrev_u32 v19, 49152, v19
    v_mfma_f32_32x32x16_bf16 v[96:111], v[200:203], v[192:195], v[96:111]
    ds_read_b128 v[176:179], v16 offset:4096
    ds_read_b64_tr_b16 v[184:185], v30 offset:16384
    v_fma_f32 v88, -v88, v230, -v233
    v_fma_f32 v89, -v89, v230, -v235
    v_mul_f32 v236, v58, v230
    v_mfma_f32_32x32x16_bf16 v[112:127], v[200:203], v[196:199], v[112:127]
    ds_read_b64_tr_b16 v[186:187], v30 offset:16896
    ds_read_b128 v[180:183], v16 offset:8192
    v_mul_f32 v238, v59, v230
    v_mul_f32 v237, v58, v231
    v_mul_f32 v239, v59, v231
    v_mfma_f32_32x32x16_bf16 v[128:143], v[204:207], v[192:195], v[128:143]
    ds_read_b64_tr_b16 v[188:189], v30 offset:40960
    ds_read_b64_tr_b16 v[190:191], v30 offset:41472
    v_fma_f32 v58, -v90, v231, v236
    v_fma_f32 v59, -v91, v231, v238
    v_fma_f32 v90, -v90, v230, -v237
    v_mfma_f32_32x32x16_bf16 v[144:159], v[204:207], v[196:199], v[144:159]
    s_waitcnt lgkmcnt(3)
    v_mfma_f32_32x32x16_bf16 v[96:111], v[184:187], v[176:179], v[96:111]
    ds_read_b128 v[192:195], v17 offset:4096
    ds_read_b64_tr_b16 v[200:201], v30 offset:18432
    v_fma_f32 v91, -v91, v230, -v239
    v_mul_f32 v240, v60, v230
    v_mul_f32 v242, v61, v230
    s_waitcnt lgkmcnt(4)
    v_mfma_f32_32x32x16_bf16 v[112:127], v[184:187], v[180:183], v[112:127]
    ds_read_b64_tr_b16 v[202:203], v30 offset:18944
    ds_read_b128 v[196:199], v17 offset:8192
    v_mul_f32 v241, v60, v231
    v_mul_f32 v243, v61, v231
    v_fma_f32 v60, -v92, v231, v240
    s_waitcnt lgkmcnt(4)
    v_mfma_f32_32x32x16_bf16 v[128:143], v[188:191], v[176:179], v[128:143]
    ds_read_b64_tr_b16 v[204:205], v30 offset:43008
    ds_read_b64_tr_b16 v[206:207], v30 offset:43520
    v_fma_f32 v61, -v93, v231, v242
    v_fma_f32 v92, -v92, v230, -v241
    v_fma_f32 v93, -v93, v230, -v243
    v_mfma_f32_32x32x16_bf16 v[144:159], v[188:191], v[180:183], v[144:159]
    s_waitcnt lgkmcnt(3)
    v_mfma_f32_32x32x16_bf16 v[96:111], v[200:203], v[192:195], v[96:111]
    ds_read_b128 v[176:179], v18 offset:4096
    ds_read_b64_tr_b16 v[184:185], v30 offset:20480
    v_mul_f32 v244, v62, v230
    v_mul_f32 v246, v63, v230
    v_mul_f32 v245, v62, v231
    s_waitcnt lgkmcnt(4)
    v_mfma_f32_32x32x16_bf16 v[112:127], v[200:203], v[196:199], v[112:127]
    ds_read_b64_tr_b16 v[186:187], v30 offset:20992
    ds_read_b128 v[180:183], v18 offset:8192
    v_mul_f32 v247, v63, v231
    v_fma_f32 v62, -v94, v231, v244
    v_fma_f32 v63, -v95, v231, v246
    s_waitcnt lgkmcnt(4)
    v_mfma_f32_32x32x16_bf16 v[128:143], v[204:207], v[192:195], v[128:143]
    ds_read_b64_tr_b16 v[188:189], v30 offset:45056
    ds_read_b64_tr_b16 v[190:191], v30 offset:45568
    v_fma_f32 v94, -v94, v230, -v245
    v_fma_f32 v95, -v95, v230, -v247
    v_readfirstlane_b32 s15, v1
    v_mfma_f32_32x32x16_bf16 v[144:159], v[204:207], v[196:199], v[144:159]
    s_waitcnt lgkmcnt(3)
    v_mfma_f32_32x32x16_bf16 v[96:111], v[184:187], v[176:179], v[96:111]
    ds_read_b128 v[192:195], v19 offset:4096
    ds_read_b64_tr_b16 v[200:201], v30 offset:22528
    v_mul_f32 v212, v160, v226
    v_mul_f32 v213, v160, v227
    s_waitcnt lgkmcnt(4)
    v_mfma_f32_32x32x16_bf16 v[112:127], v[184:187], v[180:183], v[112:127]
    ds_read_b64_tr_b16 v[202:203], v30 offset:23040
    ds_read_b128 v[196:199], v19 offset:8192
    v_fma_f32 v160, -v168, v227, v212
    v_fma_f32 v168, -v168, v226, -v213
    s_waitcnt lgkmcnt(4)
    v_mfma_f32_32x32x16_bf16 v[128:143], v[188:191], v[176:179], v[128:143]
    ds_read_b64_tr_b16 v[204:205], v30 offset:47104
    ds_read_b64_tr_b16 v[206:207], v30 offset:47616
    v_mul_f32 v214, v161, v226
    v_mul_f32 v215, v161, v227
    v_mfma_f32_32x32x16_bf16 v[144:159], v[188:191], v[180:183], v[144:159]
    v_fma_f32 v161, -v169, v227, v214
    v_fma_f32 v169, -v169, v226, -v215
    s_waitcnt lgkmcnt(0)
    s_barrier
    v_mfma_f32_32x32x16_bf16 v[96:111], v[200:203], v[192:195], v[96:111]
    ds_read_b128 v[176:179], v16 offset:20480
    ds_read_b64_tr_b16 v[184:185], v30 offset:0
    v_mul_f32 v212, v162, v226
    v_mul_f32 v213, v162, v227
    v_fma_f32 v162, -v170, v227, v212
    v_mfma_f32_32x32x16_bf16 v[112:127], v[200:203], v[196:199], v[112:127]
    ds_read_b64_tr_b16 v[186:187], v30 offset:512
    ds_read_b128 v[180:183], v16 offset:24576
    v_fma_f32 v170, -v170, v226, -v213
    v_mul_f32 v214, v163, v226
    v_mul_f32 v215, v163, v227
    v_mfma_f32_32x32x16_bf16 v[128:143], v[204:207], v[192:195], v[128:143]
    ds_read_b64_tr_b16 v[188:189], v30 offset:24576
    ds_read_b64_tr_b16 v[190:191], v30 offset:25088
    v_fma_f32 v163, -v171, v227, v214
    v_fma_f32 v171, -v171, v226, -v215
    v_mul_f32 v212, v164, v226
    v_mfma_f32_32x32x16_bf16 v[144:159], v[204:207], v[196:199], v[144:159]
    s_waitcnt lgkmcnt(3)
    v_mfma_f32_32x32x16_bf16 v[96:111], v[184:187], v[176:179], v[96:111]
    ds_read_b128 v[192:195], v17 offset:20480
    ds_read_b64_tr_b16 v[200:201], v30 offset:2048
    v_mul_f32 v213, v164, v227
    v_fma_f32 v164, -v172, v227, v212
    v_fma_f32 v172, -v172, v226, -v213
    s_waitcnt lgkmcnt(4)
    v_mfma_f32_32x32x16_bf16 v[112:127], v[184:187], v[180:183], v[112:127]
    ds_read_b64_tr_b16 v[202:203], v30 offset:2560
    ds_read_b128 v[196:199], v17 offset:24576
    v_mul_f32 v214, v165, v226
    v_mul_f32 v215, v165, v227
    v_fma_f32 v165, -v173, v227, v214
    s_waitcnt lgkmcnt(4)
    v_mfma_f32_32x32x16_bf16 v[128:143], v[188:191], v[176:179], v[128:143]
    ds_read_b64_tr_b16 v[204:205], v30 offset:26624
    ds_read_b64_tr_b16 v[206:207], v30 offset:27136
    v_fma_f32 v173, -v173, v226, -v215
    v_mul_f32 v212, v166, v226
    v_mul_f32 v213, v166, v227
    v_mfma_f32_32x32x16_bf16 v[144:159], v[188:191], v[180:183], v[144:159]
    s_waitcnt lgkmcnt(3)
    v_mfma_f32_32x32x16_bf16 v[96:111], v[200:203], v[192:195], v[96:111]
    ds_read_b128 v[176:179], v18 offset:20480
    ds_read_b64_tr_b16 v[184:185], v30 offset:4096
    v_fma_f32 v166, -v174, v227, v212
    v_fma_f32 v174, -v174, v226, -v213
    v_mul_f32 v214, v167, v226
    s_waitcnt lgkmcnt(4)
    v_mfma_f32_32x32x16_bf16 v[112:127], v[200:203], v[196:199], v[112:127]
    ds_read_b64_tr_b16 v[186:187], v30 offset:4608
    ds_read_b128 v[180:183], v18 offset:24576
    v_mul_f32 v215, v167, v227
    v_fma_f32 v167, -v175, v227, v214
    v_fma_f32 v175, -v175, v226, -v215
    s_waitcnt lgkmcnt(4)
    v_mfma_f32_32x32x16_bf16 v[128:143], v[204:207], v[192:195], v[128:143]
    ds_read_b64_tr_b16 v[188:189], v30 offset:28672
    ds_read_b64_tr_b16 v[190:191], v30 offset:29184
    s_lshl_b32 s4, s3, 10
    s_add_u32 s4, s4, 155648
    v_and_b32 v7, 15, v0
    v_lshlrev_b32 v7, 6, v7
    v_lshrrev_b32 v8, 4, v0
    v_mfma_f32_32x32x16_bf16 v[144:159], v[204:207], v[196:199], v[144:159]
    s_waitcnt lgkmcnt(3)
    v_mfma_f32_32x32x16_bf16 v[96:111], v[184:187], v[176:179], v[96:111]
    ds_read_b128 v[192:195], v19 offset:20480
    ds_read_b64_tr_b16 v[200:201], v30 offset:6144
    v_lshl_add_u32 v7, v8, 4, v7
    v_add_u32 v7, s4, v7
    s_waitcnt lgkmcnt(4)
    v_mfma_f32_32x32x16_bf16 v[112:127], v[184:187], v[180:183], v[112:127]
    ds_read_b64_tr_b16 v[202:203], v30 offset:6656
    ds_read_b128 v[196:199], v19 offset:24576
    v_lshrrev_b32 v9, 5, v0
    v_lshlrev_b32 v9, 3, v9
    s_waitcnt lgkmcnt(4)
    v_mfma_f32_32x32x16_bf16 v[128:143], v[188:191], v[176:179], v[128:143]
    ds_read_b64_tr_b16 v[204:205], v30 offset:30720
    ds_read_b64_tr_b16 v[206:207], v30 offset:31232
    v_bfe_u32 v10, v0, 2, 2
    v_add_u32 v9, v9, v10
    v_mfma_f32_32x32x16_bf16 v[144:159], v[188:191], v[180:183], v[144:159]
    v_bfe_u32 v10, v0, 4, 1
    v_lshlrev_b32 v10, 5, v10
    s_waitcnt lgkmcnt(0)
    s_barrier
    v_mfma_f32_32x32x16_bf16 v[96:111], v[200:203], v[192:195], v[96:111]
    ds_read_b128 v[176:179], v16 offset:36864
    ds_read_b64_tr_b16 v[184:185], v30 offset:8192
    v_and_b32 v11, 3, v0
    v_lshl_add_u32 v10, v11, 3, v10
    v_mfma_f32_32x32x16_bf16 v[112:127], v[200:203], v[196:199], v[112:127]
    ds_read_b64_tr_b16 v[186:187], v30 offset:8704
    ds_read_b128 v[180:183], v16 offset:40960
    v_lshl_add_u32 v8, v9, 6, v10
    v_add_u32 v8, s4, v8
    v_mfma_f32_32x32x16_bf16 v[128:143], v[204:207], v[192:195], v[128:143]
    ds_read_b64_tr_b16 v[188:189], v30 offset:32768
    ds_read_b64_tr_b16 v[190:191], v30 offset:33280
    s_mov_b32 s4, 69632
    s_cmp_ge_u32 s3, 2
    s_cselect_b32 s4, 77824, s4
    s_and_b32 s5, s3, 1
    s_lshl_b32 s5, s5, 12
    s_add_u32 s4, s4, s5
    v_and_b32 v11, 1, v0
    v_bfe_u32 v4, v0, 2, 1
    v_mfma_f32_32x32x16_bf16 v[144:159], v[204:207], v[196:199], v[144:159]
    v_lshl_or_b32 v11, v4, 1, v11
    v_bfe_u32 v4, v0, 1, 1
    s_waitcnt lgkmcnt(3)
    v_mfma_f32_32x32x16_bf16 v[96:111], v[184:187], v[176:179], v[96:111]
    ds_read_b128 v[192:195], v17 offset:36864
    ds_read_b64_tr_b16 v[200:201], v30 offset:10240
    v_lshl_or_b32 v11, v4, 2, v11
    v_lshrrev_b32 v4, 5, v0
    s_waitcnt lgkmcnt(4)
    v_mfma_f32_32x32x16_bf16 v[112:127], v[184:187], v[180:183], v[112:127]
    ds_read_b64_tr_b16 v[202:203], v30 offset:10752
    ds_read_b128 v[196:199], v17 offset:40960
    v_lshlrev_b32 v4, 2, v4
    v_xor_b32 v11, v11, v4
    s_waitcnt lgkmcnt(4)
    v_mfma_f32_32x32x16_bf16 v[128:143], v[188:191], v[176:179], v[128:143]
    ds_read_b64_tr_b16 v[204:205], v30 offset:34816
    ds_read_b64_tr_b16 v[206:207], v30 offset:35328
    v_lshlrev_b32 v11, 4, v11
    v_and_b32 v4, 31, v0
    v_mfma_f32_32x32x16_bf16 v[144:159], v[188:191], v[180:183], v[144:159]
    v_lshl_add_u32 v12, v4, 7, v11
    v_add_u32 v12, s4, v12
    s_waitcnt lgkmcnt(3)
    v_mfma_f32_32x32x16_bf16 v[96:111], v[200:203], v[192:195], v[96:111]
    ds_read_b128 v[176:179], v18 offset:36864
    ds_read_b64_tr_b16 v[184:185], v30 offset:12288
    v_xor_b32 v13, 16, v12
    v_xor_b32 v14, 32, v12
    s_waitcnt lgkmcnt(4)
    v_mfma_f32_32x32x16_bf16 v[112:127], v[200:203], v[196:199], v[112:127]
    ds_read_b64_tr_b16 v[186:187], v30 offset:12800
    ds_read_b128 v[180:183], v18 offset:40960
    v_xor_b32 v15, 48, v12
    v_bfe_u32 v11, v0, 2, 1
    s_waitcnt lgkmcnt(4)
    v_mfma_f32_32x32x16_bf16 v[128:143], v[204:207], v[192:195], v[128:143]
    ds_read_b64_tr_b16 v[188:189], v30 offset:36864
    ds_read_b64_tr_b16 v[190:191], v30 offset:37376
    v_bfe_u32 v4, v0, 3, 1
    v_lshl_or_b32 v11, v4, 2, v11
    v_mfma_f32_32x32x16_bf16 v[144:159], v[204:207], v[196:199], v[144:159]
    v_lshlrev_b32 v11, 4, v11
    v_xor_b32 v11, v11, v10
    s_waitcnt lgkmcnt(3)
    v_mfma_f32_32x32x16_bf16 v[96:111], v[184:187], v[176:179], v[96:111]
    ds_read_b128 v[192:195], v19 offset:36864
    ds_read_b64_tr_b16 v[200:201], v30 offset:14336
    v_lshl_add_u32 v20, v9, 7, v11
    v_add_u32 v20, s4, v20
    s_waitcnt lgkmcnt(4)
    v_mfma_f32_32x32x16_bf16 v[112:127], v[184:187], v[180:183], v[112:127]
    ds_read_b64_tr_b16 v[202:203], v30 offset:14848
    ds_read_b128 v[196:199], v19 offset:40960
    v_xor_b32 v21, 32, v20
    v_add_u32 v21, 512, v21
    s_waitcnt lgkmcnt(4)
    v_mfma_f32_32x32x16_bf16 v[128:143], v[188:191], v[176:179], v[128:143]
    ds_read_b64_tr_b16 v[204:205], v30 offset:38912
    ds_read_b64_tr_b16 v[206:207], v30 offset:39424
    v_xor_b32 v22, 64, v20
    v_xor_b32 v23, 64, v21
    v_mfma_f32_32x32x16_bf16 v[144:159], v[188:191], v[180:183], v[144:159]
    v_mov_b32 v1, s15
    v_mov_b32 v2, 0
    s_mov_b64 exec, 1
    buffer_store_dword v1, v2, s[64:67], s81 offen offset:0 sc1
    s_mov_b64 exec, -1
    s_waitcnt lgkmcnt(0)
    s_barrier
    v_add_u32 v16, 49152, v16
    v_add_u32 v17, 49152, v17
    v_add_u32 v18, 49152, v18
    v_add_u32 v19, 49152, v19
    v_mfma_f32_32x32x16_bf16 v[96:111], v[200:203], v[192:195], v[96:111]
    ds_read_b128 v[176:179], v16 offset:36864
    ds_read_b64_tr_b16 v[184:185], v30 offset:16384
    ds_read_b32 v208, v5 offset:0
    ds_read_b32 v209, v5 offset:1024
    ds_read_b32 v216, v3 offset:2048
    ds_read_b32 v218, v3 offset:8192
    ds_read_b32 v217, v3 offset:2304
    v_mfma_f32_32x32x16_bf16 v[112:127], v[200:203], v[196:199], v[112:127]
    ds_read_b64_tr_b16 v[186:187], v30 offset:16896
    ds_read_b128 v[180:183], v16 offset:40960
    ds_read_b32 v219, v3 offset:8448
    s_waitcnt lgkmcnt(6)
    v_mul_f32 v212, v208, v226
    v_mul_f32 v213, v208, v227
    v_fma_f32 v208, -v209, v227, v212
    v_fma_f32 v209, -v209, v226, -v213
    v_mfma_f32_32x32x16_bf16 v[128:143], v[204:207], v[192:195], v[128:143]
    ds_read_b64_tr_b16 v[188:189], v30 offset:40960
    ds_read_b64_tr_b16 v[190:191], v30 offset:41472
    s_waitcnt lgkmcnt(2)
    v_mul_f32 v220, v216, v230
    v_mul_f32 v222, v217, v230
    v_mul_f32 v221, v216, v231
    v_mul_f32 v223, v217, v231
    v_fma_f32 v216, -v218, v231, v220
    v_mfma_f32_32x32x16_bf16 v[144:159], v[204:207], v[196:199], v[144:159]
    v_fma_f32 v217, -v219, v231, v222
    v_fma_f32 v218, -v218, v230, -v221
    v_fma_f32 v219, -v219, v230, -v223
    v_mfma_f32_32x32x16_bf16 v[96:111], v[184:187], v[176:179], v[96:111]
    ds_read_b128 v[192:195], v17 offset:36864
    ds_read_b64_tr_b16 v[200:201], v30 offset:18432
    v_fma_f32 v32, v216, v228, v32
    v_fma_f32 v160, v208, v224, v160
    v_fma_f32 v64, v218, v228, v64
    v_fma_f32 v33, v217, v228, v33
    v_fma_f32 v168, v209, v224, v168
    v_mfma_f32_32x32x16_bf16 v[112:127], v[184:187], v[180:183], v[112:127]
    ds_read_b64_tr_b16 v[202:203], v30 offset:18944
    ds_read_b128 v[196:199], v17 offset:40960
    v_fma_f32 v65, v219, v228, v65
    v_fma_f32 v32, v218, v229, v32
    v_fma_f32 v64, -v216, v229, v64
    v_fma_f32 v160, v209, v225, v160
    v_fma_f32 v33, v219, v229, v33
    s_waitcnt lgkmcnt(4)
    v_mfma_f32_32x32x16_bf16 v[128:143], v[188:191], v[176:179], v[128:143]
    ds_read_b64_tr_b16 v[204:205], v30 offset:43008
    ds_read_b64_tr_b16 v[206:207], v30 offset:43520
    v_fma_f32 v65, -v217, v229, v65
    v_fma_f32 v34, v32, v228, v34
    v_fma_f32 v168, -v208, v225, v168
    v_fma_f32 v66, v64, v228, v66
    v_fma_f32 v35, v33, v228, v35
    v_mfma_f32_32x32x16_bf16 v[144:159], v[188:191], v[180:183], v[144:159]
    v_fma_f32 v161, v160, v224, v161
    v_fma_f32 v67, v65, v228, v67
    v_fma_f32 v34, v64, v229, v34
    s_waitcnt lgkmcnt(3)
    v_mfma_f32_32x32x16_bf16 v[96:111], v[200:203], v[192:195], v[96:111]
    ds_read_b128 v[176:179], v18 offset:36864
    ds_read_b64_tr_b16 v[184:185], v30 offset:20480
    v_fma_f32 v66, -v32, v229, v66
    v_fma_f32 v169, v168, v224, v169
    v_fma_f32 v35, v65, v229, v35
    v_fma_f32 v67, -v33, v229, v67
    v_fma_f32 v36, v34, v228, v36
    s_waitcnt lgkmcnt(4)
    v_mfma_f32_32x32x16_bf16 v[112:127], v[200:203], v[196:199], v[112:127]
    ds_read_b64_tr_b16 v[186:187], v30 offset:20992
    ds_read_b128 v[180:183], v18 offset:40960
    v_fma_f32 v161, v168, v225, v161
    v_fma_f32 v68, v66, v228, v68
    v_fma_f32 v37, v35, v228, v37
    v_fma_f32 v169, -v160, v225, v169
    v_fma_f32 v69, v67, v228, v69
    s_waitcnt lgkmcnt(4)
    v_mfma_f32_32x32x16_bf16 v[128:143], v[204:207], v[192:195], v[128:143]
    ds_read_b64_tr_b16 v[188:189], v30 offset:45056
    ds_read_b64_tr_b16 v[190:191], v30 offset:45568
    v_fma_f32 v36, v66, v229, v36
    v_fma_f32 v68, -v34, v229, v68
    v_fma_f32 v162, v161, v224, v162
    v_fma_f32 v37, v67, v229, v37
    v_fma_f32 v69, -v35, v229, v69
    v_mfma_f32_32x32x16_bf16 v[144:159], v[204:207], v[196:199], v[144:159]
    v_fma_f32 v38, v36, v228, v38
    v_fma_f32 v170, v169, v224, v170
    v_fma_f32 v70, v68, v228, v70
    s_waitcnt lgkmcnt(3)
    v_mfma_f32_32x32x16_bf16 v[96:111], v[184:187], v[176:179], v[96:111]
    ds_read_b128 v[192:195], v19 offset:36864
    ds_read_b64_tr_b16 v[200:201], v30 offset:22528
    v_fma_f32 v39, v37, v228, v39
    v_fma_f32 v162, v169, v225, v162
    v_fma_f32 v71, v69, v228, v71
    v_fma_f32 v38, v68, v229, v38
    v_fma_f32 v70, -v36, v229, v70
    s_waitcnt lgkmcnt(4)
    v_mfma_f32_32x32x16_bf16 v[112:127], v[184:187], v[180:183], v[112:127]
    ds_read_b64_tr_b16 v[202:203], v30 offset:23040
    ds_read_b128 v[196:199], v19 offset:40960
    v_fma_f32 v170, -v161, v225, v170
    v_fma_f32 v39, v69, v229, v39
    v_fma_f32 v71, -v37, v229, v71
    v_fma_f32 v40, v38, v228, v40
    v_fma_f32 v163, v162, v224, v163
    s_waitcnt lgkmcnt(4)
    v_mfma_f32_32x32x16_bf16 v[128:143], v[188:191], v[176:179], v[128:143]
    ds_read_b64_tr_b16 v[204:205], v30 offset:47104
    ds_read_b64_tr_b16 v[206:207], v30 offset:47616
    v_fma_f32 v72, v70, v228, v72
    v_fma_f32 v41, v39, v228, v41
    v_fma_f32 v171, v170, v224, v171
    v_fma_f32 v73, v71, v228, v73
    v_fma_f32 v40, v70, v229, v40
    v_mfma_f32_32x32x16_bf16 v[144:159], v[188:191], v[180:183], v[144:159]
    v_fma_f32 v72, -v38, v229, v72
    v_fma_f32 v163, v170, v225, v163
    v_fma_f32 v41, v71, v229, v41
    s_waitcnt lgkmcnt(0)
    s_barrier
    v_mfma_f32_32x32x16_bf16 v[96:111], v[200:203], v[192:195], v[96:111]
    ds_read_b128 v[176:179], v16 offset:4096
    ds_read_b64_tr_b16 v[184:185], v30 offset:0
    v_fma_f32 v73, -v39, v229, v73
    v_fma_f32 v42, v40, v228, v42
    v_fma_f32 v171, -v162, v225, v171
    v_fma_f32 v74, v72, v228, v74
    v_fma_f32 v43, v41, v228, v43
    v_mfma_f32_32x32x16_bf16 v[112:127], v[200:203], v[196:199], v[112:127]
    ds_read_b64_tr_b16 v[186:187], v30 offset:512
    ds_read_b128 v[180:183], v16 offset:8192
    v_fma_f32 v164, v163, v224, v164
    v_fma_f32 v75, v73, v228, v75
    v_fma_f32 v42, v72, v229, v42
    v_fma_f32 v74, -v40, v229, v74
    v_fma_f32 v172, v171, v224, v172
    v_mfma_f32_32x32x16_bf16 v[128:143], v[204:207], v[192:195], v[128:143]
    ds_read_b64_tr_b16 v[188:189], v30 offset:24576
    ds_read_b64_tr_b16 v[190:191], v30 offset:25088
    v_fma_f32 v43, v73, v229, v43
    v_fma_f32 v75, -v41, v229, v75
    v_fma_f32 v44, v42, v228, v44
    v_fma_f32 v164, v171, v225, v164
    v_fma_f32 v76, v74, v228, v76
    v_mfma_f32_32x32x16_bf16 v[144:159], v[204:207], v[196:199], v[144:159]
    v_fma_f32 v45, v43, v228, v45
    v_fma_f32 v172, -v163, v225, v172
    v_fma_f32 v77, v75, v228, v77
    s_waitcnt lgkmcnt(3)
    v_mfma_f32_32x32x16_bf16 v[96:111], v[184:187], v[176:179], v[96:111]
    ds_read_b128 v[192:195], v17 offset:4096
    ds_read_b64_tr_b16 v[200:201], v30 offset:2048
    v_fma_f32 v44, v74, v229, v44
    v_fma_f32 v76, -v42, v229, v76
    v_fma_f32 v165, v164, v224, v165
    v_fma_f32 v45, v75, v229, v45
    v_fma_f32 v77, -v43, v229, v77
    s_waitcnt lgkmcnt(4)
    v_mfma_f32_32x32x16_bf16 v[112:127], v[184:187], v[180:183], v[112:127]
    ds_read_b64_tr_b16 v[202:203], v30 offset:2560
    ds_read_b128 v[196:199], v17 offset:8192
    v_fma_f32 v46, v44, v228, v46
    v_fma_f32 v173, v172, v224, v173
    v_fma_f32 v78, v76, v228, v78
    v_fma_f32 v47, v45, v228, v47
    v_fma_f32 v165, v172, v225, v165
    s_waitcnt lgkmcnt(4)
    v_mfma_f32_32x32x16_bf16 v[128:143], v[188:191], v[176:179], v[128:143]
    ds_read_b64_tr_b16 v[204:205], v30 offset:26624
    ds_read_b64_tr_b16 v[206:207], v30 offset:27136
    v_fma_f32 v79, v77, v228, v79
    v_fma_f32 v46, v76, v229, v46
    v_fma_f32 v78, -v44, v229, v78
    v_fma_f32 v173, -v164, v225, v173
    v_fma_f32 v47, v77, v229, v47
    v_mfma_f32_32x32x16_bf16 v[144:159], v[188:191], v[180:183], v[144:159]
    v_fma_f32 v79, -v45, v229, v79
    v_fma_f32 v48, v46, v228, v48
    v_fma_f32 v166, v165, v224, v166
    s_waitcnt lgkmcnt(3)
    v_mfma_f32_32x32x16_bf16 v[96:111], v[200:203], v[192:195], v[96:111]
    ds_read_b128 v[176:179], v18 offset:4096
    ds_read_b64_tr_b16 v[184:185], v30 offset:4096
    v_fma_f32 v80, v78, v228, v80
    v_fma_f32 v49, v47, v228, v49
    v_fma_f32 v174, v173, v224, v174
    v_fma_f32 v81, v79, v228, v81
    v_fma_f32 v48, v78, v229, v48
    s_waitcnt lgkmcnt(4)
    v_mfma_f32_32x32x16_bf16 v[112:127], v[200:203], v[196:199], v[112:127]
    ds_read_b64_tr_b16 v[186:187], v30 offset:4608
    ds_read_b128 v[180:183], v18 offset:8192
    v_fma_f32 v80, -v46, v229, v80
    v_fma_f32 v166, v173, v225, v166
    v_fma_f32 v49, v79, v229, v49
    v_fma_f32 v81, -v47, v229, v81
    v_fma_f32 v50, v48, v228, v50
    s_waitcnt lgkmcnt(4)
    v_mfma_f32_32x32x16_bf16 v[128:143], v[204:207], v[192:195], v[128:143]
    ds_read_b64_tr_b16 v[188:189], v30 offset:28672
    ds_read_b64_tr_b16 v[190:191], v30 offset:29184
    v_fma_f32 v174, -v165, v225, v174
    v_fma_f32 v82, v80, v228, v82
    v_fma_f32 v51, v49, v228, v51
    v_fma_f32 v167, v166, v224, v167
    v_fma_f32 v83, v81, v228, v83
    v_mfma_f32_32x32x16_bf16 v[144:159], v[204:207], v[196:199], v[144:159]
    v_fma_f32 v50, v80, v229, v50
    v_fma_f32 v82, -v48, v229, v82
    v_fma_f32 v175, v174, v224, v175
    s_waitcnt lgkmcnt(3)
    v_mfma_f32_32x32x16_bf16 v[96:111], v[184:187], v[176:179], v[96:111]
    ds_read_b128 v[192:195], v19 offset:4096
    ds_read_b64_tr_b16 v[200:201], v30 offset:6144
    v_fma_f32 v51, v81, v229, v51
    v_fma_f32 v83, -v49, v229, v83
    v_fma_f32 v52, v50, v228, v52
    v_fma_f32 v167, v174, v225, v167
    v_fma_f32 v84, v82, v228, v84
    s_waitcnt lgkmcnt(4)
    v_mfma_f32_32x32x16_bf16 v[112:127], v[184:187], v[180:183], v[112:127]
    ds_read_b64_tr_b16 v[202:203], v30 offset:6656
    ds_read_b128 v[196:199], v19 offset:8192
    v_fma_f32 v53, v51, v228, v53
    v_fma_f32 v175, -v166, v225, v175
    v_fma_f32 v85, v83, v228, v85
    v_fma_f32 v52, v82, v229, v52
    v_fma_f32 v84, -v50, v229, v84
    s_waitcnt lgkmcnt(4)
    v_mfma_f32_32x32x16_bf16 v[128:143], v[188:191], v[176:179], v[128:143]
    ds_read_b64_tr_b16 v[204:205], v30 offset:30720
    ds_read_b64_tr_b16 v[206:207], v30 offset:31232
    v_cvt_pk_bf16_f32 v232, v160, v161
    v_fma_f32 v53, v83, v229, v53
    v_fma_f32 v85, -v51, v229, v85
    v_fma_f32 v54, v52, v228, v54
    v_cvt_pk_bf16_f32 v233, v162, v163
    v_mfma_f32_32x32x16_bf16 v[144:159], v[188:191], v[180:183], v[144:159]
    v_fma_f32 v86, v84, v228, v86
    v_fma_f32 v55, v53, v228, v55
    v_cvt_pk_bf16_f32 v234, v164, v165
    s_waitcnt lgkmcnt(3)
    v_mfma_f32_32x32x16_bf16 v[96:111], v[200:203], v[192:195], v[96:111]
    v_fma_f32 v87, v85, v228, v87
    v_fma_f32 v54, v84, v229, v54
    v_fma_f32 v86, -v52, v229, v86
    v_cvt_pk_bf16_f32 v235, v166, v167
    s_waitcnt lgkmcnt(2)
    v_mfma_f32_32x32x16_bf16 v[112:127], v[200:203], v[196:199], v[112:127]
    v_fma_f32 v55, v85, v229, v55
    v_fma_f32 v87, -v53, v229, v87
    v_fma_f32 v56, v54, v228, v56
    v_cvt_pk_bf16_f32 v236, v168, v169
    s_waitcnt lgkmcnt(0)
    v_mfma_f32_32x32x16_bf16 v[128:143], v[204:207], v[192:195], v[128:143]
    v_fma_f32 v88, v86, v228, v88
    v_fma_f32 v57, v55, v228, v57
    v_cvt_pk_bf16_f32 v237, v170, v171
    v_fma_f32 v89, v87, v228, v89
    v_mfma_f32_32x32x16_bf16 v[144:159], v[204:207], v[196:199], v[144:159]
    v_fma_f32 v56, v86, v229, v56
    v_fma_f32 v88, -v54, v229, v88
    v_cvt_pk_bf16_f32 v238, v172, v173
    v_fma_f32 v57, v87, v229, v57
    v_fma_f32 v89, -v55, v229, v89
    v_fma_f32 v58, v56, v228, v58
    v_cvt_pk_bf16_f32 v239, v174, v175
    v_fma_f32 v90, v88, v228, v90
    v_fma_f32 v59, v57, v228, v59
    ds_write_b128 v7, v[232:235]
    v_fma_f32 v91, v89, v228, v91
    v_fma_f32 v58, v88, v229, v58
    v_fma_f32 v90, -v56, v229, v90
    ds_read_b64_tr_b16 v[240:241], v8
    v_fma_f32 v59, v89, v229, v59
    v_fma_f32 v91, -v57, v229, v91
    v_fma_f32 v60, v58, v228, v60
    ds_read_b64_tr_b16 v[242:243], v8 offset:256
    v_fma_f32 v92, v90, v228, v92
    v_fma_f32 v61, v59, v228, v61
    ds_write_b128 v7, v[236:239]
    v_fma_f32 v93, v91, v228, v93
    v_fma_f32 v60, v90, v229, v60
    v_fma_f32 v92, -v58, v229, v92
    ds_read_b64_tr_b16 v[244:245], v8
    v_fma_f32 v61, v91, v229, v61
    v_fma_f32 v93, -v59, v229, v93
    v_fma_f32 v62, v60, v228, v62
    ds_read_b64_tr_b16 v[246:247], v8 offset:256
    v_fma_f32 v94, v92, v228, v94
    v_fma_f32 v63, v61, v228, v63
    s_waitcnt lgkmcnt(3)
    buffer_store_dwordx4 v[240:243], v6, s[64:67], s82 offen sc1
    v_fma_f32 v95, v93, v228, v95
    v_fma_f32 v62, v92, v229, v62
    v_fma_f32 v94, -v60, v229, v94
    s_waitcnt lgkmcnt(0)
    buffer_store_dwordx4 v[244:247], v6, s[64:67], s83 offen sc1
    v_fma_f32 v63, v93, v229, v63
    v_fma_f32 v95, -v61, v229, v95
    v_cvt_pk_bf16_f32 v216, v32, v34
    v_cvt_pk_bf16_f32 v217, v36, v38
    v_cvt_pk_bf16_f32 v218, v40, v42
    v_cvt_pk_bf16_f32 v219, v44, v46
    ds_write_b128 v12, v[216:219]
    v_cvt_pk_bf16_f32 v220, v48, v50
    v_cvt_pk_bf16_f32 v221, v52, v54
    v_cvt_pk_bf16_f32 v222, v56, v58
    v_cvt_pk_bf16_f32 v223, v60, v62
    ds_write_b128 v13, v[220:223]
    v_cvt_pk_bf16_f32 v224, v33, v35
    v_cvt_pk_bf16_f32 v225, v37, v39
    v_cvt_pk_bf16_f32 v226, v41, v43
    v_cvt_pk_bf16_f32 v227, v45, v47
    ds_write_b128 v14, v[224:227]
    v_cvt_pk_bf16_f32 v228, v49, v51
    v_cvt_pk_bf16_f32 v229, v53, v55
    v_cvt_pk_bf16_f32 v230, v57, v59
    v_cvt_pk_bf16_f32 v231, v61, v63
    ds_write_b128 v15, v[228:231]
    ds_read_b64_tr_b16 v[32:33], v20 offset:0
    ds_read_b64_tr_b16 v[34:35], v21 offset:0
    ds_read_b64_tr_b16 v[36:37], v20 offset:2048
    ds_read_b64_tr_b16 v[38:39], v21 offset:2048
    ds_read_b64_tr_b16 v[40:41], v22 offset:0
    ds_read_b64_tr_b16 v[42:43], v23 offset:0
    ds_read_b64_tr_b16 v[44:45], v22 offset:2048
    ds_read_b64_tr_b16 v[46:47], v23 offset:2048
    v_cvt_pk_bf16_f32 v232, v64, v66
    v_cvt_pk_bf16_f32 v233, v68, v70
    v_cvt_pk_bf16_f32 v234, v72, v74
    v_cvt_pk_bf16_f32 v235, v76, v78
    ds_write_b128 v12, v[232:235]
    v_cvt_pk_bf16_f32 v236, v80, v82
    v_cvt_pk_bf16_f32 v237, v84, v86
    v_cvt_pk_bf16_f32 v238, v88, v90
    v_cvt_pk_bf16_f32 v239, v92, v94
    ds_write_b128 v13, v[236:239]
    v_cvt_pk_bf16_f32 v240, v65, v67
    v_cvt_pk_bf16_f32 v241, v69, v71
    v_cvt_pk_bf16_f32 v242, v73, v75
    v_cvt_pk_bf16_f32 v243, v77, v79
    ds_write_b128 v14, v[240:243]
    v_cvt_pk_bf16_f32 v244, v81, v83
    v_cvt_pk_bf16_f32 v245, v85, v87
    v_cvt_pk_bf16_f32 v246, v89, v91
    v_cvt_pk_bf16_f32 v247, v93, v95
    ds_write_b128 v15, v[244:247]
    ds_read_b64_tr_b16 v[64:65], v20 offset:0
    ds_read_b64_tr_b16 v[66:67], v21 offset:0
    ds_read_b64_tr_b16 v[68:69], v20 offset:2048
    ds_read_b64_tr_b16 v[70:71], v21 offset:2048
    ds_read_b64_tr_b16 v[72:73], v22 offset:0
    ds_read_b64_tr_b16 v[74:75], v23 offset:0
    ds_read_b64_tr_b16 v[76:77], v22 offset:2048
    ds_read_b64_tr_b16 v[78:79], v23 offset:2048
    s_waitcnt lgkmcnt(15)
    s_add_u32 s5, s80, 0
    buffer_store_dwordx4 v[32:35], v6, s[64:67], s5 offen sc1
    s_add_u32 s5, s80, 1024
    buffer_store_dwordx4 v[36:39], v6, s[64:67], s5 offen sc1
    s_waitcnt lgkmcnt(14)
    s_add_u32 s5, s80, 180224
    buffer_store_dwordx4 v[40:43], v6, s[64:67], s5 offen sc1
    s_waitcnt lgkmcnt(12)
    s_add_u32 s5, s80, 181248
    buffer_store_dwordx4 v[44:47], v6, s[64:67], s5 offen sc1
    s_waitcnt lgkmcnt(6)
    s_add_u32 s5, s80, 4096
    buffer_store_dwordx4 v[64:67], v6, s[64:67], s5 offen sc1
    s_waitcnt lgkmcnt(4)
    s_add_u32 s5, s80, 5120
    buffer_store_dwordx4 v[68:71], v6, s[64:67], s5 offen sc1
    s_waitcnt lgkmcnt(2)
    s_add_u32 s5, s80, 184320
    buffer_store_dwordx4 v[72:75], v6, s[64:67], s5 offen sc1
    s_waitcnt lgkmcnt(0)
    s_add_u32 s5, s80, 185344
    buffer_store_dwordx4 v[76:79], v6, s[64:67], s5 offen sc1
L_4:
    s_and_b32 s4, s2, 7
    s_lshr_b32 s5, s2, 3
    s_lshl_b32 s84, s4, 2
    s_lshr_b32 s4, s5, 3
    s_add_u32 s84, s84, s4
    s_and_b32 s85, s5, 7
    s_and_b32 s8, s3, 1
    s_lshr_b32 s9, s3, 1
    s_mov_b32 s52, s16
    s_mov_b32 s53, s17
    s_mov_b32 s54, 2097152
    s_mov_b32 s55, 0x20000
    s_mov_b32 s56, s32
    s_mov_b32 s57, s33
    s_mov_b32 s58, 1024
    s_mov_b32 s59, 0x20000
    s_mov_b32 s60, s44
    s_mov_b32 s61, s45
    s_mov_b32 s62, 4194304
    s_mov_b32 s63, 0x20000
    s_lshl_b32 s10, s84, 6
    s_lshl_b32 s4, s9, 5
    s_add_u32 s10, s10, s4
    s_lshl_b32 s11, s85, 6
    s_lshl_b32 s4, s8, 5
    s_add_u32 s11, s11, s4
    v_and_b32 v1, 31, v0
    v_add_u32 v1, s11, v1
    v_lshrrev_b32 v2, 5, v0
    v_lshlrev_b32 v2, 2, v2
    v_add_u32 v2, s10, v2
    v_lshlrev_b32 v3, 1, v1
    v_lshl_add_u32 v4, v2, 10, v3
    v_lshlrev_b32 v5, 2, v1
    v_lshl_add_u32 v5, v2, 11, v5
    v_lshlrev_b32 v10, 2, v2
    v_add_u32 v10, 11534336, v10
    s_lshl_b32 s4, s84, 1
    s_add_u32 s4, s4, s9
    s_mul_i32 s4, s4, 176
    s_lshl_b32 s5, s8, 1
    s_add_u32 s4, s4, s5
    s_lshl_b32 s80, s4, 10
    v_lshrrev_b32 v7, 5, v0
    v_lshlrev_b32 v7, 2, v7
    v_bfe_u32 v8, v0, 2, 2
    v_add_u32 v7, v7, v8
    v_bfe_u32 v8, v0, 4, 1
    v_lshlrev_b32 v8, 5, v8
    v_and_b32 v9, 3, v0
    v_lshl_add_u32 v8, v9, 3, v8
    v_bfe_u32 v9, v0, 3, 1
    v_lshlrev_b32 v9, 6, v9
    v_xor_b32 v8, v8, v9
    s_lshl_b32 s4, s8, 12
    v_lshl_add_u32 v12, v7, 7, v8
    v_add_u32 v12, s4, v12
    v_xor_b32 v13, 64, v12
    v_and_b32 v7, 31, v0
    v_bfe_u32 v8, v0, 1, 3
    v_lshrrev_b32 v9, 5, v0
    v_xor_b32 v8, v8, v9
    s_lshl_b32 s4, s8, 2
    v_xor_b32 v8, s4, v8
    v_lshlrev_b32 v8, 4, v8
    v_lshl_add_u32 v18, v7, 7, v8
    v_xor_b32 v19, 32, v18
    v_add_u32 v14, 57344, v12
    v_add_u32 v20, 57344, v18
    v_add_u32 v15, 57344, v13
    v_add_u32 v21, 57344, v19
    v_add_u32 v16, 114688, v12
    v_add_u32 v22, 114688, v18
    v_add_u32 v17, 114688, v13
    v_add_u32 v23, 114688, v19
    s_barrier
    s_add_u32 s4, s80, 0
    buffer_load_dwordx4 v[240:243], v6, s[64:67], s4 offen sc1
    s_add_u32 s4, s80, 1024
    buffer_load_dwordx4 v[244:247], v6, s[64:67], s4 offen sc1
    s_add_u32 s4, s80, 8192
    buffer_load_dwordx4 v[248:251], v6, s[64:67], s4 offen sc1
    s_add_u32 s4, s80, 9216
    buffer_load_dwordx4 v[252:255], v6, s[64:67], s4 offen sc1
    s_add_u32 s4, s80, 16384
    buffer_load_dwordx4 v[160:163], v6, s[64:67], s4 offen sc1
    s_add_u32 s4, s80, 17408
    buffer_load_dwordx4 v[164:167], v6, s[64:67], s4 offen sc1
    s_add_u32 s4, s80, 28672
    buffer_load_dwordx4 v[168:171], v6, s[64:67], s4 offen sc1
    s_add_u32 s4, s80, 29696
    buffer_load_dwordx4 v[172:175], v6, s[64:67], s4 offen sc1
    ds_read_b64_tr_b16 v[176:177], v12 offset:4096
    ds_read_b64_tr_b16 v[178:179], v12 offset:5120
    ds_read_b64_tr_b16 v[180:181], v13 offset:4096
    ds_read_b64_tr_b16 v[182:183], v13 offset:5120
    ds_read_b64_tr_b16 v[184:185], v12 offset:6144
    ds_read_b64_tr_b16 v[186:187], v12 offset:7168
    ds_read_b64_tr_b16 v[188:189], v13 offset:6144
    ds_read_b64_tr_b16 v[190:191], v13 offset:7168
    ds_read_b64_tr_b16 v[192:193], v12 offset:12288
    ds_read_b64_tr_b16 v[194:195], v12 offset:13312
    ds_read_b64_tr_b16 v[196:197], v13 offset:12288
    ds_read_b64_tr_b16 v[198:199], v13 offset:13312
    ds_read_b64_tr_b16 v[200:201], v12 offset:14336
    ds_read_b64_tr_b16 v[202:203], v12 offset:15360
    ds_read_b64_tr_b16 v[204:205], v13 offset:14336
    ds_read_b64_tr_b16 v[206:207], v13 offset:15360
    v_mul_f32 v64, s50, v112
    v_mul_f32 v65, s50, v113
    v_mul_f32 v66, s50, v114
    v_mul_f32 v67, s50, v115
    v_mul_f32 v68, s50, v116
    v_mul_f32 v69, s50, v117
    v_mul_f32 v70, s50, v118
    v_mul_f32 v71, s50, v119
    v_exp_f32 v64, v64
    v_exp_f32 v65, v65
    v_exp_f32 v66, v66
    v_exp_f32 v67, v67
    v_exp_f32 v68, v68
    v_exp_f32 v69, v69
    v_exp_f32 v70, v70
    v_exp_f32 v71, v71
    v_add_f32 v64, 1.0, v64
    v_add_f32 v65, 1.0, v65
    v_add_f32 v66, 1.0, v66
    v_add_f32 v67, 1.0, v67
    v_add_f32 v68, 1.0, v68
    v_add_f32 v69, 1.0, v69
    v_add_f32 v70, 1.0, v70
    v_add_f32 v71, 1.0, v71
    v_rcp_f32 v64, v64
    v_rcp_f32 v65, v65
    v_rcp_f32 v66, v66
    v_rcp_f32 v67, v67
    v_rcp_f32 v68, v68
    v_rcp_f32 v69, v69
    v_rcp_f32 v70, v70
    v_rcp_f32 v71, v71
    v_mul_f32 v64, v64, v144
    v_mul_f32 v65, v65, v145
    v_mul_f32 v66, v66, v146
    v_mul_f32 v67, v67, v147
    v_mul_f32 v68, v68, v148
    v_mul_f32 v69, v69, v149
    v_mul_f32 v70, v70, v150
    v_mul_f32 v71, v71, v151
    v_cvt_pk_bf16_f32 v80, v64, v65
    v_cvt_pk_bf16_f32 v81, v66, v67
    v_cvt_pk_bf16_f32 v82, v68, v69
    v_cvt_pk_bf16_f32 v83, v70, v71
    s_add_u32 s5, s77, 180224
    buffer_store_dwordx4 v[80:83], v6, s[64:67], s5 offen sc1
    v_mul_f32 v72, s50, v120
    v_mul_f32 v73, s50, v121
    v_mul_f32 v74, s50, v122
    v_mul_f32 v75, s50, v123
    v_mul_f32 v76, s50, v124
    v_mul_f32 v77, s50, v125
    v_mul_f32 v78, s50, v126
    v_mul_f32 v79, s50, v127
    v_exp_f32 v72, v72
    v_exp_f32 v73, v73
    v_exp_f32 v74, v74
    v_exp_f32 v75, v75
    v_exp_f32 v76, v76
    v_exp_f32 v77, v77
    v_exp_f32 v78, v78
    v_exp_f32 v79, v79
    v_add_f32 v72, 1.0, v72
    v_add_f32 v73, 1.0, v73
    v_add_f32 v74, 1.0, v74
    v_add_f32 v75, 1.0, v75
    v_add_f32 v76, 1.0, v76
    v_add_f32 v77, 1.0, v77
    v_add_f32 v78, 1.0, v78
    v_add_f32 v79, 1.0, v79
    v_rcp_f32 v72, v72
    v_rcp_f32 v73, v73
    v_rcp_f32 v74, v74
    v_rcp_f32 v75, v75
    v_rcp_f32 v76, v76
    v_rcp_f32 v77, v77
    v_rcp_f32 v78, v78
    v_rcp_f32 v79, v79
    v_mul_f32 v72, v72, v152
    v_mul_f32 v73, v73, v153
    v_mul_f32 v74, v74, v154
    v_mul_f32 v75, v75, v155
    v_mul_f32 v76, v76, v156
    v_mul_f32 v77, v77, v157
    v_mul_f32 v78, v78, v158
    v_mul_f32 v79, v79, v159
    v_cvt_pk_bf16_f32 v84, v72, v73
    v_cvt_pk_bf16_f32 v85, v74, v75
    v_cvt_pk_bf16_f32 v86, v76, v77
    v_cvt_pk_bf16_f32 v87, v78, v79
    s_add_u32 s5, s77, 181248
    buffer_store_dwordx4 v[84:87], v6, s[64:67], s5 offen sc1
    s_waitcnt vmcnt(10)
    v_mov_b32 v1, s15
    v_mov_b32 v2, 0
    s_mov_b64 exec, 1
    buffer_store_dword v1, v2, s[64:67], s81 offen offset:256 sc1
    s_mov_b64 exec, -1
    s_add_u32 s4, s80, 36864
    buffer_load_dwordx4 v[24:27], v6, s[64:67], s4 offen sc1
    s_add_u32 s4, s80, 37888
    buffer_load_dwordx4 v[148:151], v6, s[64:67], s4 offen sc1
    s_add_u32 s4, s80, 45056
    buffer_load_dwordx4 v[152:155], v6, s[64:67], s4 offen sc1
    s_add_u32 s4, s80, 46080
    buffer_load_dwordx4 v[156:159], v6, s[64:67], s4 offen sc1
    s_barrier
    s_waitcnt vmcnt(14)
    s_waitcnt lgkmcnt(14)
    v_mfma_f32_32x32x16_bf16 v[32:47], v[240:243], v[176:179], 0
    ds_read_b64_tr_b16 v[208:209], v12 offset:20480
    ds_read_b64_tr_b16 v[210:211], v12 offset:21504
    v_mul_f32 v64, s50, v96
    v_mul_f32 v65, s50, v97
    v_mul_f32 v66, s50, v98
    v_mul_f32 v67, s50, v99
    s_waitcnt lgkmcnt(14)
    v_mfma_f32_32x32x16_bf16 v[48:63], v[240:243], v[180:183], 0
    ds_read_b64_tr_b16 v[212:213], v13 offset:20480
    ds_read_b64_tr_b16 v[214:215], v13 offset:21504
    v_mul_f32 v68, s50, v100
    v_mul_f32 v69, s50, v101
    v_mul_f32 v70, s50, v102
    v_mul_f32 v71, s50, v103
    s_waitcnt vmcnt(13)
    s_waitcnt lgkmcnt(14)
    v_mfma_f32_32x32x16_bf16 v[32:47], v[244:247], v[184:187], v[32:47]
    ds_read_b64_tr_b16 v[216:217], v12 offset:22528
    ds_read_b64_tr_b16 v[218:219], v12 offset:23552
    v_exp_f32 v64, v64
    v_exp_f32 v65, v65
    v_exp_f32 v66, v66
    v_exp_f32 v67, v67
    s_waitcnt lgkmcnt(14)
    v_mfma_f32_32x32x16_bf16 v[48:63], v[244:247], v[188:191], v[48:63]
    ds_read_b64_tr_b16 v[220:221], v13 offset:22528
    ds_read_b64_tr_b16 v[222:223], v13 offset:23552
    v_exp_f32 v68, v68
    v_exp_f32 v69, v69
    v_exp_f32 v70, v70
    v_exp_f32 v71, v71
    s_add_u32 s4, s80, 57344
    buffer_load_dwordx4 v[240:243], v6, s[64:67], s4 offen sc1
    s_add_u32 s4, s80, 58368
    buffer_load_dwordx4 v[244:247], v6, s[64:67], s4 offen sc1
    s_waitcnt vmcnt(14)
    s_waitcnt lgkmcnt(14)
    v_mfma_f32_32x32x16_bf16 v[32:47], v[248:251], v[192:195], v[32:47]
    ds_read_b64_tr_b16 v[224:225], v12 offset:28672
    ds_read_b64_tr_b16 v[226:227], v12 offset:29696
    v_add_f32 v64, 1.0, v64
    v_add_f32 v65, 1.0, v65
    v_add_f32 v66, 1.0, v66
    v_add_f32 v67, 1.0, v67
    s_waitcnt lgkmcnt(14)
    v_mfma_f32_32x32x16_bf16 v[48:63], v[248:251], v[196:199], v[48:63]
    ds_read_b64_tr_b16 v[228:229], v13 offset:28672
    ds_read_b64_tr_b16 v[230:231], v13 offset:29696
    v_add_f32 v68, 1.0, v68
    v_add_f32 v69, 1.0, v69
    v_add_f32 v70, 1.0, v70
    v_add_f32 v71, 1.0, v71
    s_waitcnt vmcnt(13)
    s_waitcnt lgkmcnt(14)
    v_mfma_f32_32x32x16_bf16 v[32:47], v[252:255], v[200:203], v[32:47]
    ds_read_b64_tr_b16 v[232:233], v12 offset:30720
    ds_read_b64_tr_b16 v[234:235], v12 offset:31744
    v_rcp_f32 v64, v64
    v_rcp_f32 v65, v65
    v_rcp_f32 v66, v66
    v_rcp_f32 v67, v67
    s_waitcnt lgkmcnt(14)
    v_mfma_f32_32x32x16_bf16 v[48:63], v[252:255], v[204:207], v[48:63]
    ds_read_b64_tr_b16 v[236:237], v13 offset:30720
    ds_read_b64_tr_b16 v[238:239], v13 offset:31744
    v_rcp_f32 v68, v68
    v_rcp_f32 v69, v69
    v_rcp_f32 v70, v70
    v_rcp_f32 v71, v71
    s_add_u32 s4, s80, 65536
    buffer_load_dwordx4 v[248:251], v6, s[64:67], s4 offen sc1
    s_add_u32 s4, s80, 66560
    buffer_load_dwordx4 v[252:255], v6, s[64:67], s4 offen sc1
    s_barrier
    s_waitcnt vmcnt(14)
    s_waitcnt lgkmcnt(14)
    v_mfma_f32_32x32x16_bf16 v[32:47], v[160:163], v[208:211], v[32:47]
    ds_read_b64_tr_b16 v[176:177], v12 offset:36864
    ds_read_b64_tr_b16 v[178:179], v12 offset:37888
    v_mul_f32 v64, v64, v128
    v_mul_f32 v65, v65, v129
    v_mul_f32 v66, v66, v130
    v_mul_f32 v67, v67, v131
    s_waitcnt lgkmcnt(14)
    v_mfma_f32_32x32x16_bf16 v[48:63], v[160:163], v[212:215], v[48:63]
    ds_read_b64_tr_b16 v[180:181], v13 offset:36864
    ds_read_b64_tr_b16 v[182:183], v13 offset:37888
    v_mul_f32 v68, v68, v132
    v_mul_f32 v69, v69, v133
    v_mul_f32 v70, v70, v134
    v_mul_f32 v71, v71, v135
    s_waitcnt vmcnt(13)
    s_waitcnt lgkmcnt(14)
    v_mfma_f32_32x32x16_bf16 v[32:47], v[164:167], v[216:219], v[32:47]
    ds_read_b64_tr_b16 v[184:185], v12 offset:38912
    ds_read_b64_tr_b16 v[186:187], v12 offset:39936
    v_cvt_pk_bf16_f32 v80, v64, v65
    v_cvt_pk_bf16_f32 v81, v66, v67
    v_cvt_pk_bf16_f32 v82, v68, v69
    v_cvt_pk_bf16_f32 v83, v70, v71
    s_waitcnt lgkmcnt(14)
    v_mfma_f32_32x32x16_bf16 v[48:63], v[164:167], v[220:223], v[48:63]
    ds_read_b64_tr_b16 v[188:189], v13 offset:38912
    ds_read_b64_tr_b16 v[190:191], v13 offset:39936
    s_add_u32 s5, s77, 0
    buffer_store_dwordx4 v[80:83], v6, s[64:67], s5 offen sc1
    v_mul_f32 v72, s50, v104
    v_mul_f32 v73, s50, v105
    v_mul_f32 v74, s50, v106
    s_add_u32 s4, s80, 73728
    buffer_load_dwordx4 v[160:163], v6, s[64:67], s4 offen sc1
    s_add_u32 s4, s80, 74752
    buffer_load_dwordx4 v[164:167], v6, s[64:67], s4 offen sc1
    s_waitcnt vmcnt(15)
    s_waitcnt lgkmcnt(14)
    v_mfma_f32_32x32x16_bf16 v[32:47], v[168:171], v[224:227], v[32:47]
    ds_read_b64_tr_b16 v[192:193], v12 offset:45056
    ds_read_b64_tr_b16 v[194:195], v12 offset:46080
    v_mul_f32 v75, s50, v107
    v_mul_f32 v76, s50, v108
    v_mul_f32 v77, s50, v109
    v_mul_f32 v78, s50, v110
    s_waitcnt lgkmcnt(14)
    v_mfma_f32_32x32x16_bf16 v[48:63], v[168:171], v[228:231], v[48:63]
    ds_read_b64_tr_b16 v[196:197], v13 offset:45056
    ds_read_b64_tr_b16 v[198:199], v13 offset:46080
    v_mul_f32 v79, s50, v111
    v_exp_f32 v72, v72
    v_exp_f32 v73, v73
    v_exp_f32 v74, v74
    s_waitcnt vmcnt(14)
    s_waitcnt lgkmcnt(14)
    v_mfma_f32_32x32x16_bf16 v[32:47], v[172:175], v[232:235], v[32:47]
    ds_read_b64_tr_b16 v[200:201], v12 offset:47104
    ds_read_b64_tr_b16 v[202:203], v12 offset:48128
    v_exp_f32 v75, v75
    v_exp_f32 v76, v76
    v_exp_f32 v77, v77
    v_exp_f32 v78, v78
    s_waitcnt lgkmcnt(14)
    v_mfma_f32_32x32x16_bf16 v[48:63], v[172:175], v[236:239], v[48:63]
    ds_read_b64_tr_b16 v[204:205], v13 offset:47104
    ds_read_b64_tr_b16 v[206:207], v13 offset:48128
    v_exp_f32 v79, v79
    v_add_f32 v72, 1.0, v72
    v_add_f32 v73, 1.0, v73
    v_add_f32 v74, 1.0, v74
    s_add_u32 s4, s80, 86016
    buffer_load_dwordx4 v[168:171], v6, s[64:67], s4 offen sc1
    s_add_u32 s4, s80, 87040
    buffer_load_dwordx4 v[172:175], v6, s[64:67], s4 offen sc1
    s_barrier
    s_waitcnt vmcnt(12)
    s_waitcnt lgkmcnt(14)
    v_mfma_f32_32x32x16_bf16 v[32:47], v[24:27], v[176:179], v[32:47]
    ds_read_b64_tr_b16 v[208:209], v14 offset:53248
    ds_read_b64_tr_b16 v[210:211], v14 offset:54272
    v_add_f32 v75, 1.0, v75
    v_add_f32 v76, 1.0, v76
    v_add_f32 v77, 1.0, v77
    v_add_f32 v78, 1.0, v78
    s_waitcnt lgkmcnt(14)
    v_mfma_f32_32x32x16_bf16 v[48:63], v[24:27], v[180:183], v[48:63]
    ds_read_b64_tr_b16 v[212:213], v15 offset:53248
    ds_read_b64_tr_b16 v[214:215], v15 offset:54272
    v_add_f32 v79, 1.0, v79
    v_rcp_f32 v72, v72
    v_rcp_f32 v73, v73
    v_rcp_f32 v74, v74
    s_waitcnt vmcnt(11)
    s_waitcnt lgkmcnt(14)
    v_mfma_f32_32x32x16_bf16 v[32:47], v[148:151], v[184:187], v[32:47]
    ds_read_b64_tr_b16 v[216:217], v14 offset:55296
    ds_read_b64_tr_b16 v[218:219], v14 offset:56320
    v_rcp_f32 v75, v75
    v_rcp_f32 v76, v76
    v_rcp_f32 v77, v77
    v_rcp_f32 v78, v78
    s_waitcnt lgkmcnt(14)
    v_mfma_f32_32x32x16_bf16 v[48:63], v[148:151], v[188:191], v[48:63]
    ds_read_b64_tr_b16 v[220:221], v15 offset:55296
    ds_read_b64_tr_b16 v[222:223], v15 offset:56320
    v_rcp_f32 v79, v79
    v_mul_f32 v72, v72, v136
    v_mul_f32 v73, v73, v137
    v_mul_f32 v74, v74, v138
    s_add_u32 s4, s80, 94208
    buffer_load_dwordx4 v[24:27], v6, s[64:67], s4 offen sc1
    s_add_u32 s4, s80, 95232
    buffer_load_dwordx4 v[148:151], v6, s[64:67], s4 offen sc1
    s_waitcnt vmcnt(12)
    s_waitcnt lgkmcnt(14)
    v_mfma_f32_32x32x16_bf16 v[32:47], v[152:155], v[192:195], v[32:47]
    ds_read_b64_tr_b16 v[224:225], v16 offset:20480
    ds_read_b64_tr_b16 v[226:227], v16 offset:21504
    v_mul_f32 v75, v75, v139
    v_mul_f32 v76, v76, v140
    v_mul_f32 v77, v77, v141
    v_mul_f32 v78, v78, v142
    s_waitcnt lgkmcnt(14)
    v_mfma_f32_32x32x16_bf16 v[48:63], v[152:155], v[196:199], v[48:63]
    ds_read_b64_tr_b16 v[228:229], v17 offset:20480
    ds_read_b64_tr_b16 v[230:231], v17 offset:21504
    v_mul_f32 v79, v79, v143
    v_cvt_pk_bf16_f32 v84, v72, v73
    v_cvt_pk_bf16_f32 v85, v74, v75
    v_cvt_pk_bf16_f32 v86, v76, v77
    s_waitcnt vmcnt(11)
    s_waitcnt lgkmcnt(14)
    v_mfma_f32_32x32x16_bf16 v[32:47], v[156:159], v[200:203], v[32:47]
    ds_read_b64_tr_b16 v[232:233], v16 offset:22528
    ds_read_b64_tr_b16 v[234:235], v16 offset:23552
    v_cvt_pk_bf16_f32 v87, v78, v79
    s_add_u32 s5, s77, 1024
    buffer_store_dwordx4 v[84:87], v6, s[64:67], s5 offen sc1
    s_waitcnt lgkmcnt(14)
    v_mfma_f32_32x32x16_bf16 v[48:63], v[156:159], v[204:207], v[48:63]
    ds_read_b64_tr_b16 v[236:237], v17 offset:22528
    ds_read_b64_tr_b16 v[238:239], v17 offset:23552
    s_add_u32 s4, s80, 102400
    buffer_load_dwordx4 v[152:155], v6, s[64:67], s4 offen sc1
    s_add_u32 s4, s80, 103424
    buffer_load_dwordx4 v[156:159], v6, s[64:67], s4 offen sc1
    s_barrier
    s_waitcnt vmcnt(13)
    s_waitcnt lgkmcnt(14)
    v_mfma_f32_32x32x16_bf16 v[32:47], v[240:243], v[208:211], v[32:47]
    ds_read_b64_tr_b16 v[176:177], v14 offset:28672
    ds_read_b64_tr_b16 v[178:179], v14 offset:29696
    s_waitcnt lgkmcnt(14)
    v_mfma_f32_32x32x16_bf16 v[48:63], v[240:243], v[212:215], v[48:63]
    ds_read_b64_tr_b16 v[180:181], v15 offset:28672
    ds_read_b64_tr_b16 v[182:183], v15 offset:29696
    s_waitcnt vmcnt(12)
    s_waitcnt lgkmcnt(14)
    v_mfma_f32_32x32x16_bf16 v[32:47], v[244:247], v[216:219], v[32:47]
    ds_read_b64_tr_b16 v[184:185], v14 offset:30720
    ds_read_b64_tr_b16 v[186:187], v14 offset:31744
    s_waitcnt lgkmcnt(14)
    v_mfma_f32_32x32x16_bf16 v[48:63], v[244:247], v[220:223], v[48:63]
    ds_read_b64_tr_b16 v[188:189], v15 offset:30720
    ds_read_b64_tr_b16 v[190:191], v15 offset:31744
    s_add_u32 s4, s80, 114688
    buffer_load_dwordx4 v[240:243], v6, s[64:67], s4 offen sc1
    s_add_u32 s4, s80, 115712
    buffer_load_dwordx4 v[244:247], v6, s[64:67], s4 offen sc1
    s_waitcnt vmcnt(13)
    s_waitcnt lgkmcnt(14)
    v_mfma_f32_32x32x16_bf16 v[32:47], v[248:251], v[224:227], v[32:47]
    ds_read_b64_tr_b16 v[192:193], v14 offset:36864
    ds_read_b64_tr_b16 v[194:195], v14 offset:37888
    s_waitcnt lgkmcnt(14)
    v_mfma_f32_32x32x16_bf16 v[48:63], v[248:251], v[228:231], v[48:63]
    ds_read_b64_tr_b16 v[196:197], v15 offset:36864
    ds_read_b64_tr_b16 v[198:199], v15 offset:37888
    s_waitcnt vmcnt(12)
    s_waitcnt lgkmcnt(14)
    v_mfma_f32_32x32x16_bf16 v[32:47], v[252:255], v[232:235], v[32:47]
    ds_read_b64_tr_b16 v[200:201], v14 offset:38912
    ds_read_b64_tr_b16 v[202:203], v14 offset:39936
    s_waitcnt lgkmcnt(14)
    v_mfma_f32_32x32x16_bf16 v[48:63], v[252:255], v[236:239], v[48:63]
    ds_read_b64_tr_b16 v[204:205], v15 offset:38912
    ds_read_b64_tr_b16 v[206:207], v15 offset:39936
    s_add_u32 s4, s80, 118784
    buffer_load_dwordx4 v[248:251], v6, s[64:67], s4 offen sc1
    s_add_u32 s4, s80, 119808
    buffer_load_dwordx4 v[252:255], v6, s[64:67], s4 offen sc1
    s_waitcnt vmcnt(6)
    v_mov_b32 v1, s15
    v_mov_b32 v2, 0
    s_mov_b64 exec, 1
    buffer_store_dword v1, v2, s[64:67], s81 offen offset:512 sc1
    s_mov_b64 exec, -1
    s_barrier
    s_waitcnt lgkmcnt(14)
    v_mfma_f32_32x32x16_bf16 v[32:47], v[160:163], v[176:179], v[32:47]
    ds_read_b64_tr_b16 v[208:209], v16 offset:4096
    ds_read_b64_tr_b16 v[210:211], v16 offset:5120
    s_waitcnt lgkmcnt(14)
    v_mfma_f32_32x32x16_bf16 v[48:63], v[160:163], v[180:183], v[48:63]
    ds_read_b64_tr_b16 v[212:213], v17 offset:4096
    ds_read_b64_tr_b16 v[214:215], v17 offset:5120
    s_waitcnt lgkmcnt(14)
    v_mfma_f32_32x32x16_bf16 v[32:47], v[164:167], v[184:187], v[32:47]
    ds_read_b64_tr_b16 v[216:217], v16 offset:6144
    ds_read_b64_tr_b16 v[218:219], v16 offset:7168
    s_waitcnt lgkmcnt(14)
    v_mfma_f32_32x32x16_bf16 v[48:63], v[164:167], v[188:191], v[48:63]
    ds_read_b64_tr_b16 v[220:221], v17 offset:6144
    ds_read_b64_tr_b16 v[222:223], v17 offset:7168
    s_add_u32 s4, s80, 122880
    buffer_load_dwordx4 v[160:163], v6, s[64:67], s4 offen sc1
    s_add_u32 s4, s80, 123904
    buffer_load_dwordx4 v[164:167], v6, s[64:67], s4 offen sc1
    s_waitcnt lgkmcnt(14)
    v_mfma_f32_32x32x16_bf16 v[32:47], v[168:171], v[192:195], v[32:47]
    ds_read_b64_tr_b16 v[224:225], v16 offset:28672
    ds_read_b64_tr_b16 v[226:227], v16 offset:29696
    s_waitcnt lgkmcnt(14)
    v_mfma_f32_32x32x16_bf16 v[48:63], v[168:171], v[196:199], v[48:63]
    ds_read_b64_tr_b16 v[228:229], v17 offset:28672
    ds_read_b64_tr_b16 v[230:231], v17 offset:29696
    s_waitcnt lgkmcnt(14)
    v_mfma_f32_32x32x16_bf16 v[32:47], v[172:175], v[200:203], v[32:47]
    ds_read_b64_tr_b16 v[232:233], v16 offset:30720
    ds_read_b64_tr_b16 v[234:235], v16 offset:31744
    s_waitcnt lgkmcnt(14)
    v_mfma_f32_32x32x16_bf16 v[48:63], v[172:175], v[204:207], v[48:63]
    ds_read_b64_tr_b16 v[236:237], v17 offset:30720
    ds_read_b64_tr_b16 v[238:239], v17 offset:31744
    s_add_u32 s4, s80, 126976
    buffer_load_dwordx4 v[168:171], v6, s[64:67], s4 offen sc1
    s_add_u32 s4, s80, 128000
    buffer_load_dwordx4 v[172:175], v6, s[64:67], s4 offen sc1
    s_mov_b32 s4, 0
    buffer_load_ushort v96, v4, s[52:55], s4 offen
    s_mov_b32 s4, 1024
    buffer_load_ushort v97, v4, s[52:55], s4 offen
    s_mov_b32 s4, 2048
    buffer_load_ushort v98, v4, s[52:55], s4 offen
    s_barrier
    s_waitcnt lgkmcnt(14)
    v_mfma_f32_32x32x16_bf16 v[32:47], v[24:27], v[208:211], v[32:47]
    ds_read_b128 v[176:179], v18 offset:53248
    ds_read_b128 v[180:183], v18 offset:57344
    s_waitcnt lgkmcnt(14)
    v_mfma_f32_32x32x16_bf16 v[48:63], v[24:27], v[212:215], v[48:63]
    ds_read_b128 v[184:187], v19 offset:53248
    ds_read_b128 v[188:191], v19 offset:57344
    s_waitcnt lgkmcnt(14)
    v_mfma_f32_32x32x16_bf16 v[32:47], v[148:151], v[216:219], v[32:47]
    ds_read_b128 v[192:195], v20 offset:4096
    ds_read_b128 v[196:199], v20 offset:8192
    s_waitcnt lgkmcnt(14)
    v_mfma_f32_32x32x16_bf16 v[48:63], v[148:151], v[220:223], v[48:63]
    ds_read_b128 v[200:203], v21 offset:4096
    ds_read_b128 v[204:207], v21 offset:8192
    s_add_u32 s4, s80, 131072
    buffer_load_dwordx4 v[24:27], v6, s[64:67], s4 offen sc1
    s_add_u32 s4, s80, 132096
    buffer_load_dwordx4 v[148:151], v6, s[64:67], s4 offen sc1
    s_waitcnt vmcnt(15)
    s_waitcnt lgkmcnt(14)
    v_mfma_f32_32x32x16_bf16 v[32:47], v[152:155], v[224:227], v[32:47]
    s_waitcnt lgkmcnt(12)
    v_mfma_f32_32x32x16_bf16 v[48:63], v[152:155], v[228:231], v[48:63]
    s_waitcnt vmcnt(14)
    s_waitcnt lgkmcnt(10)
    v_mfma_f32_32x32x16_bf16 v[32:47], v[156:159], v[232:235], v[32:47]
    s_waitcnt lgkmcnt(8)
    v_mfma_f32_32x32x16_bf16 v[48:63], v[156:159], v[236:239], v[48:63]
    s_add_u32 s4, s80, 135168
    buffer_load_dwordx4 v[152:155], v6, s[64:67], s4 offen sc1
    s_add_u32 s4, s80, 136192
    buffer_load_dwordx4 v[156:159], v6, s[64:67], s4 offen sc1
    s_mov_b32 s4, 3072
    buffer_load_ushort v99, v4, s[52:55], s4 offen
    s_mov_b32 s4, 8192
    buffer_load_ushort v100, v4, s[52:55], s4 offen
    s_mov_b32 s4, 9216
    buffer_load_ushort v101, v4, s[52:55], s4 offen
    s_barrier
    s_waitcnt vmcnt(18)
    s_waitcnt lgkmcnt(7)
    v_mfma_f32_32x32x16_bf16 v[64:79], v[240:243], v[176:179], 0
    ds_read_b128 v[208:211], v20 offset:45056
    ds_read_b128 v[212:215], v20 offset:49152
    s_waitcnt lgkmcnt(8)
    v_mfma_f32_32x32x16_bf16 v[80:95], v[240:243], v[180:183], 0
    ds_read_b128 v[216:219], v21 offset:45056
    ds_read_b128 v[220:223], v21 offset:49152
    s_waitcnt vmcnt(17)
    s_waitcnt lgkmcnt(9)
    v_mfma_f32_32x32x16_bf16 v[64:79], v[244:247], v[184:187], v[64:79]
    ds_read_b128 v[224:227], v22 offset:12288
    ds_read_b128 v[228:231], v22 offset:16384
    s_waitcnt lgkmcnt(10)
    v_mfma_f32_32x32x16_bf16 v[80:95], v[244:247], v[188:191], v[80:95]
    ds_read_b128 v[232:235], v23 offset:12288
    ds_read_b128 v[236:239], v23 offset:16384
    s_add_u32 s4, s80, 139264
    buffer_load_dwordx4 v[240:243], v6, s[64:67], s4 offen sc1
    s_add_u32 s4, s80, 140288
    buffer_load_dwordx4 v[244:247], v6, s[64:67], s4 offen sc1
    s_waitcnt vmcnt(18)
    s_waitcnt lgkmcnt(11)
    v_mfma_f32_32x32x16_bf16 v[64:79], v[248:251], v[192:195], v[64:79]
    s_waitcnt lgkmcnt(10)
    v_mfma_f32_32x32x16_bf16 v[80:95], v[248:251], v[196:199], v[80:95]
    s_waitcnt vmcnt(17)
    s_waitcnt lgkmcnt(9)
    v_mfma_f32_32x32x16_bf16 v[64:79], v[252:255], v[200:203], v[64:79]
    s_waitcnt lgkmcnt(8)
    v_mfma_f32_32x32x16_bf16 v[80:95], v[252:255], v[204:207], v[80:95]
    s_add_u32 s4, s80, 143360
    buffer_load_dwordx4 v[248:251], v6, s[64:67], s4 offen sc1
    s_add_u32 s4, s80, 144384
    buffer_load_dwordx4 v[252:255], v6, s[64:67], s4 offen sc1
    s_mov_b32 s4, 10240
    buffer_load_ushort v102, v4, s[52:55], s4 offen
    s_mov_b32 s4, 11264
    buffer_load_ushort v103, v4, s[52:55], s4 offen
    s_mov_b32 s4, 16384
    buffer_load_ushort v104, v4, s[52:55], s4 offen
    s_barrier
    s_waitcnt vmcnt(20)
    s_waitcnt lgkmcnt(7)
    v_mfma_f32_32x32x16_bf16 v[64:79], v[160:163], v[208:211], v[64:79]
    ds_read_b128 v[176:179], v20 offset:12288
    ds_read_b128 v[180:183], v20 offset:16384
    s_waitcnt lgkmcnt(8)
    v_mfma_f32_32x32x16_bf16 v[80:95], v[160:163], v[212:215], v[80:95]
    ds_read_b128 v[184:187], v21 offset:12288
    ds_read_b128 v[188:191], v21 offset:16384
    s_waitcnt vmcnt(19)
    s_waitcnt lgkmcnt(9)
    v_mfma_f32_32x32x16_bf16 v[64:79], v[164:167], v[216:219], v[64:79]
    ds_read_b128 v[192:195], v20 offset:20480
    ds_read_b128 v[196:199], v20 offset:24576
    s_waitcnt lgkmcnt(10)
    v_mfma_f32_32x32x16_bf16 v[80:95], v[164:167], v[220:223], v[80:95]
    ds_read_b128 v[200:203], v21 offset:20480
    ds_read_b128 v[204:207], v21 offset:24576
    s_add_u32 s4, s80, 147456
    buffer_load_dwordx4 v[160:163], v6, s[64:67], s4 offen sc1
    s_add_u32 s4, s80, 148480
    buffer_load_dwordx4 v[164:167], v6, s[64:67], s4 offen sc1
    s_waitcnt vmcnt(20)
    s_waitcnt lgkmcnt(11)
    v_mfma_f32_32x32x16_bf16 v[64:79], v[168:171], v[224:227], v[64:79]
    s_waitcnt lgkmcnt(10)
    v_mfma_f32_32x32x16_bf16 v[80:95], v[168:171], v[228:231], v[80:95]
    s_waitcnt vmcnt(19)
    s_waitcnt lgkmcnt(9)
    v_mfma_f32_32x32x16_bf16 v[64:79], v[172:175], v[232:235], v[64:79]
    s_waitcnt lgkmcnt(8)
    v_mfma_f32_32x32x16_bf16 v[80:95], v[172:175], v[236:239], v[80:95]
    s_add_u32 s4, s80, 151552
    buffer_load_dwordx4 v[168:171], v6, s[64:67], s4 offen sc1
    s_add_u32 s4, s80, 152576
    buffer_load_dwordx4 v[172:175], v6, s[64:67], s4 offen sc1
    s_mov_b32 s4, 17408
    buffer_load_ushort v105, v4, s[52:55], s4 offen
    s_mov_b32 s4, 18432
    buffer_load_ushort v106, v4, s[52:55], s4 offen
    s_mov_b32 s4, 19456
    buffer_load_ushort v107, v4, s[52:55], s4 offen
    s_barrier
    s_waitcnt vmcnt(20)
    s_waitcnt lgkmcnt(7)
    v_mfma_f32_32x32x16_bf16 v[64:79], v[24:27], v[176:179], v[64:79]
    ds_read_b128 v[208:211], v18 offset:4096
    ds_read_b128 v[212:215], v18 offset:8192
    s_waitcnt lgkmcnt(8)
    v_mfma_f32_32x32x16_bf16 v[80:95], v[24:27], v[180:183], v[80:95]
    ds_read_b128 v[216:219], v19 offset:4096
    ds_read_b128 v[220:223], v19 offset:8192
    s_waitcnt vmcnt(19)
    s_waitcnt lgkmcnt(9)
    v_mfma_f32_32x32x16_bf16 v[64:79], v[148:151], v[184:187], v[64:79]
    ds_read_b128 v[224:227], v18 offset:12288
    ds_read_b128 v[228:231], v18 offset:16384
    s_waitcnt lgkmcnt(10)
    v_mfma_f32_32x32x16_bf16 v[80:95], v[148:151], v[188:191], v[80:95]
    ds_read_b128 v[232:235], v19 offset:12288
    ds_read_b128 v[236:239], v19 offset:16384
    s_add_u32 s4, s80, 155648
    buffer_load_dwordx4 v[24:27], v6, s[64:67], s4 offen sc1
    s_add_u32 s4, s80, 156672
    buffer_load_dwordx4 v[148:151], v6, s[64:67], s4 offen sc1
    s_waitcnt vmcnt(20)
    s_waitcnt lgkmcnt(11)
    v_mfma_f32_32x32x16_bf16 v[64:79], v[152:155], v[192:195], v[64:79]
    s_waitcnt lgkmcnt(10)
    v_mfma_f32_32x32x16_bf16 v[80:95], v[152:155], v[196:199], v[80:95]
    s_waitcnt vmcnt(19)
    s_waitcnt lgkmcnt(9)
    v_mfma_f32_32x32x16_bf16 v[64:79], v[156:159], v[200:203], v[64:79]
    s_waitcnt lgkmcnt(8)
    v_mfma_f32_32x32x16_bf16 v[80:95], v[156:159], v[204:207], v[80:95]
    s_add_u32 s4, s80, 159744
    buffer_load_dwordx4 v[152:155], v6, s[64:67], s4 offen sc1
    s_add_u32 s4, s80, 160768
    buffer_load_dwordx4 v[156:159], v6, s[64:67], s4 offen sc1
    s_mov_b32 s4, 24576
    buffer_load_ushort v108, v4, s[52:55], s4 offen
    s_mov_b32 s4, 25600
    buffer_load_ushort v109, v4, s[52:55], s4 offen
    s_mov_b32 s4, 26624
    buffer_load_ushort v110, v4, s[52:55], s4 offen
    s_barrier
    s_waitcnt vmcnt(20)
    s_waitcnt lgkmcnt(7)
    v_mfma_f32_32x32x16_bf16 v[64:79], v[240:243], v[208:211], v[64:79]
    ds_read_b128 v[176:179], v18 offset:20480
    ds_read_b128 v[180:183], v18 offset:24576
    s_waitcnt lgkmcnt(8)
    v_mfma_f32_32x32x16_bf16 v[80:95], v[240:243], v[212:215], v[80:95]
    ds_read_b128 v[184:187], v19 offset:20480
    ds_read_b128 v[188:191], v19 offset:24576
    s_waitcnt vmcnt(19)
    s_waitcnt lgkmcnt(9)
    v_mfma_f32_32x32x16_bf16 v[64:79], v[244:247], v[216:219], v[64:79]
    ds_read_b128 v[192:195], v18 offset:28672
    ds_read_b128 v[196:199], v18 offset:32768
    s_waitcnt lgkmcnt(10)
    v_mfma_f32_32x32x16_bf16 v[80:95], v[244:247], v[220:223], v[80:95]
    ds_read_b128 v[200:203], v19 offset:28672
    ds_read_b128 v[204:207], v19 offset:32768
    s_add_u32 s4, s80, 163840
    buffer_load_dwordx4 v[240:243], v6, s[64:67], s4 offen sc1
    s_add_u32 s4, s80, 164864
    buffer_load_dwordx4 v[244:247], v6, s[64:67], s4 offen sc1
    s_waitcnt vmcnt(20)
    s_waitcnt lgkmcnt(11)
    v_mfma_f32_32x32x16_bf16 v[64:79], v[248:251], v[224:227], v[64:79]
    s_waitcnt lgkmcnt(10)
    v_mfma_f32_32x32x16_bf16 v[80:95], v[248:251], v[228:231], v[80:95]
    s_waitcnt vmcnt(19)
    s_waitcnt lgkmcnt(9)
    v_mfma_f32_32x32x16_bf16 v[64:79], v[252:255], v[232:235], v[64:79]
    s_waitcnt lgkmcnt(8)
    v_mfma_f32_32x32x16_bf16 v[80:95], v[252:255], v[236:239], v[80:95]
    s_add_u32 s4, s80, 167936
    buffer_load_dwordx4 v[248:251], v6, s[64:67], s4 offen sc1
    s_add_u32 s4, s80, 168960
    buffer_load_dwordx4 v[252:255], v6, s[64:67], s4 offen sc1
    s_mov_b32 s4, 27648
    buffer_load_ushort v111, v4, s[52:55], s4 offen
    buffer_load_dwordx4 v[112:115], v10, s[64:67], 0 offen offset:0 sc1
    buffer_load_dwordx4 v[116:119], v10, s[64:67], 0 offen offset:32 sc1
    s_barrier
    s_waitcnt vmcnt(20)
    s_waitcnt lgkmcnt(7)
    v_mfma_f32_32x32x16_bf16 v[64:79], v[160:163], v[176:179], v[64:79]
    ds_read_b128 v[208:211], v18 offset:36864
    ds_read_b128 v[212:215], v18 offset:40960
    s_waitcnt lgkmcnt(8)
    v_mfma_f32_32x32x16_bf16 v[80:95], v[160:163], v[180:183], v[80:95]
    ds_read_b128 v[216:219], v19 offset:36864
    ds_read_b128 v[220:223], v19 offset:40960
    s_waitcnt vmcnt(19)
    s_waitcnt lgkmcnt(9)
    v_mfma_f32_32x32x16_bf16 v[64:79], v[164:167], v[184:187], v[64:79]
    ds_read_b128 v[224:227], v18 offset:45056
    ds_read_b128 v[228:231], v18 offset:49152
    s_waitcnt lgkmcnt(10)
    v_mfma_f32_32x32x16_bf16 v[80:95], v[164:167], v[188:191], v[80:95]
    ds_read_b128 v[232:235], v19 offset:45056
    ds_read_b128 v[236:239], v19 offset:49152
    s_add_u32 s4, s80, 172032
    buffer_load_dwordx4 v[160:163], v6, s[64:67], s4 offen sc1
    s_add_u32 s4, s80, 173056
    buffer_load_dwordx4 v[164:167], v6, s[64:67], s4 offen sc1
    s_waitcnt vmcnt(20)
    s_waitcnt lgkmcnt(11)
    v_mfma_f32_32x32x16_bf16 v[64:79], v[168:171], v[192:195], v[64:79]
    s_waitcnt lgkmcnt(10)
    v_mfma_f32_32x32x16_bf16 v[80:95], v[168:171], v[196:199], v[80:95]
    s_waitcnt vmcnt(19)
    s_waitcnt lgkmcnt(9)
    v_mfma_f32_32x32x16_bf16 v[64:79], v[172:175], v[200:203], v[64:79]
    s_waitcnt lgkmcnt(8)
    v_mfma_f32_32x32x16_bf16 v[80:95], v[172:175], v[204:207], v[80:95]
    s_add_u32 s4, s80, 176128
    buffer_load_dwordx4 v[168:171], v6, s[64:67], s4 offen sc1
    s_add_u32 s4, s80, 177152
    buffer_load_dwordx4 v[172:175], v6, s[64:67], s4 offen sc1
    buffer_load_dwordx4 v[120:123], v10, s[64:67], 0 offen offset:64 sc1
    buffer_load_dwordx4 v[124:127], v10, s[64:67], 0 offen offset:96 sc1
    buffer_load_ushort v128, v3, s[56:59], 0 offen
    s_barrier
    s_waitcnt vmcnt(20)
    s_waitcnt lgkmcnt(7)
    v_mfma_f32_32x32x16_bf16 v[64:79], v[24:27], v[208:211], v[64:79]
    ds_read_b128 v[176:179], v20 offset:53248
    ds_read_b128 v[180:183], v20 offset:57344
    s_waitcnt lgkmcnt(8)
    v_mfma_f32_32x32x16_bf16 v[80:95], v[24:27], v[212:215], v[80:95]
    ds_read_b128 v[184:187], v21 offset:53248
    ds_read_b128 v[188:191], v21 offset:57344
    s_waitcnt vmcnt(19)
    s_waitcnt lgkmcnt(9)
    v_mfma_f32_32x32x16_bf16 v[64:79], v[148:151], v[216:219], v[64:79]
    ds_read_b128 v[192:195], v22 offset:20480
    ds_read_b128 v[196:199], v22 offset:24576
    s_waitcnt lgkmcnt(10)
    v_mfma_f32_32x32x16_bf16 v[80:95], v[148:151], v[220:223], v[80:95]
    ds_read_b128 v[200:203], v23 offset:20480
    ds_read_b128 v[204:207], v23 offset:24576
    s_add_u32 s4, s80, 4096
    buffer_load_dwordx4 v[24:27], v6, s[64:67], s4 offen sc1
    s_add_u32 s4, s80, 5120
    buffer_load_dwordx4 v[148:151], v6, s[64:67], s4 offen sc1
    s_waitcnt vmcnt(20)
    s_waitcnt lgkmcnt(11)
    v_mfma_f32_32x32x16_bf16 v[64:79], v[152:155], v[224:227], v[64:79]
    s_waitcnt lgkmcnt(10)
    v_mfma_f32_32x32x16_bf16 v[80:95], v[152:155], v[228:231], v[80:95]
    s_waitcnt vmcnt(19)
    s_waitcnt lgkmcnt(9)
    v_mfma_f32_32x32x16_bf16 v[64:79], v[156:159], v[232:235], v[64:79]
    s_waitcnt lgkmcnt(8)
    v_mfma_f32_32x32x16_bf16 v[80:95], v[156:159], v[236:239], v[80:95]
    s_add_u32 s4, s80, 12288
    buffer_load_dwordx4 v[152:155], v6, s[64:67], s4 offen sc1
    s_add_u32 s4, s80, 13312
    buffer_load_dwordx4 v[156:159], v6, s[64:67], s4 offen sc1
    s_barrier
    s_waitcnt vmcnt(17)
    s_waitcnt lgkmcnt(7)
    v_mfma_f32_32x32x16_bf16 v[64:79], v[240:243], v[176:179], v[64:79]
    ds_read_b128 v[208:211], v20 offset:28672
    ds_read_b128 v[212:215], v20 offset:32768
    s_waitcnt lgkmcnt(8)
    v_mfma_f32_32x32x16_bf16 v[80:95], v[240:243], v[180:183], v[80:95]
    ds_read_b128 v[216:219], v21 offset:28672
    ds_read_b128 v[220:223], v21 offset:32768
    s_waitcnt vmcnt(16)
    s_waitcnt lgkmcnt(9)
    v_mfma_f32_32x32x16_bf16 v[64:79], v[244:247], v[184:187], v[64:79]
    ds_read_b128 v[224:227], v20 offset:36864
    ds_read_b128 v[228:231], v20 offset:40960
    s_waitcnt lgkmcnt(10)
    v_mfma_f32_32x32x16_bf16 v[80:95], v[244:247], v[188:191], v[80:95]
    ds_read_b128 v[232:235], v21 offset:36864
    ds_read_b128 v[236:239], v21 offset:40960
    s_add_u32 s4, s80, 20480
    buffer_load_dwordx4 v[240:243], v6, s[64:67], s4 offen sc1
    s_add_u32 s4, s80, 21504
    buffer_load_dwordx4 v[244:247], v6, s[64:67], s4 offen sc1
    s_waitcnt vmcnt(17)
    s_waitcnt lgkmcnt(11)
    v_mfma_f32_32x32x16_bf16 v[64:79], v[248:251], v[192:195], v[64:79]
    s_waitcnt lgkmcnt(10)
    v_mfma_f32_32x32x16_bf16 v[80:95], v[248:251], v[196:199], v[80:95]
    s_waitcnt vmcnt(16)
    s_waitcnt lgkmcnt(9)
    v_mfma_f32_32x32x16_bf16 v[64:79], v[252:255], v[200:203], v[64:79]
    s_waitcnt lgkmcnt(8)
    v_mfma_f32_32x32x16_bf16 v[80:95], v[252:255], v[204:207], v[80:95]
    s_add_u32 s4, s80, 24576
    buffer_load_dwordx4 v[248:251], v6, s[64:67], s4 offen sc1
    s_add_u32 s4, s80, 25600
    buffer_load_dwordx4 v[252:255], v6, s[64:67], s4 offen sc1
    s_barrier
    s_waitcnt vmcnt(14)
    s_waitcnt lgkmcnt(7)
    v_mfma_f32_32x32x16_bf16 v[64:79], v[160:163], v[208:211], v[64:79]
    ds_read_b64_tr_b16 v[176:177], v16 offset:4096
    ds_read_b64_tr_b16 v[178:179], v16 offset:5120
    s_waitcnt lgkmcnt(8)
    v_mfma_f32_32x32x16_bf16 v[80:95], v[160:163], v[212:215], v[80:95]
    ds_read_b64_tr_b16 v[180:181], v17 offset:4096
    ds_read_b64_tr_b16 v[182:183], v17 offset:5120
    s_waitcnt vmcnt(13)
    s_waitcnt lgkmcnt(9)
    v_mfma_f32_32x32x16_bf16 v[64:79], v[164:167], v[216:219], v[64:79]
    ds_read_b64_tr_b16 v[184:185], v16 offset:6144
    ds_read_b64_tr_b16 v[186:187], v16 offset:7168
    s_waitcnt lgkmcnt(10)
    v_mfma_f32_32x32x16_bf16 v[80:95], v[164:167], v[220:223], v[80:95]
    ds_read_b64_tr_b16 v[188:189], v17 offset:6144
    ds_read_b64_tr_b16 v[190:191], v17 offset:7168
    s_add_u32 s4, s80, 32768
    buffer_load_dwordx4 v[160:163], v6, s[64:67], s4 offen sc1
    s_add_u32 s4, s80, 33792
    buffer_load_dwordx4 v[164:167], v6, s[64:67], s4 offen sc1
    s_waitcnt vmcnt(14)
    s_waitcnt lgkmcnt(11)
    v_mfma_f32_32x32x16_bf16 v[64:79], v[168:171], v[224:227], v[64:79]
    ds_read_b64_tr_b16 v[192:193], v16 offset:28672
    ds_read_b64_tr_b16 v[194:195], v16 offset:29696
    s_waitcnt lgkmcnt(12)
    v_mfma_f32_32x32x16_bf16 v[80:95], v[168:171], v[228:231], v[80:95]
    ds_read_b64_tr_b16 v[196:197], v17 offset:28672
    ds_read_b64_tr_b16 v[198:199], v17 offset:29696
    s_waitcnt vmcnt(13)
    s_waitcnt lgkmcnt(13)
    v_mfma_f32_32x32x16_bf16 v[64:79], v[172:175], v[232:235], v[64:79]
    ds_read_b64_tr_b16 v[200:201], v16 offset:30720
    ds_read_b64_tr_b16 v[202:203], v16 offset:31744
    s_waitcnt lgkmcnt(14)
    v_mfma_f32_32x32x16_bf16 v[80:95], v[172:175], v[236:239], v[80:95]
    ds_read_b64_tr_b16 v[204:205], v17 offset:30720
    ds_read_b64_tr_b16 v[206:207], v17 offset:31744
    s_add_u32 s4, s80, 40960
    buffer_load_dwordx4 v[168:171], v6, s[64:67], s4 offen sc1
    s_add_u32 s4, s80, 41984
    buffer_load_dwordx4 v[172:175], v6, s[64:67], s4 offen sc1
    s_waitcnt vmcnt(12)
    v_lshlrev_b32 v128, 16, v128
    s_mov_b32 s12, 0xffff0000
    v_lshlrev_b32 v96, 16, v96
    v_mul_f32 v96, v96, v128
    v_sub_f32 v132, 1.0, v112
    v_lshlrev_b32 v97, 16, v97
    v_mul_f32 v97, v97, v128
    v_sub_f32 v133, 1.0, v113
    v_cvt_pk_bf16_f32 v129, v96, v97
    v_cvt_pk_bf16_f32 v130, v132, v133
    v_lshlrev_b32 v96, 16, v129
    v_and_b32 v97, s12, v129
    v_lshlrev_b32 v132, 16, v130
    v_and_b32 v133, s12, v130
    s_barrier
    s_waitcnt vmcnt(11)
    s_waitcnt lgkmcnt(14)
    v_mfma_f32_32x32x16_bf16 v[32:47], v[24:27], v[176:179], v[32:47]
    ds_read_b64_tr_b16 v[208:209], v12 offset:53248
    ds_read_b64_tr_b16 v[210:211], v12 offset:54272
    s_waitcnt lgkmcnt(14)
    v_mfma_f32_32x32x16_bf16 v[48:63], v[24:27], v[180:183], v[48:63]
    ds_read_b64_tr_b16 v[212:213], v13 offset:53248
    ds_read_b64_tr_b16 v[214:215], v13 offset:54272
    s_waitcnt vmcnt(10)
    s_waitcnt lgkmcnt(14)
    v_mfma_f32_32x32x16_bf16 v[32:47], v[148:151], v[184:187], v[32:47]
    ds_read_b64_tr_b16 v[216:217], v12 offset:55296
    ds_read_b64_tr_b16 v[218:219], v12 offset:56320
    s_waitcnt lgkmcnt(14)
    v_mfma_f32_32x32x16_bf16 v[48:63], v[148:151], v[188:191], v[48:63]
    ds_read_b64_tr_b16 v[220:221], v13 offset:55296
    ds_read_b64_tr_b16 v[222:223], v13 offset:56320
    s_add_u32 s4, s80, 49152
    buffer_load_dwordx4 v[24:27], v6, s[64:67], s4 offen sc1
    s_add_u32 s4, s80, 50176
    buffer_load_dwordx4 v[148:151], v6, s[64:67], s4 offen sc1
    s_waitcnt vmcnt(11)
    s_waitcnt lgkmcnt(14)
    v_mfma_f32_32x32x16_bf16 v[32:47], v[152:155], v[192:195], v[32:47]
    ds_read_b64_tr_b16 v[224:225], v14 offset:4096
    ds_read_b64_tr_b16 v[226:227], v14 offset:5120
    s_waitcnt lgkmcnt(14)
    v_mfma_f32_32x32x16_bf16 v[48:63], v[152:155], v[196:199], v[48:63]
    ds_read_b64_tr_b16 v[228:229], v15 offset:4096
    ds_read_b64_tr_b16 v[230:231], v15 offset:5120
    s_waitcnt vmcnt(10)
    s_waitcnt lgkmcnt(14)
    v_mfma_f32_32x32x16_bf16 v[32:47], v[156:159], v[200:203], v[32:47]
    ds_read_b64_tr_b16 v[232:233], v14 offset:6144
    ds_read_b64_tr_b16 v[234:235], v14 offset:7168
    s_waitcnt lgkmcnt(14)
    v_mfma_f32_32x32x16_bf16 v[48:63], v[156:159], v[204:207], v[48:63]
    ds_read_b64_tr_b16 v[236:237], v15 offset:6144
    ds_read_b64_tr_b16 v[238:239], v15 offset:7168
    s_add_u32 s4, s80, 53248
    buffer_load_dwordx4 v[152:155], v6, s[64:67], s4 offen sc1
    s_add_u32 s4, s80, 54272
    buffer_load_dwordx4 v[156:159], v6, s[64:67], s4 offen sc1
    v_lshlrev_b32 v98, 16, v98
    v_mul_f32 v98, v98, v128
    v_sub_f32 v134, 1.0, v114
    v_lshlrev_b32 v99, 16, v99
    v_mul_f32 v99, v99, v128
    v_sub_f32 v135, 1.0, v115
    v_cvt_pk_bf16_f32 v129, v98, v99
    v_cvt_pk_bf16_f32 v130, v134, v135
    v_lshlrev_b32 v98, 16, v129
    v_and_b32 v99, s12, v129
    v_lshlrev_b32 v134, 16, v130
    v_and_b32 v135, s12, v130
    v_lshlrev_b32 v100, 16, v100
    v_mul_f32 v100, v100, v128
    s_barrier
    s_waitcnt vmcnt(11)
    s_waitcnt lgkmcnt(14)
    v_mfma_f32_32x32x16_bf16 v[32:47], v[240:243], v[208:211], v[32:47]
    ds_read_b64_tr_b16 v[176:177], v14 offset:45056
    ds_read_b64_tr_b16 v[178:179], v14 offset:46080
    s_waitcnt lgkmcnt(14)
    v_mfma_f32_32x32x16_bf16 v[48:63], v[240:243], v[212:215], v[48:63]
    ds_read_b64_tr_b16 v[180:181], v15 offset:45056
    ds_read_b64_tr_b16 v[182:183], v15 offset:46080
    s_waitcnt vmcnt(10)
    s_waitcnt lgkmcnt(14)
    v_mfma_f32_32x32x16_bf16 v[32:47], v[244:247], v[216:219], v[32:47]
    ds_read_b64_tr_b16 v[184:185], v14 offset:47104
    ds_read_b64_tr_b16 v[186:187], v14 offset:48128
    s_waitcnt lgkmcnt(14)
    v_mfma_f32_32x32x16_bf16 v[48:63], v[244:247], v[220:223], v[48:63]
    ds_read_b64_tr_b16 v[188:189], v15 offset:47104
    ds_read_b64_tr_b16 v[190:191], v15 offset:48128
    s_add_u32 s4, s80, 61440
    buffer_load_dwordx4 v[240:243], v6, s[64:67], s4 offen sc1
    s_add_u32 s4, s80, 62464
    buffer_load_dwordx4 v[244:247], v6, s[64:67], s4 offen sc1
    s_waitcnt vmcnt(11)
    s_waitcnt lgkmcnt(14)
    v_mfma_f32_32x32x16_bf16 v[32:47], v[248:251], v[224:227], v[32:47]
    ds_read_b64_tr_b16 v[192:193], v16 offset:12288
    ds_read_b64_tr_b16 v[194:195], v16 offset:13312
    s_waitcnt lgkmcnt(14)
    v_mfma_f32_32x32x16_bf16 v[48:63], v[248:251], v[228:231], v[48:63]
    ds_read_b64_tr_b16 v[196:197], v17 offset:12288
    ds_read_b64_tr_b16 v[198:199], v17 offset:13312
    s_waitcnt vmcnt(10)
    s_waitcnt lgkmcnt(14)
    v_mfma_f32_32x32x16_bf16 v[32:47], v[252:255], v[232:235], v[32:47]
    ds_read_b64_tr_b16 v[200:201], v16 offset:14336
    ds_read_b64_tr_b16 v[202:203], v16 offset:15360
    s_waitcnt lgkmcnt(14)
    v_mfma_f32_32x32x16_bf16 v[48:63], v[252:255], v[236:239], v[48:63]
    ds_read_b64_tr_b16 v[204:205], v17 offset:14336
    ds_read_b64_tr_b16 v[206:207], v17 offset:15360
    s_add_u32 s4, s80, 69632
    buffer_load_dwordx4 v[248:251], v6, s[64:67], s4 offen sc1
    s_add_u32 s4, s80, 70656
    buffer_load_dwordx4 v[252:255], v6, s[64:67], s4 offen sc1
    v_sub_f32 v136, 1.0, v116
    v_lshlrev_b32 v101, 16, v101
    v_mul_f32 v101, v101, v128
    v_sub_f32 v137, 1.0, v117
    v_cvt_pk_bf16_f32 v129, v100, v101
    v_cvt_pk_bf16_f32 v130, v136, v137
    v_lshlrev_b32 v100, 16, v129
    v_and_b32 v101, s12, v129
    v_lshlrev_b32 v136, 16, v130
    v_and_b32 v137, s12, v130
    v_lshlrev_b32 v102, 16, v102
    v_mul_f32 v102, v102, v128
    v_sub_f32 v138, 1.0, v118
    v_lshlrev_b32 v103, 16, v103
    s_barrier
    s_waitcnt vmcnt(11)
    s_waitcnt lgkmcnt(14)
    v_mfma_f32_32x32x16_bf16 v[32:47], v[160:163], v[176:179], v[32:47]
    ds_read_b64_tr_b16 v[208:209], v14 offset:12288
    ds_read_b64_tr_b16 v[210:211], v14 offset:13312
    s_waitcnt lgkmcnt(14)
    v_mfma_f32_32x32x16_bf16 v[48:63], v[160:163], v[180:183], v[48:63]
    ds_read_b64_tr_b16 v[212:213], v15 offset:12288
    ds_read_b64_tr_b16 v[214:215], v15 offset:13312
    s_waitcnt vmcnt(10)
    s_waitcnt lgkmcnt(14)
    v_mfma_f32_32x32x16_bf16 v[32:47], v[164:167], v[184:187], v[32:47]
    ds_read_b64_tr_b16 v[216:217], v14 offset:14336
    ds_read_b64_tr_b16 v[218:219], v14 offset:15360
    s_waitcnt lgkmcnt(14)
    v_mfma_f32_32x32x16_bf16 v[48:63], v[164:167], v[188:191], v[48:63]
    ds_read_b64_tr_b16 v[220:221], v15 offset:14336
    ds_read_b64_tr_b16 v[222:223], v15 offset:15360
    s_add_u32 s4, s80, 77824
    buffer_load_dwordx4 v[160:163], v6, s[64:67], s4 offen sc1
    s_add_u32 s4, s80, 78848
    buffer_load_dwordx4 v[164:167], v6, s[64:67], s4 offen sc1
    s_waitcnt vmcnt(11)
    s_waitcnt lgkmcnt(14)
    v_mfma_f32_32x32x16_bf16 v[32:47], v[168:171], v[192:195], v[32:47]
    ds_read_b64_tr_b16 v[224:225], v14 offset:20480
    ds_read_b64_tr_b16 v[226:227], v14 offset:21504
    s_waitcnt lgkmcnt(14)
    v_mfma_f32_32x32x16_bf16 v[48:63], v[168:171], v[196:199], v[48:63]
    ds_read_b64_tr_b16 v[228:229], v15 offset:20480
    ds_read_b64_tr_b16 v[230:231], v15 offset:21504
    s_waitcnt vmcnt(10)
    s_waitcnt lgkmcnt(14)
    v_mfma_f32_32x32x16_bf16 v[32:47], v[172:175], v[200:203], v[32:47]
    ds_read_b64_tr_b16 v[232:233], v14 offset:22528
    ds_read_b64_tr_b16 v[234:235], v14 offset:23552
    s_waitcnt lgkmcnt(14)
    v_mfma_f32_32x32x16_bf16 v[48:63], v[172:175], v[204:207], v[48:63]
    ds_read_b64_tr_b16 v[236:237], v15 offset:22528
    ds_read_b64_tr_b16 v[238:239], v15 offset:23552
    s_add_u32 s4, s80, 81920
    buffer_load_dwordx4 v[168:171], v6, s[64:67], s4 offen sc1
    s_add_u32 s4, s80, 82944
    buffer_load_dwordx4 v[172:175], v6, s[64:67], s4 offen sc1
    v_mul_f32 v103, v103, v128
    v_sub_f32 v139, 1.0, v119
    v_cvt_pk_bf16_f32 v129, v102, v103
    v_cvt_pk_bf16_f32 v130, v138, v139
    v_lshlrev_b32 v102, 16, v129
    v_and_b32 v103, s12, v129
    v_lshlrev_b32 v138, 16, v130
    v_and_b32 v139, s12, v130
    v_lshlrev_b32 v104, 16, v104
    v_mul_f32 v104, v104, v128
    v_sub_f32 v140, 1.0, v120
    v_lshlrev_b32 v105, 16, v105
    v_mul_f32 v105, v105, v128
    v_sub_f32 v141, 1.0, v121
    s_barrier
    s_waitcnt vmcnt(11)
    s_waitcnt lgkmcnt(14)
    v_mfma_f32_32x32x16_bf16 v[32:47], v[24:27], v[208:211], v[32:47]
    ds_read_b64_tr_b16 v[176:177], v12 offset:4096
    ds_read_b64_tr_b16 v[178:179], v12 offset:5120
    s_waitcnt lgkmcnt(14)
    v_mfma_f32_32x32x16_bf16 v[48:63], v[24:27], v[212:215], v[48:63]
    ds_read_b64_tr_b16 v[180:181], v13 offset:4096
    ds_read_b64_tr_b16 v[182:183], v13 offset:5120
    s_waitcnt vmcnt(10)
    s_waitcnt lgkmcnt(14)
    v_mfma_f32_32x32x16_bf16 v[32:47], v[148:151], v[216:219], v[32:47]
    ds_read_b64_tr_b16 v[184:185], v12 offset:6144
    ds_read_b64_tr_b16 v[186:187], v12 offset:7168
    s_waitcnt lgkmcnt(14)
    v_mfma_f32_32x32x16_bf16 v[48:63], v[148:151], v[220:223], v[48:63]
    ds_read_b64_tr_b16 v[188:189], v13 offset:6144
    ds_read_b64_tr_b16 v[190:191], v13 offset:7168
    s_add_u32 s4, s80, 90112
    buffer_load_dwordx4 v[24:27], v6, s[64:67], s4 offen sc1
    s_add_u32 s4, s80, 91136
    buffer_load_dwordx4 v[148:151], v6, s[64:67], s4 offen sc1
    s_waitcnt vmcnt(11)
    s_waitcnt lgkmcnt(14)
    v_mfma_f32_32x32x16_bf16 v[32:47], v[152:155], v[224:227], v[32:47]
    ds_read_b64_tr_b16 v[192:193], v12 offset:12288
    ds_read_b64_tr_b16 v[194:195], v12 offset:13312
    s_waitcnt lgkmcnt(14)
    v_mfma_f32_32x32x16_bf16 v[48:63], v[152:155], v[228:231], v[48:63]
    ds_read_b64_tr_b16 v[196:197], v13 offset:12288
    ds_read_b64_tr_b16 v[198:199], v13 offset:13312
    s_waitcnt vmcnt(10)
    s_waitcnt lgkmcnt(14)
    v_mfma_f32_32x32x16_bf16 v[32:47], v[156:159], v[232:235], v[32:47]
    ds_read_b64_tr_b16 v[200:201], v12 offset:14336
    ds_read_b64_tr_b16 v[202:203], v12 offset:15360
    s_waitcnt lgkmcnt(14)
    v_mfma_f32_32x32x16_bf16 v[48:63], v[156:159], v[236:239], v[48:63]
    ds_read_b64_tr_b16 v[204:205], v13 offset:14336
    ds_read_b64_tr_b16 v[206:207], v13 offset:15360
    s_add_u32 s4, s80, 98304
    buffer_load_dwordx4 v[152:155], v6, s[64:67], s4 offen sc1
    s_add_u32 s4, s80, 99328
    buffer_load_dwordx4 v[156:159], v6, s[64:67], s4 offen sc1
    v_cvt_pk_bf16_f32 v129, v104, v105
    v_cvt_pk_bf16_f32 v130, v140, v141
    v_lshlrev_b32 v104, 16, v129
    v_and_b32 v105, s12, v129
    v_lshlrev_b32 v140, 16, v130
    v_and_b32 v141, s12, v130
    v_lshlrev_b32 v106, 16, v106
    v_mul_f32 v106, v106, v128
    v_sub_f32 v142, 1.0, v122
    v_lshlrev_b32 v107, 16, v107
    v_mul_f32 v107, v107, v128
    v_sub_f32 v143, 1.0, v123
    v_cvt_pk_bf16_f32 v129, v106, v107
    v_cvt_pk_bf16_f32 v130, v142, v143
    s_barrier
    s_waitcnt vmcnt(11)
    s_waitcnt lgkmcnt(14)
    v_mfma_f32_32x32x16_bf16 v[32:47], v[240:243], v[176:179], v[32:47]
    ds_read_b64_tr_b16 v[208:209], v12 offset:20480
    ds_read_b64_tr_b16 v[210:211], v12 offset:21504
    s_waitcnt lgkmcnt(14)
    v_mfma_f32_32x32x16_bf16 v[48:63], v[240:243], v[180:183], v[48:63]
    ds_read_b64_tr_b16 v[212:213], v13 offset:20480
    ds_read_b64_tr_b16 v[214:215], v13 offset:21504
    s_waitcnt vmcnt(10)
    s_waitcnt lgkmcnt(14)
    v_mfma_f32_32x32x16_bf16 v[32:47], v[244:247], v[184:187], v[32:47]
    ds_read_b64_tr_b16 v[216:217], v12 offset:22528
    ds_read_b64_tr_b16 v[218:219], v12 offset:23552
    s_waitcnt lgkmcnt(14)
    v_mfma_f32_32x32x16_bf16 v[48:63], v[244:247], v[188:191], v[48:63]
    ds_read_b64_tr_b16 v[220:221], v13 offset:22528
    ds_read_b64_tr_b16 v[222:223], v13 offset:23552
    s_add_u32 s4, s80, 106496
    buffer_load_dwordx4 v[240:243], v6, s[64:67], s4 offen sc1
    s_add_u32 s4, s80, 107520
    buffer_load_dwordx4 v[244:247], v6, s[64:67], s4 offen sc1
    s_waitcnt vmcnt(11)
    s_waitcnt lgkmcnt(14)
    v_mfma_f32_32x32x16_bf16 v[32:47], v[248:251], v[192:195], v[32:47]
    ds_read_b64_tr_b16 v[224:225], v12 offset:28672
    ds_read_b64_tr_b16 v[226:227], v12 offset:29696
    s_waitcnt lgkmcnt(14)
    v_mfma_f32_32x32x16_bf16 v[48:63], v[248:251], v[196:199], v[48:63]
    ds_read_b64_tr_b16 v[228:229], v13 offset:28672
    ds_read_b64_tr_b16 v[230:231], v13 offset:29696
    s_waitcnt vmcnt(10)
    s_waitcnt lgkmcnt(14)
    v_mfma_f32_32x32x16_bf16 v[32:47], v[252:255], v[200:203], v[32:47]
    ds_read_b64_tr_b16 v[232:233], v12 offset:30720
    ds_read_b64_tr_b16 v[234:235], v12 offset:31744
    s_waitcnt lgkmcnt(14)
    v_mfma_f32_32x32x16_bf16 v[48:63], v[252:255], v[204:207], v[48:63]
    ds_read_b64_tr_b16 v[236:237], v13 offset:30720
    ds_read_b64_tr_b16 v[238:239], v13 offset:31744
    s_add_u32 s4, s80, 110592
    buffer_load_dwordx4 v[248:251], v6, s[64:67], s4 offen sc1
    s_add_u32 s4, s80, 111616
    buffer_load_dwordx4 v[252:255], v6, s[64:67], s4 offen sc1
    v_lshlrev_b32 v106, 16, v129
    v_and_b32 v107, s12, v129
    v_lshlrev_b32 v142, 16, v130
    v_and_b32 v143, s12, v130
    v_lshlrev_b32 v108, 16, v108
    v_mul_f32 v108, v108, v128
    v_sub_f32 v144, 1.0, v124
    v_lshlrev_b32 v109, 16, v109
    v_mul_f32 v109, v109, v128
    v_sub_f32 v145, 1.0, v125
    v_cvt_pk_bf16_f32 v129, v108, v109
    v_cvt_pk_bf16_f32 v130, v144, v145
    v_lshlrev_b32 v108, 16, v129
    v_and_b32 v109, s12, v129
    s_barrier
    s_waitcnt vmcnt(11)
    s_waitcnt lgkmcnt(14)
    v_mfma_f32_32x32x16_bf16 v[32:47], v[160:163], v[208:211], v[32:47]
    ds_read_b64_tr_b16 v[176:177], v12 offset:36864
    ds_read_b64_tr_b16 v[178:179], v12 offset:37888
    s_waitcnt lgkmcnt(14)
    v_mfma_f32_32x32x16_bf16 v[48:63], v[160:163], v[212:215], v[48:63]
    ds_read_b64_tr_b16 v[180:181], v13 offset:36864
    ds_read_b64_tr_b16 v[182:183], v13 offset:37888
    s_waitcnt vmcnt(10)
    s_waitcnt lgkmcnt(14)
    v_mfma_f32_32x32x16_bf16 v[32:47], v[164:167], v[216:219], v[32:47]
    ds_read_b64_tr_b16 v[184:185], v12 offset:38912
    ds_read_b64_tr_b16 v[186:187], v12 offset:39936
    s_waitcnt lgkmcnt(14)
    v_mfma_f32_32x32x16_bf16 v[48:63], v[164:167], v[220:223], v[48:63]
    ds_read_b64_tr_b16 v[188:189], v13 offset:38912
    ds_read_b64_tr_b16 v[190:191], v13 offset:39936
    s_waitcnt vmcnt(9)
    s_waitcnt lgkmcnt(14)
    v_mfma_f32_32x32x16_bf16 v[32:47], v[168:171], v[224:227], v[32:47]
    ds_read_b64_tr_b16 v[192:193], v12 offset:45056
    ds_read_b64_tr_b16 v[194:195], v12 offset:46080
    s_waitcnt lgkmcnt(14)
    v_mfma_f32_32x32x16_bf16 v[48:63], v[168:171], v[228:231], v[48:63]
    ds_read_b64_tr_b16 v[196:197], v13 offset:45056
    ds_read_b64_tr_b16 v[198:199], v13 offset:46080
    s_waitcnt vmcnt(8)
    s_waitcnt lgkmcnt(14)
    v_mfma_f32_32x32x16_bf16 v[32:47], v[172:175], v[232:235], v[32:47]
    ds_read_b64_tr_b16 v[200:201], v12 offset:47104
    ds_read_b64_tr_b16 v[202:203], v12 offset:48128
    s_waitcnt lgkmcnt(14)
    v_mfma_f32_32x32x16_bf16 v[48:63], v[172:175], v[236:239], v[48:63]
    ds_read_b64_tr_b16 v[204:205], v13 offset:47104
    ds_read_b64_tr_b16 v[206:207], v13 offset:48128
    v_lshlrev_b32 v144, 16, v130
    v_and_b32 v145, s12, v130
    v_lshlrev_b32 v110, 16, v110
    v_mul_f32 v110, v110, v128
    v_sub_f32 v146, 1.0, v126
    v_lshlrev_b32 v111, 16, v111
    v_mul_f32 v111, v111, v128
    v_sub_f32 v147, 1.0, v127
    v_cvt_pk_bf16_f32 v129, v110, v111
    v_cvt_pk_bf16_f32 v130, v146, v147
    v_lshlrev_b32 v110, 16, v129
    v_and_b32 v111, s12, v129
    v_lshlrev_b32 v146, 16, v130
    v_and_b32 v147, s12, v130
    s_barrier
    s_waitcnt vmcnt(7)
    s_waitcnt lgkmcnt(14)
    v_mfma_f32_32x32x16_bf16 v[32:47], v[24:27], v[176:179], v[32:47]
    ds_read_b64_tr_b16 v[208:209], v14 offset:53248
    ds_read_b64_tr_b16 v[210:211], v14 offset:54272
    s_waitcnt lgkmcnt(14)
    v_mfma_f32_32x32x16_bf16 v[48:63], v[24:27], v[180:183], v[48:63]
    ds_read_b64_tr_b16 v[212:213], v15 offset:53248
    ds_read_b64_tr_b16 v[214:215], v15 offset:54272
    s_waitcnt vmcnt(6)
    s_waitcnt lgkmcnt(14)
    v_mfma_f32_32x32x16_bf16 v[32:47], v[148:151], v[184:187], v[32:47]
    ds_read_b64_tr_b16 v[216:217], v14 offset:55296
    ds_read_b64_tr_b16 v[218:219], v14 offset:56320
    s_waitcnt lgkmcnt(14)
    v_mfma_f32_32x32x16_bf16 v[48:63], v[148:151], v[188:191], v[48:63]
    ds_read_b64_tr_b16 v[220:221], v15 offset:55296
    ds_read_b64_tr_b16 v[222:223], v15 offset:56320
    s_waitcnt vmcnt(5)
    s_waitcnt lgkmcnt(14)
    v_mfma_f32_32x32x16_bf16 v[32:47], v[152:155], v[192:195], v[32:47]
    ds_read_b64_tr_b16 v[224:225], v16 offset:20480
    ds_read_b64_tr_b16 v[226:227], v16 offset:21504
    s_waitcnt lgkmcnt(14)
    v_mfma_f32_32x32x16_bf16 v[48:63], v[152:155], v[196:199], v[48:63]
    ds_read_b64_tr_b16 v[228:229], v17 offset:20480
    ds_read_b64_tr_b16 v[230:231], v17 offset:21504
    s_waitcnt vmcnt(4)
    s_waitcnt lgkmcnt(14)
    v_mfma_f32_32x32x16_bf16 v[32:47], v[156:159], v[200:203], v[32:47]
    ds_read_b64_tr_b16 v[232:233], v16 offset:22528
    ds_read_b64_tr_b16 v[234:235], v16 offset:23552
    s_waitcnt lgkmcnt(14)
    v_mfma_f32_32x32x16_bf16 v[48:63], v[156:159], v[204:207], v[48:63]
    ds_read_b64_tr_b16 v[236:237], v17 offset:22528
    ds_read_b64_tr_b16 v[238:239], v17 offset:23552
    s_waitcnt vmcnt(3)
    s_waitcnt lgkmcnt(14)
    v_mfma_f32_32x32x16_bf16 v[32:47], v[240:243], v[208:211], v[32:47]
    s_waitcnt lgkmcnt(12)
    v_mfma_f32_32x32x16_bf16 v[48:63], v[240:243], v[212:215], v[48:63]
    s_waitcnt vmcnt(2)
    s_waitcnt lgkmcnt(10)
    v_mfma_f32_32x32x16_bf16 v[32:47], v[244:247], v[216:219], v[32:47]
    s_waitcnt lgkmcnt(8)
    v_mfma_f32_32x32x16_bf16 v[48:63], v[244:247], v[220:223], v[48:63]
    s_waitcnt vmcnt(1)
    s_waitcnt lgkmcnt(6)
    v_mfma_f32_32x32x16_bf16 v[32:47], v[248:251], v[224:227], v[32:47]
    s_waitcnt lgkmcnt(4)
    v_mfma_f32_32x32x16_bf16 v[48:63], v[248:251], v[228:231], v[48:63]
    s_waitcnt vmcnt(0)
    s_waitcnt lgkmcnt(2)
    v_mfma_f32_32x32x16_bf16 v[32:47], v[252:255], v[232:235], v[32:47]
    s_waitcnt lgkmcnt(0)
    v_mfma_f32_32x32x16_bf16 v[48:63], v[252:255], v[236:239], v[48:63]
    s_mov_b32 s4, 4096
    s_mov_b32 s5, 12288
    s_cmp_eq_u32 s9, 1
    s_cselect_b32 s4, 20480, s4
    s_cselect_b32 s5, 28672, s5
    s_cmp_eq_u32 s8, 1
    s_cselect_b32 s10, s5, s4
    s_cselect_b32 s11, s4, s5
    v_lshlrev_b32 v7, 4, v0
    v_add_u32 v8, s10, v7
    v_add_u32 v9, s11, v7
    s_nop 4
    s_cbranch_scc1 L_40
    ds_write_b128 v8, v[48:51] offset:0
    ds_write_b128 v8, v[80:83] offset:4096
    ds_write_b128 v8, v[52:55] offset:1024
    ds_write_b128 v8, v[84:87] offset:5120
    ds_write_b128 v8, v[56:59] offset:2048
    ds_write_b128 v8, v[88:91] offset:6144
    ds_write_b128 v8, v[60:63] offset:3072
    ds_write_b128 v8, v[92:95] offset:7168
    v_pk_add_f32 v[64:65], v[64:65], v[96:97]
    v_pk_add_f32 v[66:67], v[66:67], v[98:99]
    v_pk_add_f32 v[68:69], v[68:69], v[100:101]
    v_pk_add_f32 v[70:71], v[70:71], v[102:103]
    v_pk_add_f32 v[72:73], v[72:73], v[104:105]
    v_pk_add_f32 v[74:75], v[74:75], v[106:107]
    v_pk_add_f32 v[76:77], v[76:77], v[108:109]
    v_pk_add_f32 v[78:79], v[78:79], v[110:111]
    s_waitcnt lgkmcnt(0)
    s_barrier
    ds_read_b128 v[176:179], v9 offset:0
    ds_read_b128 v[192:195], v9 offset:4096
    ds_read_b128 v[180:183], v9 offset:1024
    ds_read_b128 v[196:199], v9 offset:5120
    ds_read_b128 v[184:187], v9 offset:2048
    ds_read_b128 v[200:203], v9 offset:6144
    ds_read_b128 v[188:191], v9 offset:3072
    ds_read_b128 v[204:207], v9 offset:7168
    s_waitcnt lgkmcnt(6)
    v_pk_add_f32 v[176:177], v[176:177], v[32:33]
    v_pk_add_f32 v[192:193], v[192:193], v[64:65]
    v_pk_add_f32 v[178:179], v[178:179], v[34:35]
    v_pk_add_f32 v[194:195], v[194:195], v[66:67]
    s_waitcnt lgkmcnt(4)
    v_pk_add_f32 v[180:181], v[180:181], v[36:37]
    v_pk_add_f32 v[196:197], v[196:197], v[68:69]
    v_pk_add_f32 v[182:183], v[182:183], v[38:39]
    v_pk_add_f32 v[198:199], v[198:199], v[70:71]
    s_waitcnt lgkmcnt(2)
    v_pk_add_f32 v[184:185], v[184:185], v[40:41]
    v_pk_add_f32 v[200:201], v[200:201], v[72:73]
    v_pk_add_f32 v[186:187], v[186:187], v[42:43]
    v_pk_add_f32 v[202:203], v[202:203], v[74:75]
    s_waitcnt lgkmcnt(0)
    v_pk_add_f32 v[188:189], v[188:189], v[44:45]
    v_pk_add_f32 v[204:205], v[204:205], v[76:77]
    v_pk_add_f32 v[190:191], v[190:191], v[46:47]
    v_pk_add_f32 v[206:207], v[206:207], v[78:79]
    s_branch L_41
L_40:
    ds_write_b128 v8, v[32:35] offset:0
    ds_write_b128 v8, v[64:67] offset:4096
    ds_write_b128 v8, v[36:39] offset:1024
    ds_write_b128 v8, v[68:71] offset:5120
    ds_write_b128 v8, v[40:43] offset:2048
    ds_write_b128 v8, v[72:75] offset:6144
    ds_write_b128 v8, v[44:47] offset:3072
    ds_write_b128 v8, v[76:79] offset:7168
    v_pk_add_f32 v[80:81], v[80:81], v[96:97]
    v_pk_add_f32 v[82:83], v[82:83], v[98:99]
    v_pk_add_f32 v[84:85], v[84:85], v[100:101]
    v_pk_add_f32 v[86:87], v[86:87], v[102:103]
    v_pk_add_f32 v[88:89], v[88:89], v[104:105]
    v_pk_add_f32 v[90:91], v[90:91], v[106:107]
    v_pk_add_f32 v[92:93], v[92:93], v[108:109]
    v_pk_add_f32 v[94:95], v[94:95], v[110:111]
    s_waitcnt lgkmcnt(0)
    s_barrier
    ds_read_b128 v[176:179], v9 offset:0
    ds_read_b128 v[192:195], v9 offset:4096
    ds_read_b128 v[180:183], v9 offset:1024
    ds_read_b128 v[196:199], v9 offset:5120
    ds_read_b128 v[184:187], v9 offset:2048
    ds_read_b128 v[200:203], v9 offset:6144
    ds_read_b128 v[188:191], v9 offset:3072
    ds_read_b128 v[204:207], v9 offset:7168
    s_waitcnt lgkmcnt(6)
    v_pk_add_f32 v[176:177], v[176:177], v[48:49]
    v_pk_add_f32 v[192:193], v[192:193], v[80:81]
    v_pk_add_f32 v[178:179], v[178:179], v[50:51]
    v_pk_add_f32 v[194:195], v[194:195], v[82:83]
    s_waitcnt lgkmcnt(4)
    v_pk_add_f32 v[180:181], v[180:181], v[52:53]
    v_pk_add_f32 v[196:197], v[196:197], v[84:85]
    v_pk_add_f32 v[182:183], v[182:183], v[54:55]
    v_pk_add_f32 v[198:199], v[198:199], v[86:87]
    s_waitcnt lgkmcnt(2)
    v_pk_add_f32 v[184:185], v[184:185], v[56:57]
    v_pk_add_f32 v[200:201], v[200:201], v[88:89]
    v_pk_add_f32 v[186:187], v[186:187], v[58:59]
    v_pk_add_f32 v[202:203], v[202:203], v[90:91]
    s_waitcnt lgkmcnt(0)
    v_pk_add_f32 v[188:189], v[188:189], v[60:61]
    v_pk_add_f32 v[204:205], v[204:205], v[92:93]
    v_pk_add_f32 v[190:191], v[190:191], v[62:63]
    v_pk_add_f32 v[206:207], v[206:207], v[94:95]
L_41:
    v_cvt_pk_bf16_f32 v224, v176, v177
    v_pk_mul_f32 v[192:193], v[192:193], v[112:113]
    v_lshlrev_b32 v176, 16, v224
    v_and_b32 v177, s12, v224
    v_pk_mul_f32 v[176:177], v[176:177], v[132:133]
    v_cvt_pk_bf16_f32 v224, v176, v177
    v_lshlrev_b32 v176, 16, v224
    v_and_b32 v177, s12, v224
    v_pk_add_f32 v[192:193], v[192:193], v[176:177]
    s_mov_b32 s4, 0
    buffer_store_dword v192, v5, s[60:63], s4 offen sc1
    s_mov_b32 s4, 2048
    buffer_store_dword v193, v5, s[60:63], s4 offen sc1
    v_cvt_pk_bf16_f32 v226, v178, v179
    v_pk_mul_f32 v[194:195], v[194:195], v[114:115]
    v_lshlrev_b32 v178, 16, v226
    v_and_b32 v179, s12, v226
    v_pk_mul_f32 v[178:179], v[178:179], v[134:135]
    v_cvt_pk_bf16_f32 v226, v178, v179
    v_lshlrev_b32 v178, 16, v226
    v_and_b32 v179, s12, v226
    v_pk_add_f32 v[194:195], v[194:195], v[178:179]
    s_mov_b32 s4, 4096
    buffer_store_dword v194, v5, s[60:63], s4 offen sc1
    s_mov_b32 s4, 6144
    buffer_store_dword v195, v5, s[60:63], s4 offen sc1
    v_cvt_pk_bf16_f32 v228, v180, v181
    v_pk_mul_f32 v[196:197], v[196:197], v[116:117]
    v_lshlrev_b32 v180, 16, v228
    v_and_b32 v181, s12, v228
    v_pk_mul_f32 v[180:181], v[180:181], v[136:137]
    v_cvt_pk_bf16_f32 v228, v180, v181
    v_lshlrev_b32 v180, 16, v228
    v_and_b32 v181, s12, v228
    v_pk_add_f32 v[196:197], v[196:197], v[180:181]
    s_mov_b32 s4, 16384
    buffer_store_dword v196, v5, s[60:63], s4 offen sc1
    s_mov_b32 s4, 18432
    buffer_store_dword v197, v5, s[60:63], s4 offen sc1
    v_cvt_pk_bf16_f32 v230, v182, v183
    v_pk_mul_f32 v[198:199], v[198:199], v[118:119]
    v_lshlrev_b32 v182, 16, v230
    v_and_b32 v183, s12, v230
    v_pk_mul_f32 v[182:183], v[182:183], v[138:139]
    v_cvt_pk_bf16_f32 v230, v182, v183
    v_lshlrev_b32 v182, 16, v230
    v_and_b32 v183, s12, v230
    v_pk_add_f32 v[198:199], v[198:199], v[182:183]
    s_mov_b32 s4, 20480
    buffer_store_dword v198, v5, s[60:63], s4 offen sc1
    s_mov_b32 s4, 22528
    buffer_store_dword v199, v5, s[60:63], s4 offen sc1
    v_cvt_pk_bf16_f32 v224, v184, v185
    v_pk_mul_f32 v[200:201], v[200:201], v[120:121]
    v_lshlrev_b32 v184, 16, v224
    v_and_b32 v185, s12, v224
    v_pk_mul_f32 v[184:185], v[184:185], v[140:141]
    v_cvt_pk_bf16_f32 v224, v184, v185
    v_lshlrev_b32 v184, 16, v224
    v_and_b32 v185, s12, v224
    v_pk_add_f32 v[200:201], v[200:201], v[184:185]
    s_mov_b32 s4, 32768
    buffer_store_dword v200, v5, s[60:63], s4 offen sc1
    s_mov_b32 s4, 34816
    buffer_store_dword v201, v5, s[60:63], s4 offen sc1
    v_cvt_pk_bf16_f32 v226, v186, v187
    v_pk_mul_f32 v[202:203], v[202:203], v[122:123]
    v_lshlrev_b32 v186, 16, v226
    v_and_b32 v187, s12, v226
    v_pk_mul_f32 v[186:187], v[186:187], v[142:143]
    v_cvt_pk_bf16_f32 v226, v186, v187
    v_lshlrev_b32 v186, 16, v226
    v_and_b32 v187, s12, v226
    v_pk_add_f32 v[202:203], v[202:203], v[186:187]
    s_mov_b32 s4, 36864
    buffer_store_dword v202, v5, s[60:63], s4 offen sc1
    s_mov_b32 s4, 38912
    buffer_store_dword v203, v5, s[60:63], s4 offen sc1
    v_cvt_pk_bf16_f32 v228, v188, v189
    v_pk_mul_f32 v[204:205], v[204:205], v[124:125]
    v_lshlrev_b32 v188, 16, v228
    v_and_b32 v189, s12, v228
    v_pk_mul_f32 v[188:189], v[188:189], v[144:145]
    v_cvt_pk_bf16_f32 v228, v188, v189
    v_lshlrev_b32 v188, 16, v228
    v_and_b32 v189, s12, v228
    v_pk_add_f32 v[204:205], v[204:205], v[188:189]
    s_mov_b32 s4, 49152
    buffer_store_dword v204, v5, s[60:63], s4 offen sc1
    s_mov_b32 s4, 51200
    buffer_store_dword v205, v5, s[60:63], s4 offen sc1
    v_cvt_pk_bf16_f32 v230, v190, v191
    v_pk_mul_f32 v[206:207], v[206:207], v[126:127]
    v_lshlrev_b32 v190, 16, v230
    v_and_b32 v191, s12, v230
    v_pk_mul_f32 v[190:191], v[190:191], v[146:147]
    v_cvt_pk_bf16_f32 v230, v190, v191
    v_lshlrev_b32 v190, 16, v230
    v_and_b32 v191, s12, v230
    v_pk_add_f32 v[206:207], v[206:207], v[190:191]
    s_mov_b32 s4, 53248
    buffer_store_dword v206, v5, s[60:63], s4 offen sc1
    s_mov_b32 s4, 55296
    buffer_store_dword v207, v5, s[60:63], s4 offen sc1
    s_endpgm
L_1:
    s_endpgm
L_code_end:
    s_endpgm
.section .rodata,"a"
.p2align 6
.amdhsa_kernel gated_mix__ssm_conv_s5__glu_gated_glu__prompt_kernel
  .amdhsa_next_free_vgpr 256
  .amdhsa_next_free_sgpr 102
  .amdhsa_accum_offset 256
  .amdhsa_group_segment_fixed_size 0
  .amdhsa_kernarg_size 136
  .amdhsa_user_sgpr_count 2
  .amdhsa_user_sgpr_kernarg_segment_ptr 1
  .amdhsa_system_sgpr_workgroup_id_x 1
.end_amdhsa_kernel
```
